```python
import torch

def _softmax(x, axis=-1):
    return torch.softmax(x, dim=axis)
def _gelu(x):
    return torch.nn.functional.gelu(x, approximate="tanh")
def _silu(x):
    return torch.nn.functional.silu(x)
def _sigmoid(x):
    return torch.sigmoid(x)
def _layernorm(x, axis=-1, eps=1e-5):
    m = x.mean(dim=axis, keepdim=True)
    v = x.var(dim=axis, keepdim=True, unbiased=False)
    return (x - m) / torch.sqrt(v + eps)
def _scatter_add(tgt, idx, src, axis=0):
    return tgt.clone().index_add_(axis, idx, src)
def _segment_sum(src, seg, n):
    out = torch.zeros((n,) + src.shape[1:], dtype=src.dtype)
    return out.index_add_(0, seg, src)
def _pad(x, pw):
    flat = tuple(v for pair in reversed(pw) for v in pair)
    return torch.nn.functional.pad(x, flat)

kernel_name = 'gated_mix__linear_kernel_hedgehog__glu_gated_geglu__prompt'

def setup_inputs():

    _w = (lambda a: (lambda t: t.to(torch.bfloat16) if t.is_floating_point() else t)(torch.as_tensor(a)))
    def _A_setup():
        B, S, D, H = 1, 2048, 512, 32
        Dh = D // H
        return {
            "x": _w((lambda *s: torch.randn(*s, dtype=torch.bfloat16) * 0.05)(B, S, D)),
            "wqkv": _w((lambda *s: torch.randn(*s, dtype=torch.bfloat16) * 0.8)(D, 3 * D)),
            "w_phi": _w((lambda *s: torch.randn(*s, dtype=torch.bfloat16) * 0.8)(H, Dh, Dh) * (Dh ** -0.5)),
            "wo": _w((lambda *s: torch.randn(*s, dtype=torch.bfloat16) * 0.05)(D, D)),
        }
    _A_in = _A_setup()

    def _B_setup():
        B, S, Dm, Df = 1, 2048, 512, 1376
        return {
            "x": _w((lambda *s: torch.randn(*s, dtype=torch.bfloat16) * 0.05)(B, S, Dm)),
            "w_gate": _w((lambda *s: torch.randn(*s, dtype=torch.bfloat16) * 1.6)(Dm, Df) * (Dm ** -0.5)),
            "w_up": _w((lambda *s: torch.randn(*s, dtype=torch.bfloat16) * 1.6)(Dm, Df) * (Dm ** -0.5)),
            "w_down": _w((lambda *s: torch.randn(*s, dtype=torch.bfloat16) * 1.6)(Df, Dm) * (Df ** -0.5)),
        }
    _B_in = _B_setup()

    return {
        "A_x": _A_in["x"],
        "A_wqkv": _A_in["wqkv"],
        "A_w_phi": _A_in["w_phi"],
        "A_wo": _A_in["wo"],
        "B_x": _B_in["x"],
        "B_w_gate": _B_in["w_gate"],
        "B_w_up": _B_in["w_up"],
        "B_w_down": _B_in["w_down"],
        "gate_w": _w((lambda *s: torch.randn(*s, dtype=torch.bfloat16) * 0.05)(512) * 16.0),
    }

def reference(A_x, A_wqkv, A_w_phi, A_wo, B_x, B_w_gate, B_w_up, B_w_down, gate_w):
    def _A_ref(x, wqkv, w_phi, wo):
        B, S, D = x.shape
        H = 32; Dh = D // H
        qkv = (lambda x, *d: x.permute(*d))((x @ wqkv).reshape(B, S, 3, H, Dh), 2, 0, 3, 1, 4)
        q, k, v = qkv[0], qkv[1], qkv[2]
        pq = torch.einsum("bhsd,hdf->bhsf", q, w_phi)
        pk = torch.einsum("bhsd,hdf->bhsf", k, w_phi)
        phi_q = torch.concatenate([_softmax(pq, axis=-1), _softmax(-pq, axis=-1)], axis=-1)
        phi_k = torch.concatenate([_softmax(pk, axis=-1), _softmax(-pk, axis=-1)], axis=-1)
        kv = torch.einsum("bhsf,bhsd->bhfd", phi_k, v)
        z  = torch.einsum("bhsf->bhf", phi_k)
        num = torch.einsum("bhqf,bhfd->bhqd", phi_q, kv)
        den = torch.einsum("bhqf,bhf->bhq", phi_q, z)[..., None] + 1e-6
        o = num / den
        return (lambda x, *d: x.permute(*d))(o, 0, 2, 1, 3).reshape(B, S, D) @ wo

    def _B_ref(x, w_gate, w_up, w_down):
        g = torch.einsum("bsd,df->bsf", x, w_gate)
        u = torch.einsum("bsd,df->bsf", x, w_up)
        h = _gelu(g) * u
        return torch.einsum("bsf,fd->bsd", h, w_down)

    x = A_x
    g = _sigmoid((x * gate_w).sum(-1, keepdims=True))
    a = _A_ref(x, A_wqkv, A_w_phi, A_wo)
    b = _B_ref(x, B_w_gate, B_w_up, B_w_down)
    return g * a + (1 - g) * b
```

```asm
; @launch grid=(256,1,1) block=(256,1,1) lds=163840
.amdgcn_target "amdgcn-amd-amdhsa--gfx950"
.text
.globl gated_mix__linear_kernel_hedgehog__glu_gated_geglu__prompt_kernel
.p2align 12
.p2align 8
.type gated_mix__linear_kernel_hedgehog__glu_gated_geglu__prompt_kernel,@function
gated_mix__linear_kernel_hedgehog__glu_gated_geglu__prompt_kernel:
s_cmp_ge_u32 s2, 256
s_cbranch_scc1 L_end
s_load_dwordx16 s[4:19], s[0:1], 0
s_load_dwordx8 s[20:27], s[0:1], 64
v_lshrrev_b32 v68, 6, v0
v_and_b32 v1, 63, v0
s_and_b32 s90, s2, 7
s_lshr_b32 s91, s2, 3
v_readfirstlane_b32 s74, v68
s_and_b32 s72, s90, 1
s_lshl_b32 s72, s72, 3
s_and_b32 s78, s91, 7
s_add_u32 s72, s72, s78
s_lshr_b32 s92, s91, 3
s_and_b32 s73, s90, 6
s_lshr_b32 s93, s92, 1
s_add_u32 s73, s73, s93
s_lshl_b32 s87, s74, 12
s_getpc_b64 s[100:101]
L_pc:
s_lshl_b32 s83, s78, 2
s_add_u32 s83, s83, s74
s_mul_i32 s83, s83, 768
s_cmp_ge_u32 s73, 6
s_cselect_b32 s84, L_KL-L_KH, 0
s_bitcmp1_b32 s92, 0
s_cselect_b32 s84, L_Q-L_KH, s84
s_add_u32 s83, s83, L_KH-L_pc
s_add_u32 s83, s83, s84
v_lshl_add_u32 v69, v1, 7, s83
s_mov_b64 exec, 63
global_load_dword v45, v69, s[100:101]
s_mov_b64 exec, -1
s_mul_i32 s79, s93, 3
s_add_u32 s79, s79, 1
s_bitcmp1_b32 s92, 0
s_cselect_b32 s79, s79, 0
s_add_u32 s79, s79, s78
s_lshl_b32 s79, s79, 7
s_lshl_b32 s80, s72, 7
v_lshrrev_b32 v71, 3, v1
v_lshrrev_b32 v70, 4, v1
v_xor_b32 v69, v70, v1
v_and_b32 v69, 7, v69
v_lshl_add_u32 v71, v68, 5, v71
v_add_lshl_u32 v71, v71, s80, 10
v_lshl_add_u32 v2, v69, 4, v71
v_xor_b32_e64 v3, 64, v2
v_add_u32 v3, 7168, v3
v_add_u32 v4, 14336, v2
v_add_u32 v5, 14336, v3
s_lshl_b32 s81, s73, 7
s_mov_b32 s30, 2097152
s_mov_b32 s31, 0x20000
s_mov_b32 s34, 1572864
s_mov_b32 s35, 0x20000
s_bitcmp1_b32 s92, 0
s_cbranch_scc1 L_Q
v_bfe_u32 v71, v1, 2, 2
v_lshl_add_u32 v71, v68, 4, v71
v_mul_u32_u24 v71, 3, v71
v_lshrrev_b32_e64 v72, 5, v1
v_add3_u32 v71, v71, v72, 1
v_and_b32_e64 v72, 1, v70
v_lshl_add_u32 v71, v71, 4, v72
v_and_b32_e64 v72, 3, v1
v_lshl_add_u32 v71, v71, 2, v72
v_lshl_add_u32 v6, v71, 4, s81
v_add_u32 v7, 11264, v6
v_add_u32 v8, 22528, v6
v_add_u32 v9, 33792, v6
v_xor_b32 v8, 32, v8
v_xor_b32 v9, 32, v9
s_add_u32 m0, s87, 0
s_add_u32 s84, s79, 0
s_and_b32 s84, s84, 0x380
s_waitcnt lgkmcnt(0)
s_mov_b64 s[28:29], s[4:5]
s_mov_b64 s[32:33], s[6:7]
buffer_load_dwordx4 v2, s[28:31], s84 offen lds
buffer_load_dwordx4 v3, s[28:31], s84 offen offset:1024 lds
buffer_load_dwordx4 v4, s[28:31], s84 offen offset:2048 lds
buffer_load_dwordx4 v5, s[28:31], s84 offen offset:3072 lds
s_add_u32 m0, s87, 65536
s_mul_i32 s85, s84, 1536
buffer_load_dwordx4 v6, s[32:35], s85 offen lds
buffer_load_dwordx4 v7, s[32:35], s85 offen offset:1024 lds
buffer_load_dwordx4 v8, s[32:35], s85 offen offset:2048 lds
buffer_load_dwordx4 v9, s[32:35], s85 offen offset:3072 lds
s_cmp_ge_u32 s73, 6
s_cbranch_scc1 L_KL
s_branch L_KH
.p2align 12
L_KH:
s_and_b32 s75, s74, 1
s_lshr_b32 s76, s74, 1
v_lshlrev_b32_e64 v38, 4, v1
s_bfe_u32 s77, s2, 0x20001
s_bitcmp1_b32 s2, 0
s_cselect_b32 s90, 0, 4
s_add_u32 s77, s77, s90
s_lshl_b32 s77, s77, 2
s_and_b32 s90, s78, 1
s_xor_b32 s90, s90, s92
s_add_u32 s77, s77, s90
v_bfe_u32 v68, v1, 2, 2
v_and_b32 v69, 3, v1
v_lshlrev_b32_e64 v69, 3, v69
v_lshl_add_u32 v43, v68, 6, v69
v_lshrrev_b32_e64 v70, 5, v1
v_bfe_u32 v71, v1, 4, 1
v_and_b32_e64 v72, 15, v1
v_bfe_u32 v73, v1, 1, 3
v_lshrrev_b32 v75, 4, v1
v_xor_b32 v73, v73, v75
v_lshlrev_b32_e64 v73, 4, v73
v_lshl_add_u32 v73, v72, 7, v73
s_lshl_b32 s90, s75, 13
s_lshl_b32 s91, s76, 12
s_add_u32 s90, s90, s91
v_add_u32 v16, s90, v73
v_xor_b32_e64 v17, 64, v16
v_xor_b32 v18, 0x1000, v16
v_xor_b32 v19, 0x1040, v16
v_lshl_add_u32 v74, v71, 5, v43
v_lshl_add_u32 v40, v70, 11, v74
v_add_u32_e64 v40, s87, v40
v_lshl_add_u32 v40, v71, 9, v40
v_add_u32 v41, 0x10000, v40
v_add_u32 v42, 0x20000, v40
v_xor_b32 v13, 32, v40
v_xor_b32 v14, 32, v41
v_xor_b32 v15, 32, v42
v_lshrrev_b32 v75, 1, v1
v_xor_b32 v75, v75, v1
v_and_b32 v75, 1, v75
v_mul_u32_u24_e64 v75, 24, v75
v_xor_b32 v75, v75, v74
s_lshl_b32 s90, s76, 8
s_add_u32 s90, s90, 65536
v_lshrrev_b32_e64 v76, 4, v1
v_mul_u32_u24 v76, 2048, v76
v_add3_u32 v60, v76, v75, s90
v_xor_b32_e64 v61, 32, v60
v_add3_u32 v62, v76, v74, s90
v_xor_b32_e64 v63, 32, v62
s_mov_b64 exec, 0
s_cmp_eq_u32 s74, 0
s_cbranch_scc1 L_pad_KH_1
s_cmp_eq_u32 s74, 1
s_cbranch_scc1 L_pad_KH_2
s_cmp_eq_u32 s74, 2
s_cbranch_scc1 L_pad_KH_3
s_branch L_pad_KH_4
L_warm_KH:
s_mov_b64 exec, -1
s_mov_b64 s[60:61], s[8:9]
s_mov_b32 s62, 16384
s_mov_b32 s63, 0x20000
s_mov_b64 s[64:65], s[20:21]
s_mov_b32 s66, 1024
s_mov_b32 s67, 0x20000
s_mov_b64 s[52:53], s[26:27]
s_mov_b32 s54, 9109504
s_mov_b32 s55, 0x20000
s_mov_b64 s[36:37], s[14:15]
s_mov_b32 s38, 1409024
s_mov_b32 s39, 0x20000
s_mov_b64 s[40:41], s[16:17]
s_mov_b32 s42, 1409024
s_mov_b32 s43, 0x20000
s_mov_b64 s[44:45], s[10:11]
s_mov_b32 s46, 524288
s_mov_b32 s47, 0x20000
s_mov_b64 s[48:49], s[18:19]
s_mov_b32 s50, 1409024
s_mov_b32 s51, 0x20000
s_mov_b64 s[56:57], s[22:23]
s_mov_b32 s58, 2097152
s_mov_b32 s59, 0x20000
s_add_u32 s26, s52, 8519680
s_addc_u32 s27, s53, 0
s_lshr_b32 s95, s73, 1
s_mul_i32 s95, s95, 22
s_and_b32 s90, s73, 1
s_mul_i32 s90, s90, 5
s_add_u32 s95, s95, s90
s_cmp_eq_u32 s73, 7
s_cselect_b32 s90, 1, 0
s_sub_u32 s95, s95, s90
s_lshr_b32 s82, s95, 1
s_lshl_b32 s82, s82, 6
s_mul_i32 s89, s74, 6144
v_lshl_add_u32 v76, v70, 2, v71
v_mul_u32_u24 v76, 1536, v76
v_add_u32 v76, v76, v75
s_and_b32 s93, s95, 1
s_lshl_b32 s90, s76, 1
s_add_u32 s90, s90, s93
s_lshr_b32 s91, s90, 1
s_lshl_b32 s91, s91, 8
s_and_b32 s92, s90, 1
s_lshl_b32 s92, s92, 5
v_xor_b32 v20, s92, v76
v_add_u32 v20, s91, v20
v_add_u32 v23, 0x10000, v20
s_add_u32 s90, s90, 1
s_lshr_b32 s91, s90, 1
s_lshl_b32 s91, s91, 8
s_and_b32 s92, s90, 1
s_lshl_b32 s92, s92, 5
v_xor_b32 v21, s92, v76
v_add_u32_e64 v21, s91, v21
v_add_u32 v24, 0x10000, v21
s_add_u32 s90, s93, 4
s_lshr_b32 s91, s90, 1
s_lshl_b32 s91, s91, 8
s_and_b32 s92, s90, 1
s_lshl_b32 s92, s92, 5
v_xor_b32 v22, s92, v76
v_add_u32_e64 v22, s91, v22
v_add_u32 v25, 0x10000, v22
v_bfe_u32 v68, v1, 2, 2
v_and_b32 v69, 3, v1
v_lshlrev_b32 v69, 4, v69
v_lshrrev_b32 v70, 4, v1
s_lshl_b32 s90, s74, 4
v_add_u32_e64 v73, s90, v68
v_mul_u32_u24 v73, 2752, v73
v_lshl_add_u32 v74, v70, 6, v69
s_movk_i32 s90, 10816
v_add3_u32 v73, v73, v74, s82
v_add_u32 v71, 1, v70
v_lshrrev_b32_e64 v71, 2, v71
v_mad_u32_u24 v10, v71, s90, v73
v_add_u32 v71, 2, v70
v_lshrrev_b32 v71, 2, v71
v_mad_u32_u24 v11, v71, s90, v73
v_add_u32 v11, 10048, v11
v_add_u32 v71, 3, v70
v_lshrrev_b32 v71, 2, v71
v_mad_u32_u24 v12, v71, s90, v73
v_add_u32 v12, 20096, v12
v_and_b32 v71, 32, v1
v_xor_b32 v11, v71, v11
v_xor_b32_e64 v12, 32, v12
v_mov_b32 v48, 0xbdd2d3e8
v_mov_b32 v49, 0xc0135761
v_mov_b32 v50, 0x3fb8aa3b
v_mov_b32 v51, 0x358637bd
s_mov_b32 s69, 1
s_mov_b32 s70, 65536
s_mov_b32 s98, 0xffff0000
s_mov_b32 s99, 0xffff0000
v_lshrrev_b32 v68, 5, v1
v_bfe_u32 v69, v1, 1, 4
v_lshlrev_b32 v68, 1, v68
v_sub_u32 v68, v69, v68
v_and_b32 v69, 1, v1
v_lshlrev_b32 v69, 4, v69
v_mov_b32 v70, 0x3f80
v_lshlrev_b32_e64 v70, v69, v70
v_cmp_eq_u32 s[16:17], 0, v68
v_cmp_eq_u32 s[18:19], 1, v68
v_cmp_eq_u32 s[20:21], 4, v68
v_cmp_eq_u32 s[22:23], 5, v68
v_cndmask_b32 v52, 0, v70, s[16:17]
v_cndmask_b32 v53, 0, v70, s[18:19]
v_cndmask_b32 v54, 0, v70, s[20:21]
v_cndmask_b32 v55, 0, v70, s[22:23]
v_cmp_eq_u32 s[16:17], 8, v68
v_cmp_eq_u32 s[18:19], 9, v68
v_cmp_eq_u32 s[20:21], 12, v68
v_cmp_eq_u32 s[22:23], 13, v68
v_cndmask_b32 v56, 0, v70, s[16:17]
v_cndmask_b32 v57, 0, v70, s[18:19]
v_cndmask_b32 v58, 0, v70, s[20:21]
v_cndmask_b32 v59, 0, v70, s[22:23]
s_lshl_b32 s91, s74, 3
s_or_b32 s91, s91, 0x80000
s_bfe_u32 s4, 0x2620100a, s91
s_bfe_u32 s5, 0x504a3c36, s91
s_bfe_u32 s6, 0x1b160500, s91
s_bfe_u32 s7, 0x4642312c, s91
s_mul_i32 s90, s77, 118
s_lshl_b32 s92, s78, 7
s_add_u32 s8, s4, s90
s_lshl_b32 s8, s8, 11
s_lshl_b32 s4, s4, 14
s_add_u32 s4, s4, s92
s_add_u32 s9, s5, s90
s_lshl_b32 s9, s9, 11
s_lshl_b32 s5, s5, 14
s_add_u32 s5, s5, s92
s_add_u32 s10, s6, s90
s_lshl_b32 s10, s10, 11
s_lshl_b32 s6, s6, 14
s_add_u32 s6, s6, s92
s_add_u32 s11, s7, s90
s_lshl_b32 s11, s11, 11
s_lshl_b32 s7, s7, 14
s_add_u32 s7, s7, s92
s_lshl_b32 s91, s74, 2
s_add_u32 s12, s91, s90
s_add_u32 s12, s12, 86
s_lshl_b32 s12, s12, 11
s_lshl_b32 s13, s74, 16
s_add_u32 s13, s13, s92
s_lshl_b32 s14, s77, 2
s_add_u32 s14, s14, s74
s_lshl_b32 s14, s14, 8
s_add_u32 s14, s14, 8192
s_mov_b64 s[18:19], s[6:7]
s_mov_b64 s[20:21], s[10:11]
s_add_u32 s22, s12, 32768
s_add_u32 s23, s13, 262144
s_xor_b32 s90, s78, s77
s_bitcmp1_b32 s90, 1
s_cselect_b32 s90, s5, s4
s_cselect_b32 s5, s4, s5
s_mov_b32 s4, s90
s_cselect_b32 s90, s7, s6
s_cselect_b32 s7, s6, s7
s_mov_b32 s6, s90
s_cselect_b32 s90, s9, s8
s_cselect_b32 s9, s8, s9
s_mov_b32 s8, s90
s_cselect_b32 s90, s11, s10
s_cselect_b32 s11, s10, s11
s_mov_b32 s10, s90
s_cselect_b32 s90, s22, s12
s_cselect_b32 s22, s12, s22
s_mov_b32 s12, s90
s_cselect_b32 s90, s23, s13
s_cselect_b32 s23, s13, s23
s_mov_b32 s13, s90
v_bfe_u32 v68, v1, 2, 2
v_and_b32 v69, 3, v1
v_lshlrev_b32 v69, 4, v69
v_lshrrev_b32 v70, 4, v1
v_and_b32 v71, 32, v1
v_xor_b32 v69, v69, v71
v_lshrrev_b32 v71, 5, v1
v_lshl_add_u32 v71, v71, 2, v68
v_mul_u32_u24 v71, 1024, v71
v_and_b32_e64 v72, 1, v70
v_lshl_add_u32 v72, v72, 6, v69
v_add3_u32 v32, v71, v72, 0
v_add_u32 v33, 7168, v32
v_add_u32 v34, 14336, v32
v_add_u32 v35, 21504, v32
s_cmp_ge_u32 s74, 2
s_cselect_b32 s90, 2146435072, 0
v_add_u32 v36, s90, v34
v_add_u32 v37, s90, v35
v_add_u32 v39, s90, v38
s_sub_u32 s91, s21, s20
s_add_u32 s90, s90, s91
v_and_b32_e64 v68, 15, v1
v_bfe_u32 v69, v1, 4, 1
v_lshlrev_b32_e64 v68, 4, v68
v_lshl_add_u32 v68, v69, 9, v68
v_lshrrev_b32_e64 v69, 5, v1
v_lshl_add_u32 v77, v69, 11, v68
v_mul_lo_u32 v69, v69, s90
v_add_u32_e64 v39, v68, v69
s_lshl_b32 s94, s72, 1
s_add_u32 s94, s94, s75
s_mul_i32 s94, s94, 241664
s_lshl_b32 s15, s73, 2
s_add_u32 s15, s15, s74
s_lshl_b32 s15, s15, 8
s_lshl_b32 s16, s72, 1
s_add_u32 s16, s16, s75
s_lshl_b32 s16, s16, 10
s_add_u32 s16, s16, 8192
s_and_b32 s17, s73, 3
s_lshl_b32 s17, s17, 8
s_add_u32 s17, s17, s16
s_and_b32 s90, s2, 63
s_lshr_b32 s91, s2, 7
s_lshl_b32 s91, s91, 6
s_add_u32 s90, s90, s91
s_lshl_b32 s90, s90, 2
s_add_u32 s90, s90, s74
s_mul_i32 s91, s90, 2816
s_lshl_b32 s90, s90, 10
v_mov_b32 v68, 2146435072
v_lshl_add_u32 v69, v1, 7, s91
s_mov_b64 vcc, 0x3fffff
s_mov_b64 s[100:101], 0xff
v_lshl_add_u32 v70, v1, 7, s90
v_cndmask_b32_e64 v44, v68, v69, vcc
v_cndmask_b32 v46, v68, v70, s[100:101]
s_add_u32 m0, s87, 16384
s_add_u32 s84, s79, 128
s_and_b32 s84, s84, 0x380
buffer_load_dwordx4 v2, s[28:31], s84 offen lds
buffer_load_dwordx4 v3, s[28:31], s84 offen offset:1024 lds
buffer_load_dwordx4 v4, s[28:31], s84 offen offset:2048 lds
buffer_load_dwordx4 v5, s[28:31], s84 offen offset:3072 lds
s_add_u32 m0, s87, 81920
s_mul_i32 s85, s84, 1536
buffer_load_dwordx4 v6, s[32:35], s85 offen lds
buffer_load_dwordx4 v7, s[32:35], s85 offen offset:1024 lds
buffer_load_dwordx4 v8, s[32:35], s85 offen offset:2048 lds
buffer_load_dwordx4 v9, s[32:35], s85 offen offset:3072 lds
s_waitcnt vmcnt(8)
s_barrier
ds_read_b128 a[0:3], v16 offset:0
ds_read_b128 a[4:7], v16 offset:2048
ds_read_b64_tr_b16 v[80:81], v60 offset:0
ds_read_b64_tr_b16 v[82:83], v60 offset:1024
ds_read_b64_tr_b16 v[84:85], v61 offset:0
ds_read_b64_tr_b16 v[86:87], v61 offset:1024
ds_read_b128 a[8:11], v18 offset:0
ds_read_b128 a[12:15], v18 offset:2048
ds_read_b64_tr_b16 v[88:89], v62 offset:512
ds_read_b64_tr_b16 v[90:91], v62 offset:1536
ds_read_b64_tr_b16 v[92:93], v63 offset:512
ds_read_b64_tr_b16 v[94:95], v63 offset:1536
s_waitcnt lgkmcnt(8)
v_mfma_f32_16x16x32_bf16 v[128:131], v[80:83], a[0:3], 0
ds_read_b128 a[16:19], v17 offset:0
ds_read_b128 a[20:23], v17 offset:2048
s_add_u32 m0, s87, 32768
s_add_u32 s84, s79, 256
s_and_b32 s84, s84, 0x380
v_mfma_f32_16x16x32_bf16 v[132:135], v[80:83], a[4:7], 0
buffer_load_dwordx4 v2, s[28:31], s84 offen lds
s_waitcnt lgkmcnt(8)
v_mfma_f32_16x16x32_bf16 v[136:139], v[84:87], a[0:3], 0
buffer_load_dwordx4 v3, s[28:31], s84 offen offset:1024 lds
v_mfma_f32_16x16x32_bf16 v[140:143], v[84:87], a[4:7], 0
ds_read_b64_tr_b16 v[96:97], v60 offset:8192
ds_read_b64_tr_b16 v[98:99], v60 offset:9216
s_waitcnt lgkmcnt(4)
v_mfma_f32_16x16x32_bf16 v[160:163], a[0:3], v[88:91], 0
buffer_load_dwordx4 v4, s[28:31], s84 offen offset:2048 lds
v_mfma_f32_16x16x32_bf16 v[168:171], a[4:7], v[88:91], 0
ds_read_b64_tr_b16 v[100:101], v61 offset:8192
v_mfma_f32_16x16x32_bf16 v[164:167], a[0:3], v[92:95], 0
buffer_load_dwordx4 v5, s[28:31], s84 offen offset:3072 lds
v_mfma_f32_16x16x32_bf16 v[172:175], a[4:7], v[92:95], 0
ds_read_b64_tr_b16 v[102:103], v61 offset:9216
v_mfma_f32_16x16x32_bf16 v[144:147], v[80:83], a[8:11], 0
ds_read_b128 a[24:27], v19 offset:0
ds_read_b128 a[28:31], v19 offset:2048
s_add_u32 m0, s87, 98304
s_mul_i32 s85, s84, 1536
v_mfma_f32_16x16x32_bf16 v[148:151], v[80:83], a[12:15], 0
buffer_load_dwordx4 v6, s[32:35], s85 offen lds
v_mfma_f32_16x16x32_bf16 v[152:155], v[84:87], a[8:11], 0
buffer_load_dwordx4 v7, s[32:35], s85 offen offset:1024 lds
v_mfma_f32_16x16x32_bf16 v[156:159], v[84:87], a[12:15], 0
ds_read_b64_tr_b16 v[104:105], v62 offset:8704
ds_read_b64_tr_b16 v[106:107], v62 offset:9728
v_mfma_f32_16x16x32_bf16 v[176:179], a[8:11], v[88:91], 0
buffer_load_dwordx4 v8, s[32:35], s85 offen offset:2048 lds
v_mfma_f32_16x16x32_bf16 v[184:187], a[12:15], v[88:91], 0
ds_read_b64_tr_b16 v[108:109], v63 offset:8704
v_mfma_f32_16x16x32_bf16 v[180:183], a[8:11], v[92:95], 0
buffer_load_dwordx4 v9, s[32:35], s85 offen offset:3072 lds
v_mfma_f32_16x16x32_bf16 v[188:191], a[12:15], v[92:95], 0
ds_read_b64_tr_b16 v[110:111], v63 offset:9728
s_waitcnt lgkmcnt(0)
v_mfma_f32_16x16x32_bf16 v[128:131], v[96:99], a[16:19], v[128:131]
s_waitcnt vmcnt(8)
s_barrier
ds_read_b128 a[32:35], v16 offset:16384
ds_read_b128 a[36:39], v16 offset:18432
s_add_u32 m0, s87, 49152
s_add_u32 s84, s79, 384
s_and_b32 s84, s84, 0x380
v_mfma_f32_16x16x32_bf16 v[132:135], v[96:99], a[20:23], v[132:135]
buffer_load_dwordx4 v2, s[28:31], s84 offen lds
v_mfma_f32_16x16x32_bf16 v[136:139], v[100:103], a[16:19], v[136:139]
buffer_load_dwordx4 v3, s[28:31], s84 offen offset:1024 lds
v_mfma_f32_16x16x32_bf16 v[140:143], v[100:103], a[20:23], v[140:143]
ds_read_b64_tr_b16 v[80:81], v60 offset:16384
ds_read_b64_tr_b16 v[82:83], v60 offset:17408
v_mfma_f32_16x16x32_bf16 v[160:163], a[16:19], v[104:107], v[160:163]
buffer_load_dwordx4 v4, s[28:31], s84 offen offset:2048 lds
v_mfma_f32_16x16x32_bf16 v[168:171], a[20:23], v[104:107], v[168:171]
ds_read_b64_tr_b16 v[84:85], v61 offset:16384
v_mfma_f32_16x16x32_bf16 v[164:167], a[16:19], v[108:111], v[164:167]
buffer_load_dwordx4 v5, s[28:31], s84 offen offset:3072 lds
v_mfma_f32_16x16x32_bf16 v[172:175], a[20:23], v[108:111], v[172:175]
ds_read_b64_tr_b16 v[86:87], v61 offset:17408
v_mfma_f32_16x16x32_bf16 v[144:147], v[96:99], a[24:27], v[144:147]
ds_read_b128 a[40:43], v18 offset:16384
ds_read_b128 a[44:47], v18 offset:18432
s_add_u32 m0, s87, 114688
s_mul_i32 s85, s84, 1536
v_mfma_f32_16x16x32_bf16 v[148:151], v[96:99], a[28:31], v[148:151]
buffer_load_dwordx4 v6, s[32:35], s85 offen lds
v_mfma_f32_16x16x32_bf16 v[152:155], v[100:103], a[24:27], v[152:155]
buffer_load_dwordx4 v7, s[32:35], s85 offen offset:1024 lds
v_mfma_f32_16x16x32_bf16 v[156:159], v[100:103], a[28:31], v[156:159]
ds_read_b64_tr_b16 v[88:89], v62 offset:16896
ds_read_b64_tr_b16 v[90:91], v62 offset:17920
v_mfma_f32_16x16x32_bf16 v[176:179], a[24:27], v[104:107], v[176:179]
buffer_load_dwordx4 v8, s[32:35], s85 offen offset:2048 lds
v_mfma_f32_16x16x32_bf16 v[184:187], a[28:31], v[104:107], v[184:187]
ds_read_b64_tr_b16 v[92:93], v63 offset:16896
v_mfma_f32_16x16x32_bf16 v[180:183], a[24:27], v[108:111], v[180:183]
buffer_load_dwordx4 v9, s[32:35], s85 offen offset:3072 lds
v_mfma_f32_16x16x32_bf16 v[188:191], a[28:31], v[108:111], v[188:191]
ds_read_b64_tr_b16 v[94:95], v63 offset:17920
s_waitcnt lgkmcnt(6)
v_mfma_f32_16x16x32_bf16 v[128:131], v[80:83], a[32:35], v[128:131]
ds_read_b128 a[48:51], v17 offset:16384
s_add_u32 m0, s87, 0
v_mfma_f32_16x16x32_bf16 v[132:135], v[80:83], a[36:39], v[132:135]
ds_read_b128 a[52:55], v17 offset:18432
s_add_u32 s84, s79, 512
s_and_b32 s84, s84, 0x380
v_mfma_f32_16x16x32_bf16 v[136:139], v[84:87], a[32:35], v[136:139]
buffer_load_dwordx4 v2, s[28:31], s84 offen lds
v_mfma_f32_16x16x32_bf16 v[140:143], v[84:87], a[36:39], v[140:143]
ds_read_b64_tr_b16 v[96:97], v60 offset:24576
s_waitcnt lgkmcnt(3)
v_mfma_f32_16x16x32_bf16 v[160:163], a[32:35], v[88:91], v[160:163]
ds_read_b64_tr_b16 v[98:99], v60 offset:25600
v_mfma_f32_16x16x32_bf16 v[168:171], a[36:39], v[88:91], v[168:171]
ds_read_b64_tr_b16 v[100:101], v61 offset:24576
v_mfma_f32_16x16x32_bf16 v[164:167], a[32:35], v[92:95], v[164:167]
buffer_load_dwordx4 v3, s[28:31], s84 offen offset:1024 lds
v_mfma_f32_16x16x32_bf16 v[172:175], a[36:39], v[92:95], v[172:175]
ds_read_b64_tr_b16 v[102:103], v61 offset:25600
v_mfma_f32_16x16x32_bf16 v[144:147], v[80:83], a[40:43], v[144:147]
ds_read_b128 a[56:59], v19 offset:16384
v_mfma_f32_16x16x32_bf16 v[148:151], v[80:83], a[44:47], v[148:151]
ds_read_b128 a[60:63], v19 offset:18432
v_mfma_f32_16x16x32_bf16 v[152:155], v[84:87], a[40:43], v[152:155]
ds_read_b64_tr_b16 v[104:105], v62 offset:25088
v_mfma_f32_16x16x32_bf16 v[156:159], v[84:87], a[44:47], v[156:159]
ds_read_b64_tr_b16 v[106:107], v62 offset:26112
v_mfma_f32_16x16x32_bf16 v[176:179], a[40:43], v[88:91], v[176:179]
buffer_load_dwordx4 v4, s[28:31], s84 offen offset:2048 lds
v_mfma_f32_16x16x32_bf16 v[184:187], a[44:47], v[88:91], v[184:187]
ds_read_b64_tr_b16 v[108:109], v63 offset:25088
v_mfma_f32_16x16x32_bf16 v[180:183], a[40:43], v[92:95], v[180:183]
buffer_load_dwordx4 v5, s[28:31], s84 offen offset:3072 lds
v_mfma_f32_16x16x32_bf16 v[188:191], a[44:47], v[92:95], v[188:191]
ds_read_b64_tr_b16 v[110:111], v63 offset:26112
s_waitcnt lgkmcnt(0)
v_mfma_f32_16x16x32_bf16 v[128:131], v[96:99], a[48:51], v[128:131]
s_waitcnt vmcnt(12)
s_barrier
ds_read_b128 a[64:67], v16 offset:32768
v_mfma_f32_16x16x32_bf16 v[132:135], v[96:99], a[52:55], v[132:135]
ds_read_b128 a[68:71], v16 offset:34816
s_add_u32 m0, s87, 65536
s_mul_i32 s85, s84, 1536
v_mfma_f32_16x16x32_bf16 v[136:139], v[100:103], a[48:51], v[136:139]
buffer_load_dwordx4 v6, s[32:35], s85 offen lds
v_mfma_f32_16x16x32_bf16 v[140:143], v[100:103], a[52:55], v[140:143]
ds_read_b64_tr_b16 v[80:81], v60 offset:32768
v_mfma_f32_16x16x32_bf16 v[160:163], a[48:51], v[104:107], v[160:163]
ds_read_b64_tr_b16 v[82:83], v60 offset:33792
v_mfma_f32_16x16x32_bf16 v[168:171], a[52:55], v[104:107], v[168:171]
ds_read_b64_tr_b16 v[84:85], v61 offset:32768
v_mfma_f32_16x16x32_bf16 v[164:167], a[48:51], v[108:111], v[164:167]
buffer_load_dwordx4 v7, s[32:35], s85 offen offset:1024 lds
v_mfma_f32_16x16x32_bf16 v[172:175], a[52:55], v[108:111], v[172:175]
ds_read_b64_tr_b16 v[86:87], v61 offset:33792
v_mfma_f32_16x16x32_bf16 v[144:147], v[96:99], a[56:59], v[144:147]
ds_read_b128 a[72:75], v18 offset:32768
v_mfma_f32_16x16x32_bf16 v[148:151], v[96:99], a[60:63], v[148:151]
ds_read_b128 a[76:79], v18 offset:34816
v_mfma_f32_16x16x32_bf16 v[152:155], v[100:103], a[56:59], v[152:155]
buffer_load_dwordx4 v8, s[32:35], s85 offen offset:2048 lds
v_mfma_f32_16x16x32_bf16 v[156:159], v[100:103], a[60:63], v[156:159]
ds_read_b64_tr_b16 v[88:89], v62 offset:33280
v_mfma_f32_16x16x32_bf16 v[176:179], a[56:59], v[104:107], v[176:179]
ds_read_b64_tr_b16 v[90:91], v62 offset:34304
v_mfma_f32_16x16x32_bf16 v[184:187], a[60:63], v[104:107], v[184:187]
ds_read_b64_tr_b16 v[92:93], v63 offset:33280
v_mfma_f32_16x16x32_bf16 v[180:183], a[56:59], v[108:111], v[180:183]
buffer_load_dwordx4 v9, s[32:35], s85 offen offset:3072 lds
v_mfma_f32_16x16x32_bf16 v[188:191], a[60:63], v[108:111], v[188:191]
ds_read_b64_tr_b16 v[94:95], v63 offset:34304
s_waitcnt lgkmcnt(6)
v_mfma_f32_16x16x32_bf16 v[128:131], v[80:83], a[64:67], v[128:131]
ds_read_b128 a[80:83], v17 offset:32768
s_add_u32 m0, s87, 16384
v_mfma_f32_16x16x32_bf16 v[132:135], v[80:83], a[68:71], v[132:135]
ds_read_b128 a[84:87], v17 offset:34816
s_add_u32 s84, s79, 640
s_and_b32 s84, s84, 0x380
v_mfma_f32_16x16x32_bf16 v[136:139], v[84:87], a[64:67], v[136:139]
buffer_load_dwordx4 v2, s[28:31], s84 offen lds
v_mfma_f32_16x16x32_bf16 v[140:143], v[84:87], a[68:71], v[140:143]
ds_read_b64_tr_b16 v[96:97], v60 offset:40960
s_waitcnt lgkmcnt(3)
v_mfma_f32_16x16x32_bf16 v[160:163], a[64:67], v[88:91], v[160:163]
ds_read_b64_tr_b16 v[98:99], v60 offset:41984
v_mfma_f32_16x16x32_bf16 v[168:171], a[68:71], v[88:91], v[168:171]
ds_read_b64_tr_b16 v[100:101], v61 offset:40960
v_mfma_f32_16x16x32_bf16 v[164:167], a[64:67], v[92:95], v[164:167]
buffer_load_dwordx4 v3, s[28:31], s84 offen offset:1024 lds
v_mfma_f32_16x16x32_bf16 v[172:175], a[68:71], v[92:95], v[172:175]
ds_read_b64_tr_b16 v[102:103], v61 offset:41984
v_mfma_f32_16x16x32_bf16 v[144:147], v[80:83], a[72:75], v[144:147]
ds_read_b128 a[88:91], v19 offset:32768
v_mfma_f32_16x16x32_bf16 v[148:151], v[80:83], a[76:79], v[148:151]
ds_read_b128 a[92:95], v19 offset:34816
v_mfma_f32_16x16x32_bf16 v[152:155], v[84:87], a[72:75], v[152:155]
ds_read_b64_tr_b16 v[104:105], v62 offset:41472
v_mfma_f32_16x16x32_bf16 v[156:159], v[84:87], a[76:79], v[156:159]
ds_read_b64_tr_b16 v[106:107], v62 offset:42496
v_mfma_f32_16x16x32_bf16 v[176:179], a[72:75], v[88:91], v[176:179]
buffer_load_dwordx4 v4, s[28:31], s84 offen offset:2048 lds
v_mfma_f32_16x16x32_bf16 v[184:187], a[76:79], v[88:91], v[184:187]
ds_read_b64_tr_b16 v[108:109], v63 offset:41472
v_mfma_f32_16x16x32_bf16 v[180:183], a[72:75], v[92:95], v[180:183]
buffer_load_dwordx4 v5, s[28:31], s84 offen offset:3072 lds
v_mfma_f32_16x16x32_bf16 v[188:191], a[76:79], v[92:95], v[188:191]
ds_read_b64_tr_b16 v[110:111], v63 offset:42496
s_waitcnt lgkmcnt(0)
v_mfma_f32_16x16x32_bf16 v[128:131], v[96:99], a[80:83], v[128:131]
s_waitcnt vmcnt(12)
s_barrier
ds_read_b128 a[96:99], v16 offset:49152
v_mfma_f32_16x16x32_bf16 v[132:135], v[96:99], a[84:87], v[132:135]
ds_read_b128 a[100:103], v16 offset:51200
s_add_u32 m0, s87, 81920
s_mul_i32 s85, s84, 1536
v_mfma_f32_16x16x32_bf16 v[136:139], v[100:103], a[80:83], v[136:139]
buffer_load_dwordx4 v6, s[32:35], s85 offen lds
v_mfma_f32_16x16x32_bf16 v[140:143], v[100:103], a[84:87], v[140:143]
ds_read_b64_tr_b16 v[80:81], v60 offset:49152
v_mfma_f32_16x16x32_bf16 v[160:163], a[80:83], v[104:107], v[160:163]
ds_read_b64_tr_b16 v[82:83], v60 offset:50176
v_mfma_f32_16x16x32_bf16 v[168:171], a[84:87], v[104:107], v[168:171]
ds_read_b64_tr_b16 v[84:85], v61 offset:49152
v_mfma_f32_16x16x32_bf16 v[164:167], a[80:83], v[108:111], v[164:167]
buffer_load_dwordx4 v7, s[32:35], s85 offen offset:1024 lds
v_mfma_f32_16x16x32_bf16 v[172:175], a[84:87], v[108:111], v[172:175]
ds_read_b64_tr_b16 v[86:87], v61 offset:50176
v_mfma_f32_16x16x32_bf16 v[144:147], v[96:99], a[88:91], v[144:147]
ds_read_b128 a[104:107], v18 offset:49152
v_mfma_f32_16x16x32_bf16 v[148:151], v[96:99], a[92:95], v[148:151]
ds_read_b128 a[108:111], v18 offset:51200
v_mfma_f32_16x16x32_bf16 v[152:155], v[100:103], a[88:91], v[152:155]
buffer_load_dwordx4 v8, s[32:35], s85 offen offset:2048 lds
v_mfma_f32_16x16x32_bf16 v[156:159], v[100:103], a[92:95], v[156:159]
ds_read_b64_tr_b16 v[88:89], v62 offset:49664
v_mfma_f32_16x16x32_bf16 v[176:179], a[88:91], v[104:107], v[176:179]
ds_read_b64_tr_b16 v[90:91], v62 offset:50688
v_mfma_f32_16x16x32_bf16 v[184:187], a[92:95], v[104:107], v[184:187]
ds_read_b64_tr_b16 v[92:93], v63 offset:49664
v_mfma_f32_16x16x32_bf16 v[180:183], a[88:91], v[108:111], v[180:183]
buffer_load_dwordx4 v9, s[32:35], s85 offen offset:3072 lds
v_mfma_f32_16x16x32_bf16 v[188:191], a[92:95], v[108:111], v[188:191]
ds_read_b64_tr_b16 v[94:95], v63 offset:50688
s_waitcnt lgkmcnt(6)
v_mfma_f32_16x16x32_bf16 v[128:131], v[80:83], a[96:99], v[128:131]
ds_read_b128 a[112:115], v17 offset:49152
s_lshl_b32 s85, s73, 1
v_mfma_f32_16x16x32_bf16 v[132:135], v[80:83], a[100:103], v[132:135]
ds_read_b128 a[116:119], v17 offset:51200
s_add_u32 s85, s85, s76
s_lshr_b32 s86, s87, 2
s_add_u32 m0, s86, 147456
s_lshl_b32 s85, s85, 10
v_mfma_f32_16x16x32_bf16 v[136:139], v[84:87], a[96:99], v[136:139]
buffer_load_dwordx4 v38, s[60:63], s85 offen lds
v_mfma_f32_16x16x32_bf16 v[140:143], v[84:87], a[100:103], v[140:143]
ds_read_b64_tr_b16 v[96:97], v60 offset:57344
s_waitcnt lgkmcnt(3)
v_mfma_f32_16x16x32_bf16 v[160:163], a[96:99], v[88:91], v[160:163]
ds_read_b64_tr_b16 v[98:99], v60 offset:58368
s_add_u32 m0, s87, 32768
v_mfma_f32_16x16x32_bf16 v[168:171], a[100:103], v[88:91], v[168:171]
ds_read_b64_tr_b16 v[100:101], v61 offset:57344
s_add_u32 s84, s79, 768
s_and_b32 s84, s84, 0x380
v_mfma_f32_16x16x32_bf16 v[164:167], a[96:99], v[92:95], v[164:167]
buffer_load_dwordx4 v2, s[28:31], s84 offen lds
v_mfma_f32_16x16x32_bf16 v[172:175], a[100:103], v[92:95], v[172:175]
ds_read_b64_tr_b16 v[102:103], v61 offset:58368
v_mfma_f32_16x16x32_bf16 v[144:147], v[80:83], a[104:107], v[144:147]
ds_read_b128 a[120:123], v19 offset:49152
v_mfma_f32_16x16x32_bf16 v[148:151], v[80:83], a[108:111], v[148:151]
ds_read_b128 a[124:127], v19 offset:51200
v_mfma_f32_16x16x32_bf16 v[152:155], v[84:87], a[104:107], v[152:155]
ds_read_b64_tr_b16 v[104:105], v62 offset:57856
v_mfma_f32_16x16x32_bf16 v[156:159], v[84:87], a[108:111], v[156:159]
ds_read_b64_tr_b16 v[106:107], v62 offset:58880
v_mfma_f32_16x16x32_bf16 v[176:179], a[104:107], v[88:91], v[176:179]
buffer_load_dwordx4 v3, s[28:31], s84 offen offset:1024 lds
v_mfma_f32_16x16x32_bf16 v[184:187], a[108:111], v[88:91], v[184:187]
ds_read_b64_tr_b16 v[108:109], v63 offset:57856
v_mfma_f32_16x16x32_bf16 v[180:183], a[104:107], v[92:95], v[180:183]
buffer_load_dwordx4 v4, s[28:31], s84 offen offset:2048 lds
v_mfma_f32_16x16x32_bf16 v[188:191], a[108:111], v[92:95], v[188:191]
ds_read_b64_tr_b16 v[110:111], v63 offset:58880
s_waitcnt lgkmcnt(0)
v_mfma_f32_16x16x32_bf16 v[128:131], v[96:99], a[112:115], v[128:131]
s_waitcnt vmcnt(12)
s_barrier
ds_read_b128 a[128:131], v16 offset:0
v_mfma_f32_16x16x32_bf16 v[132:135], v[96:99], a[116:119], v[132:135]
ds_read_b128 a[132:135], v16 offset:2048
L_pad_KH_1:
s_cbranch_execz L_pad_KH_2
s_nop 0
v_mfma_f32_16x16x32_bf16 v[136:139], v[100:103], a[112:115], v[136:139]
buffer_load_dwordx4 v5, s[28:31], s84 offen offset:3072 lds
v_mfma_f32_16x16x32_bf16 v[140:143], v[100:103], a[116:119], v[140:143]
ds_read_b64_tr_b16 v[80:81], v60 offset:0
s_add_u32 m0, s87, 98304
v_mfma_f32_16x16x32_bf16 v[160:163], a[112:115], v[104:107], v[160:163]
ds_read_b64_tr_b16 v[82:83], v60 offset:1024
s_mul_i32 s85, s84, 1536
v_mfma_f32_16x16x32_bf16 v[168:171], a[116:119], v[104:107], v[168:171]
ds_read_b64_tr_b16 v[84:85], v61 offset:0
v_mfma_f32_16x16x32_bf16 v[164:167], a[112:115], v[108:111], v[164:167]
buffer_load_dwordx4 v6, s[32:35], s85 offen lds
v_mfma_f32_16x16x32_bf16 v[172:175], a[116:119], v[108:111], v[172:175]
ds_read_b64_tr_b16 v[86:87], v61 offset:1024
v_mfma_f32_16x16x32_bf16 v[144:147], v[96:99], a[120:123], v[144:147]
ds_read_b128 a[136:139], v18 offset:0
v_mfma_f32_16x16x32_bf16 v[148:151], v[96:99], a[124:127], v[148:151]
ds_read_b128 a[140:143], v18 offset:2048
v_mfma_f32_16x16x32_bf16 v[152:155], v[100:103], a[120:123], v[152:155]
buffer_load_dwordx4 v7, s[32:35], s85 offen offset:1024 lds
v_mfma_f32_16x16x32_bf16 v[156:159], v[100:103], a[124:127], v[156:159]
ds_read_b64_tr_b16 v[88:89], v62 offset:512
v_mfma_f32_16x16x32_bf16 v[176:179], a[120:123], v[104:107], v[176:179]
ds_read_b64_tr_b16 v[90:91], v62 offset:1536
v_mfma_f32_16x16x32_bf16 v[184:187], a[124:127], v[104:107], v[184:187]
ds_read_b64_tr_b16 v[92:93], v63 offset:512
v_mfma_f32_16x16x32_bf16 v[180:183], a[120:123], v[108:111], v[180:183]
buffer_load_dwordx4 v8, s[32:35], s85 offen offset:2048 lds
v_mfma_f32_16x16x32_bf16 v[188:191], a[124:127], v[108:111], v[188:191]
ds_read_b64_tr_b16 v[94:95], v63 offset:1536
s_waitcnt lgkmcnt(6)
v_mfma_f32_16x16x32_bf16 v[128:131], v[80:83], a[128:131], v[128:131]
ds_read_b128 a[144:147], v17 offset:0
v_mfma_f32_16x16x32_bf16 v[132:135], v[80:83], a[132:135], v[132:135]
ds_read_b128 a[148:151], v17 offset:2048
v_mfma_f32_16x16x32_bf16 v[136:139], v[84:87], a[128:131], v[136:139]
buffer_load_dwordx4 v9, s[32:35], s85 offen offset:3072 lds
v_mfma_f32_16x16x32_bf16 v[140:143], v[84:87], a[132:135], v[140:143]
ds_read_b64_tr_b16 v[96:97], v60 offset:8192
s_waitcnt lgkmcnt(3)
v_mfma_f32_16x16x32_bf16 v[160:163], a[128:131], v[88:91], v[160:163]
ds_read_b64_tr_b16 v[98:99], v60 offset:9216
s_add_u32 m0, s87, 49152
v_mfma_f32_16x16x32_bf16 v[168:171], a[132:135], v[88:91], v[168:171]
ds_read_b64_tr_b16 v[100:101], v61 offset:8192
s_add_u32 s84, s79, 896
s_and_b32 s84, s84, 0x380
v_mfma_f32_16x16x32_bf16 v[164:167], a[128:131], v[92:95], v[164:167]
buffer_load_dwordx4 v2, s[28:31], s84 offen lds
v_mfma_f32_16x16x32_bf16 v[172:175], a[132:135], v[92:95], v[172:175]
ds_read_b64_tr_b16 v[102:103], v61 offset:9216
v_mfma_f32_16x16x32_bf16 v[144:147], v[80:83], a[136:139], v[144:147]
ds_read_b128 a[152:155], v19 offset:0
v_mfma_f32_16x16x32_bf16 v[148:151], v[80:83], a[140:143], v[148:151]
ds_read_b128 a[156:159], v19 offset:2048
v_mfma_f32_16x16x32_bf16 v[152:155], v[84:87], a[136:139], v[152:155]
ds_read_b64_tr_b16 v[104:105], v62 offset:8704
v_mfma_f32_16x16x32_bf16 v[156:159], v[84:87], a[140:143], v[156:159]
ds_read_b64_tr_b16 v[106:107], v62 offset:9728
v_mfma_f32_16x16x32_bf16 v[176:179], a[136:139], v[88:91], v[176:179]
buffer_load_dwordx4 v3, s[28:31], s84 offen offset:1024 lds
v_mfma_f32_16x16x32_bf16 v[184:187], a[140:143], v[88:91], v[184:187]
ds_read_b64_tr_b16 v[108:109], v63 offset:8704
v_mfma_f32_16x16x32_bf16 v[180:183], a[136:139], v[92:95], v[180:183]
buffer_load_dwordx4 v4, s[28:31], s84 offen offset:2048 lds
v_mfma_f32_16x16x32_bf16 v[188:191], a[140:143], v[92:95], v[188:191]
ds_read_b64_tr_b16 v[110:111], v63 offset:9728
s_waitcnt lgkmcnt(0)
v_mfma_f32_16x16x32_bf16 v[128:131], v[96:99], a[144:147], v[128:131]
s_waitcnt vmcnt(12)
s_barrier
ds_read_b128 a[160:163], v16 offset:16384
v_mfma_f32_16x16x32_bf16 v[132:135], v[96:99], a[148:151], v[132:135]
ds_read_b128 a[164:167], v16 offset:18432
v_mfma_f32_16x16x32_bf16 v[136:139], v[100:103], a[144:147], v[136:139]
buffer_load_dwordx4 v5, s[28:31], s84 offen offset:3072 lds
v_mfma_f32_16x16x32_bf16 v[140:143], v[100:103], a[148:151], v[140:143]
ds_read_b64_tr_b16 v[80:81], v60 offset:16384
s_add_u32 m0, s87, 114688
v_mfma_f32_16x16x32_bf16 v[160:163], a[144:147], v[104:107], v[160:163]
ds_read_b64_tr_b16 v[82:83], v60 offset:17408
s_mul_i32 s85, s84, 1536
v_mfma_f32_16x16x32_bf16 v[168:171], a[148:151], v[104:107], v[168:171]
ds_read_b64_tr_b16 v[84:85], v61 offset:16384
v_mfma_f32_16x16x32_bf16 v[164:167], a[144:147], v[108:111], v[164:167]
buffer_load_dwordx4 v6, s[32:35], s85 offen lds
v_mfma_f32_16x16x32_bf16 v[172:175], a[148:151], v[108:111], v[172:175]
ds_read_b64_tr_b16 v[86:87], v61 offset:17408
v_mfma_f32_16x16x32_bf16 v[144:147], v[96:99], a[152:155], v[144:147]
ds_read_b128 a[168:171], v18 offset:16384
v_mfma_f32_16x16x32_bf16 v[148:151], v[96:99], a[156:159], v[148:151]
ds_read_b128 a[172:175], v18 offset:18432
v_mfma_f32_16x16x32_bf16 v[152:155], v[100:103], a[152:155], v[152:155]
buffer_load_dwordx4 v7, s[32:35], s85 offen offset:1024 lds
v_mfma_f32_16x16x32_bf16 v[156:159], v[100:103], a[156:159], v[156:159]
ds_read_b64_tr_b16 v[88:89], v62 offset:16896
v_mfma_f32_16x16x32_bf16 v[176:179], a[152:155], v[104:107], v[176:179]
ds_read_b64_tr_b16 v[90:91], v62 offset:17920
v_mfma_f32_16x16x32_bf16 v[184:187], a[156:159], v[104:107], v[184:187]
ds_read_b64_tr_b16 v[92:93], v63 offset:16896
v_mfma_f32_16x16x32_bf16 v[180:183], a[152:155], v[108:111], v[180:183]
buffer_load_dwordx4 v8, s[32:35], s85 offen offset:2048 lds
v_mfma_f32_16x16x32_bf16 v[188:191], a[156:159], v[108:111], v[188:191]
ds_read_b64_tr_b16 v[94:95], v63 offset:17920
s_waitcnt lgkmcnt(6)
v_mfma_f32_16x16x32_bf16 v[128:131], v[80:83], a[160:163], v[128:131]
ds_read_b128 a[176:179], v17 offset:16384
v_mfma_f32_16x16x32_bf16 v[132:135], v[80:83], a[164:167], v[132:135]
ds_read_b128 a[180:183], v17 offset:18432
v_mfma_f32_16x16x32_bf16 v[136:139], v[84:87], a[160:163], v[136:139]
buffer_load_dwordx4 v9, s[32:35], s85 offen offset:3072 lds
v_mfma_f32_16x16x32_bf16 v[140:143], v[84:87], a[164:167], v[140:143]
ds_read_b64_tr_b16 v[96:97], v60 offset:24576
s_waitcnt lgkmcnt(3)
v_mfma_f32_16x16x32_bf16 v[160:163], a[160:163], v[88:91], v[160:163]
ds_read_b64_tr_b16 v[98:99], v60 offset:25600
v_mfma_f32_16x16x32_bf16 v[168:171], a[164:167], v[88:91], v[168:171]
ds_read_b64_tr_b16 v[100:101], v61 offset:24576
v_mfma_f32_16x16x32_bf16 v[164:167], a[160:163], v[92:95], v[164:167]
buffer_load_dword v46, v46, s[44:47], 0 offen
v_mfma_f32_16x16x32_bf16 v[172:175], a[164:167], v[92:95], v[172:175]
ds_read_b64_tr_b16 v[102:103], v61 offset:25600
v_mfma_f32_16x16x32_bf16 v[144:147], v[80:83], a[168:171], v[144:147]
ds_read_b128 a[184:187], v19 offset:16384
v_mfma_f32_16x16x32_bf16 v[148:151], v[80:83], a[172:175], v[148:151]
ds_read_b128 a[188:191], v19 offset:18432
v_mfma_f32_16x16x32_bf16 v[152:155], v[84:87], a[168:171], v[152:155]
ds_read_b64_tr_b16 v[104:105], v62 offset:25088
v_mfma_f32_16x16x32_bf16 v[156:159], v[84:87], a[172:175], v[156:159]
ds_read_b64_tr_b16 v[106:107], v62 offset:26112
v_mfma_f32_16x16x32_bf16 v[176:179], a[168:171], v[88:91], v[176:179]
buffer_load_dword v44, v44, s[48:51], 0 offen
v_mfma_f32_16x16x32_bf16 v[184:187], a[172:175], v[88:91], v[184:187]
ds_read_b64_tr_b16 v[108:109], v63 offset:25088
s_add_u32 m0, s87, 131072
s_add_u32 s85, s13, 0
v_mfma_f32_16x16x32_bf16 v[180:183], a[168:171], v[92:95], v[180:183]
buffer_load_dwordx4 v32, s[44:47], s85 offen lds
v_mfma_f32_16x16x32_bf16 v[188:191], a[172:175], v[92:95], v[188:191]
ds_read_b64_tr_b16 v[110:111], v63 offset:26112
s_waitcnt lgkmcnt(0)
v_mfma_f32_16x16x32_bf16 v[128:131], v[96:99], a[176:179], v[128:131]
s_waitcnt vmcnt(11)
s_barrier
ds_read_b128 a[192:195], v16 offset:32768
v_mfma_f32_16x16x32_bf16 v[132:135], v[96:99], a[180:183], v[132:135]
ds_read_b128 a[196:199], v16 offset:34816
v_mfma_f32_16x16x32_bf16 v[136:139], v[100:103], a[176:179], v[136:139]
buffer_load_dwordx4 v33, s[44:47], s85 offen offset:1024 lds
v_mfma_f32_16x16x32_bf16 v[140:143], v[100:103], a[180:183], v[140:143]
ds_read_b64_tr_b16 v[80:81], v60 offset:32768
v_mfma_f32_16x16x32_bf16 v[160:163], a[176:179], v[104:107], v[160:163]
ds_read_b64_tr_b16 v[82:83], v60 offset:33792
v_mfma_f32_16x16x32_bf16 v[168:171], a[180:183], v[104:107], v[168:171]
ds_read_b64_tr_b16 v[84:85], v61 offset:32768
v_mfma_f32_16x16x32_bf16 v[164:167], a[176:179], v[108:111], v[164:167]
buffer_load_dwordx4 v34, s[44:47], s85 offen offset:2048 lds
v_mfma_f32_16x16x32_bf16 v[172:175], a[180:183], v[108:111], v[172:175]
ds_read_b64_tr_b16 v[86:87], v61 offset:33792
v_lshrrev_b32 v68, 5, v1
v_bfe_u32 v69, v1, 2, 2
v_lshl_add_u32 v68, v68, 2, v69
v_lshlrev_b32 v68, 5, v68
v_and_b32 v69, 3, v1
v_mfma_f32_16x16x32_bf16 v[144:147], v[96:99], a[184:187], v[144:147]
ds_read_b128 a[200:203], v18 offset:32768
v_mfma_f32_16x16x32_bf16 v[148:151], v[96:99], a[188:191], v[148:151]
ds_read_b128 a[204:207], v18 offset:34816
v_mfma_f32_16x16x32_bf16 v[152:155], v[100:103], a[184:187], v[152:155]
buffer_load_dwordx4 v35, s[44:47], s85 offen offset:3072 lds
v_mfma_f32_16x16x32_bf16 v[156:159], v[100:103], a[188:191], v[156:159]
ds_read_b64_tr_b16 v[88:89], v62 offset:33280
s_add_u32 s83, s79, 0
v_mfma_f32_16x16x32_bf16 v[176:179], a[184:187], v[104:107], v[176:179]
ds_read_b64_tr_b16 v[90:91], v62 offset:34304
s_and_b32 s83, s83, 0x380
v_mfma_f32_16x16x32_bf16 v[184:187], a[188:191], v[104:107], v[184:187]
ds_read_b64_tr_b16 v[92:93], v63 offset:33280
s_add_u32 m0, s89, 0
s_mul_i32 s86, s83, 1376
v_mfma_f32_16x16x32_bf16 v[180:183], a[184:187], v[108:111], v[180:183]
buffer_load_dwordx4 v10, s[36:39], s86 offen lds
v_mfma_f32_16x16x32_bf16 v[188:191], a[188:191], v[108:111], v[188:191]
ds_read_b64_tr_b16 v[94:95], v63 offset:34304
v_lshl_add_u32 v68, v69, 3, v68
v_bfe_u32 v69, v1, 4, 1
v_lshl_add_u32 v68, v69, 9, v68
s_lshr_b32 s91, s87, 2
s_add_u32 s91, s91, 147456
s_waitcnt lgkmcnt(6)
v_mfma_f32_16x16x32_bf16 v[128:131], v[80:83], a[192:195], v[128:131]
ds_read_b128 a[208:211], v17 offset:32768
v_add_u32_e64 v68, s91, v68
v_mfma_f32_16x16x32_bf16 v[132:135], v[80:83], a[196:199], v[132:135]
ds_read_b128 a[212:215], v17 offset:34816
v_mfma_f32_16x16x32_bf16 v[136:139], v[84:87], a[192:195], v[136:139]
ds_read_b64_tr_b16 v[96:97], v60 offset:40960
v_mfma_f32_16x16x32_bf16 v[140:143], v[84:87], a[196:199], v[140:143]
ds_read_b64_tr_b16 v[98:99], v60 offset:41984
s_waitcnt lgkmcnt(4)
v_mfma_f32_16x16x32_bf16 v[160:163], a[192:195], v[88:91], v[160:163]
ds_read_b64_tr_b16 v[100:101], v61 offset:40960
v_mfma_f32_16x16x32_bf16 v[168:171], a[196:199], v[88:91], v[168:171]
ds_read_b64_tr_b16 v[102:103], v61 offset:41984
v_mfma_f32_16x16x32_bf16 v[164:167], a[192:195], v[92:95], v[164:167]
ds_read_b64_tr_b16 v[64:65], v68
v_mfma_f32_16x16x32_bf16 v[172:175], a[196:199], v[92:95], v[172:175]
ds_read_b64_tr_b16 v[66:67], v68 offset:256
s_lshl_b32 s93, s73, 2
v_mfma_f32_16x16x32_bf16 v[144:147], v[80:83], a[200:203], v[144:147]
ds_read_b128 a[216:219], v19 offset:32768
s_add_u32 s93, s93, s74
v_mfma_f32_16x16x32_bf16 v[148:151], v[80:83], a[204:207], v[148:151]
ds_read_b128 a[220:223], v19 offset:34816
s_lshl_b32 s84, s93, 4
v_mfma_f32_16x16x32_bf16 v[152:155], v[84:87], a[200:203], v[152:155]
ds_read_b64_tr_b16 v[104:105], v62 offset:41472
s_add_u32 s84, s84, s72
v_mfma_f32_16x16x32_bf16 v[156:159], v[84:87], a[204:207], v[156:159]
ds_read_b64_tr_b16 v[106:107], v62 offset:42496
s_lshr_b32 s80, s93, 1
v_mfma_f32_16x16x32_bf16 v[176:179], a[200:203], v[88:91], v[176:179]
ds_read_b64_tr_b16 v[108:109], v63 offset:41472
s_lshl_b32 s80, s80, 4
v_mfma_f32_16x16x32_bf16 v[184:187], a[204:207], v[88:91], v[184:187]
ds_read_b64_tr_b16 v[110:111], v63 offset:42496
v_mfma_f32_16x16x32_bf16 v[180:183], a[200:203], v[92:95], v[180:183]
v_mfma_f32_16x16x32_bf16 v[188:191], a[204:207], v[92:95], v[188:191]
s_waitcnt lgkmcnt(0)
v_mfma_f32_16x16x32_bf16 v[128:131], v[96:99], a[208:211], v[128:131]
s_waitcnt vmcnt(7)
s_barrier
ds_read_b128 a[224:227], v16 offset:49152
v_mfma_f32_16x16x32_bf16 v[132:135], v[96:99], a[212:215], v[132:135]
ds_read_b128 a[228:231], v16 offset:51200
s_add_u32 s80, s80, s72
v_mfma_f32_16x16x32_bf16 v[136:139], v[100:103], a[208:211], v[136:139]
ds_read_b64_tr_b16 v[80:81], v60 offset:49152
s_lshl_b32 s80, s80, 10
v_mfma_f32_16x16x32_bf16 v[140:143], v[100:103], a[212:215], v[140:143]
ds_read_b64_tr_b16 v[82:83], v60 offset:50176
s_add_u32 s80, s80, 8781824
v_mfma_f32_16x16x32_bf16 v[160:163], a[208:211], v[104:107], v[160:163]
ds_read_b64_tr_b16 v[84:85], v61 offset:49152
s_lshl_b32 s84, s84, 10
v_mfma_f32_16x16x32_bf16 v[168:171], a[212:215], v[104:107], v[168:171]
ds_read_b64_tr_b16 v[86:87], v61 offset:50176
s_add_u32 s84, s84, 7864320
v_mfma_f32_16x16x32_bf16 v[164:167], a[208:211], v[108:111], v[164:167]
v_mfma_f32_16x16x32_bf16 v[172:175], a[212:215], v[108:111], v[172:175]
v_mfma_f32_16x16x32_bf16 v[144:147], v[96:99], a[216:219], v[144:147]
ds_read_b128 a[232:235], v18 offset:49152
s_sub_u32 s100, 0, s75
v_mfma_f32_16x16x32_bf16 v[148:151], v[96:99], a[220:223], v[148:151]
ds_read_b128 a[236:239], v18 offset:51200
s_mov_b32 s101, s100
v_mfma_f32_16x16x32_bf16 v[152:155], v[100:103], a[216:219], v[152:155]
ds_read_b64_tr_b16 v[88:89], v62 offset:49664
s_lshr_b32 s90, s87, 1
v_mfma_f32_16x16x32_bf16 v[156:159], v[100:103], a[220:223], v[156:159]
ds_read_b64_tr_b16 v[90:91], v62 offset:50688
s_add_u32 s90, s90, 151552
v_mfma_f32_16x16x32_bf16 v[176:179], a[216:219], v[104:107], v[176:179]
ds_read_b64_tr_b16 v[92:93], v63 offset:49664
v_add_u32_e64 v2, s90, v38
v_mfma_f32_16x16x32_bf16 v[184:187], a[220:223], v[104:107], v[184:187]
ds_read_b64_tr_b16 v[94:95], v63 offset:50688
v_mfma_f32_16x16x32_bf16 v[180:183], a[216:219], v[108:111], v[180:183]
v_mfma_f32_16x16x32_bf16 v[188:191], a[220:223], v[108:111], v[188:191]
s_waitcnt lgkmcnt(6)
v_mfma_f32_16x16x32_bf16 v[128:131], v[80:83], a[224:227], v[128:131]
ds_read_b128 a[240:243], v17 offset:49152
v_xor_b32 v3, 0x800, v2
v_mfma_f32_16x16x32_bf16 v[132:135], v[80:83], a[228:231], v[132:135]
ds_read_b128 a[244:247], v17 offset:51200
s_lshl_b32 s91, s74, 8
v_mfma_f32_16x16x32_bf16 v[136:139], v[84:87], a[224:227], v[136:139]
ds_read_b64_tr_b16 v[96:97], v60 offset:57344
s_add_u32 s91, s91, 147456
v_mfma_f32_16x16x32_bf16 v[140:143], v[84:87], a[228:231], v[140:143]
ds_read_b64_tr_b16 v[98:99], v60 offset:58368
s_waitcnt lgkmcnt(4)
v_mfma_f32_16x16x32_bf16 v[160:163], a[224:227], v[88:91], v[160:163]
ds_read_b64_tr_b16 v[100:101], v61 offset:57344
v_lshl_add_u32 v4, v1, 2, s91
v_mfma_f32_16x16x32_bf16 v[168:171], a[228:231], v[88:91], v[168:171]
ds_read_b64_tr_b16 v[102:103], v61 offset:58368
s_and_b32 s91, s91, 0xfffffeff
v_mfma_f32_16x16x32_bf16 v[164:167], a[224:227], v[92:95], v[164:167]
v_mfma_f32_16x16x32_bf16 v[172:175], a[228:231], v[92:95], v[172:175]
v_mfma_f32_16x16x32_bf16 v[144:147], v[80:83], a[232:235], v[144:147]
ds_read_b128 a[248:251], v19 offset:49152
v_and_b32 v5, 31, v1
v_mfma_f32_16x16x32_bf16 v[148:151], v[80:83], a[236:239], v[148:151]
ds_read_b128 a[252:255], v19 offset:51200
v_lshl_add_u32 v5, v5, 3, s91
v_mfma_f32_16x16x32_bf16 v[152:155], v[84:87], a[232:235], v[152:155]
ds_read_b64_tr_b16 v[104:105], v62 offset:57856
v_lshrrev_b32_e64 v6, 5, v1
v_mfma_f32_16x16x32_bf16 v[156:159], v[84:87], a[236:239], v[156:159]
ds_read_b64_tr_b16 v[106:107], v62 offset:58880
v_or_b32_e64 v6, s75, v6
v_mfma_f32_16x16x32_bf16 v[176:179], a[232:235], v[88:91], v[176:179]
ds_read_b64_tr_b16 v[108:109], v63 offset:57856
v_lshlrev_b32_e64 v6, 30, v6
v_mfma_f32_16x16x32_bf16 v[184:187], a[236:239], v[88:91], v[184:187]
ds_read_b64_tr_b16 v[110:111], v63 offset:58880
v_mfma_f32_16x16x32_bf16 v[180:183], a[232:235], v[92:95], v[180:183]
v_mfma_f32_16x16x32_bf16 v[188:191], a[236:239], v[92:95], v[188:191]
s_waitcnt lgkmcnt(0)
v_mfma_f32_16x16x32_bf16 v[128:131], v[96:99], a[240:243], v[128:131]
s_barrier
v_lshl_add_u32 v6, v1, 2, v6
v_mfma_f32_16x16x32_bf16 v[132:135], v[96:99], a[244:247], v[132:135]
v_lshrrev_b32 v7, 1, v1
v_xor_b32 v7, v7, v1
v_mfma_f32_16x16x32_bf16 v[136:139], v[100:103], a[240:243], v[136:139]
v_and_b32 v7, 2, v7
v_mul_u32_u24 v7, 12, v7
v_mfma_f32_16x16x32_bf16 v[140:143], v[100:103], a[244:247], v[140:143]
v_mfma_f32_16x16x32_bf16 v[160:163], a[240:243], v[104:107], v[160:163]
v_mfma_f32_16x16x32_bf16 v[168:171], a[244:247], v[104:107], v[168:171]
v_mfma_f32_16x16x32_bf16 v[164:167], a[240:243], v[108:111], v[164:167]
v_mfma_f32_16x16x32_bf16 v[172:175], a[244:247], v[108:111], v[172:175]
v_mfma_f32_16x16x32_bf16 v[144:147], v[96:99], a[248:251], v[144:147]
v_xor_b32_e64 v6, v6, v7
v_mfma_f32_16x16x32_bf16 v[148:151], v[96:99], a[252:255], v[148:151]
v_mfma_f32_16x16x32_bf16 v[152:155], v[100:103], a[248:251], v[152:155]
v_mfma_f32_16x16x32_bf16 v[156:159], v[100:103], a[252:255], v[156:159]
v_mfma_f32_16x16x32_bf16 v[176:179], a[248:251], v[104:107], v[176:179]
v_mfma_f32_16x16x32_bf16 v[184:187], a[252:255], v[104:107], v[184:187]
v_mfma_f32_16x16x32_bf16 v[180:183], a[248:251], v[108:111], v[180:183]
v_mfma_f32_16x16x32_bf16 v[188:191], a[252:255], v[108:111], v[188:191]
v_cvt_pk_bf16_f32 v80, v128, v129
v_cvt_pk_bf16_f32 v83, v134, v135
v_cvt_pk_bf16_f32 v86, v140, v141
v_cvt_pk_bf16_f32 v87, v142, v143
v_cvt_pk_bf16_f32 v82, v132, v133
v_cvt_pk_bf16_f32 v84, v136, v137
v_cvt_pk_bf16_f32 v85, v138, v139
v_cvt_pk_bf16_f32 v81, v130, v131
v_permlane16_swap_b32 v84, v86
v_permlane16_swap_b32 v85, v87
v_permlane16_swap_b32 v81, v83
v_permlane16_swap_b32 v80, v82
v_mfma_f32_32x32x16_bf16 v[208:223], v[64:67], v[84:87], 0
v_cvt_pk_bf16_f32 v92, v152, v153
v_cvt_pk_bf16_f32 v91, v150, v151
v_cvt_pk_bf16_f32 v95, v158, v159
v_cvt_pk_bf16_f32 v94, v156, v157
v_cvt_pk_bf16_f32 v89, v146, v147
v_cvt_pk_bf16_f32 v93, v154, v155
v_mfma_f32_32x32x16_bf16 v[192:207], v[64:67], v[80:83], 0
v_cvt_pk_bf16_f32 v88, v144, v145
v_permlane16_swap_b32_e64 v93, v95
v_cvt_pk_bf16_f32 v90, v148, v149
v_permlane16_swap_b32 v89, v91
v_permlane16_swap_b32 v92, v94
v_max3_f32 v71, -v216, -v217, -v218
v_max3_f32 v71, v71, -v219, -v220
v_mfma_f32_32x32x16_bf16 v[240:255], v[64:67], v[92:95], 0
v_max3_f32 v70, v216, v217, v218
v_max3_f32 v71, v71, -v221, -v222
v_max3_f32 v70, v70, v219, v220
v_max3_f32 v70, v70, v221, v222
v_max3_f32 v69, -v192, -v193, -v194
v_max3_f32 v69, v69, -v195, -v196
v_max3_f32 v69, v69, -v197, -v198
v_max_f32 v69, v69, -v199
v_max_f32 v71, v71, -v223
v_max_f32_e64 v70, v70, v223
v_max3_f32 v68, v192, v193, v194
v_max3_f32 v68, v68, v195, v196
v_max3_f32 v68, v68, v197, v198
v_max_f32 v68, v68, v199
v_permlane32_swap_b32 v70, v71
v_max_f32 v70, v70, v71
v_permlane32_swap_b32 v68, v69
v_max_f32_e64 v68, v68, v69
v_mul_f32 v71, -v70, v50
v_mul_f32 v70, -v70, v50
v_permlane16_swap_b32_e64 v88, v90
v_mul_f32 v69, -v68, v50
v_mul_f32 v68, -v68, v50
v_mfma_f32_32x32x16_bf16 v[224:239], v[64:67], v[88:91], 0
v_permlane32_swap_b32 v70, v71
v_permlane32_swap_b32 v68, v69
v_cvt_pk_bf16_f32 v104, v176, v177
v_cvt_pk_bf16_f32 v105, v178, v179
v_cvt_pk_bf16_f32 v103, v174, v175
v_cvt_pk_bf16_f32 v109, v186, v187
v_cvt_pk_bf16_f32 v97, v162, v163
v_pk_fma_f32 v[134:135], v[198:199], v[50:51], v[68:69] op_sel_hi:[1,0,0]
v_pk_fma_f32 v[156:157], v[220:221], v[50:51], v[70:71] op_sel:[0,0,1] op_sel_hi:[1,0,1] neg_lo:[1,0,0] neg_hi:[1,0,0]
v_pk_fma_f32 v[148:149], v[220:221], v[50:51], v[70:71] op_sel_hi:[1,0,0]
v_pk_fma_f32 v[132:133], v[196:197], v[50:51], v[68:69] op_sel_hi:[1,0,0]
v_pk_fma_f32 v[144:145], v[216:217], v[50:51], v[70:71] op_sel_hi:[1,0,0]
v_pk_fma_f32 v[146:147], v[218:219], v[50:51], v[70:71] op_sel_hi:[1,0,0]
v_pk_fma_f32 v[136:137], v[192:193], v[50:51], v[68:69] op_sel:[0,0,1] op_sel_hi:[1,0,1] neg_lo:[1,0,0] neg_hi:[1,0,0]
v_exp_f32 v136, v136
v_exp_f32 v157, v157
v_exp_f32 v156, v156
v_exp_f32 v145, v145
v_exp_f32_e64 v135, v135
v_pk_fma_f32 v[158:159], v[222:223], v[50:51], v[70:71] op_sel:[0,0,1] op_sel_hi:[1,0,1] neg_lo:[1,0,0] neg_hi:[1,0,0]
v_exp_f32 v158, v158
v_exp_f32 v147, v147
v_exp_f32_e64 v159, v159
v_pk_fma_f32 v[130:131], v[194:195], v[50:51], v[68:69] op_sel_hi:[1,0,0]
v_exp_f32 v131, v131
v_exp_f32 v130, v130
v_exp_f32_e64 v149, v149
v_pk_fma_f32 v[152:153], v[216:217], v[50:51], v[70:71] op_sel:[0,0,1] op_sel_hi:[1,0,1] neg_lo:[1,0,0] neg_hi:[1,0,0]
s_load_dword s68, s[24:25], 0
v_exp_f32 v153, v153
v_exp_f32 v152, v152
v_exp_f32 v144, v144
v_exp_f32 v146, v146
v_pk_fma_f32 v[140:141], v[196:197], v[50:51], v[68:69] op_sel:[0,0,1] op_sel_hi:[1,0,1] neg_lo:[1,0,0] neg_hi:[1,0,0]
v_pk_add_f32 v[216:217], v[144:145], v[146:147]
v_exp_f32 v141, v141
v_exp_f32 v132, v132
v_pk_fma_f32 v[154:155], v[218:219], v[50:51], v[70:71] op_sel:[0,0,1] op_sel_hi:[1,0,1] neg_lo:[1,0,0] neg_hi:[1,0,0]
v_exp_f32 v155, v155
v_exp_f32 v154, v154
buffer_load_dwordx4 v11, s[36:39], s86 offen offset:1024 lds
v_pk_fma_f32 v[138:139], v[194:195], v[50:51], v[68:69] op_sel:[0,0,1] op_sel_hi:[1,0,1] neg_lo:[1,0,0] neg_hi:[1,0,0]
v_exp_f32 v139, v139
v_exp_f32 v138, v138
v_pk_add_f32 v[220:221], v[152:153], v[154:155]
v_pk_fma_f32 v[128:129], v[192:193], v[50:51], v[68:69] op_sel_hi:[1,0,0]
v_exp_f32_e64 v128, v128
v_pk_fma_f32 v[150:151], v[222:223], v[50:51], v[70:71] op_sel_hi:[1,0,0]
v_exp_f32_e64 v150, v150
v_pk_add_f32 v[222:223], v[156:157], v[158:159]
v_pk_add_f32 v[220:221], v[220:221], v[222:223]
v_add_f32 v71, v220, v221
v_exp_f32 v151, v151
v_exp_f32 v137, v137
v_exp_f32 v134, v134
buffer_load_dwordx4 v12, s[36:39], s86 offen offset:2048 lds
v_pk_fma_f32 v[142:143], v[198:199], v[50:51], v[68:69] op_sel:[0,0,1] op_sel_hi:[1,0,1] neg_lo:[1,0,0] neg_hi:[1,0,0]
v_exp_f32 v142, v142
v_exp_f32 v143, v143
v_exp_f32 v140, v140
v_exp_f32 v148, v148
v_pk_add_f32 v[198:199], v[140:141], v[142:143]
v_pk_add_f32 v[218:219], v[148:149], v[150:151]
v_exp_f32 v129, v129
v_exp_f32 v133, v133
v_pk_add_f32 v[196:197], v[136:137], v[138:139]
v_pk_add_f32 v[194:195], v[132:133], v[134:135]
v_pk_add_f32 v[196:197], v[196:197], v[198:199]
v_add_f32_e64 v69, v196, v197
v_pk_add_f32 v[192:193], v[128:129], v[130:131]
s_add_u32 m0, s89, 3072
s_nop 0
buffer_load_dwordx4 v10, s[40:43], s86 offen lds
v_pk_add_f32 v[192:193], v[192:193], v[194:195]
v_pk_add_f32 v[216:217], v[216:217], v[218:219]
v_add_f32 v70, v216, v217
v_add_f32_e64 v68, v192, v193
v_cvt_pk_bf16_f32 v106, v180, v181
v_permlane32_swap_b32 v70, v71
v_permlane32_swap_b32 v68, v69
v_add_f32 v70, v70, v71
v_rcp_f32 v70, v70
v_add_f32 v68, v68, v69
v_rcp_f32 v68, v68
v_mov_b32 v71, v70
v_mov_b32 v69, v68
v_cvt_pk_bf16_f32 v99, v166, v167
v_permlane32_swap_b32_e64 v70, v71
buffer_load_dwordx4 v11, s[40:43], s86 offen offset:1024 lds
v_permlane32_swap_b32_e64 v68, v69
v_pk_mul_f32 v[132:133], v[132:133], v[68:69] op_sel_hi:[1,0]
v_pk_mul_f32 v[146:147], v[146:147], v[70:71] op_sel_hi:[1,0]
v_pk_mul_f32 v[140:141], v[140:141], v[68:69] op_sel:[0,1] op_sel_hi:[1,1]
v_pk_mul_f32 v[154:155], v[154:155], v[70:71] op_sel:[0,1] op_sel_hi:[1,1]
v_pk_mul_f32 v[144:145], v[144:145], v[70:71] op_sel_hi:[1,0]
v_pk_mul_f32 v[158:159], v[158:159], v[70:71] op_sel:[0,1] op_sel_hi:[1,1]
v_pk_mul_f32 v[134:135], v[134:135], v[68:69] op_sel_hi:[1,0]
v_pk_mul_f32 v[150:151], v[150:151], v[70:71] op_sel_hi:[1,0]
v_pk_mul_f32 v[130:131], v[130:131], v[68:69] op_sel_hi:[1,0]
v_cvt_pk_bf16_f32 v113, v130, v131
v_pk_mul_f32 v[148:149], v[148:149], v[70:71] op_sel_hi:[1,0]
v_cvt_pk_bf16_f32 v122, v148, v149
v_pk_mul_f32 v[138:139], v[138:139], v[68:69] op_sel:[0,1] op_sel_hi:[1,1]
v_pk_mul_f32 v[136:137], v[136:137], v[68:69] op_sel:[0,1] op_sel_hi:[1,1]
v_pk_mul_f32 v[152:153], v[152:153], v[70:71] op_sel:[0,1] op_sel_hi:[1,1]
v_cvt_pk_bf16_f32 v115, v134, v135
v_cvt_pk_bf16_f32 v121, v146, v147
v_pk_mul_f32 v[128:129], v[128:129], v[68:69] op_sel_hi:[1,0]
buffer_load_dwordx4 v12, s[40:43], s86 offen offset:2048 lds
v_cvt_pk_bf16_f32 v120, v144, v145
v_cvt_pk_bf16_f32 v114, v132, v133
v_cvt_pk_bf16_f32 v111, v190, v191
v_pk_mul_f32 v[142:143], v[142:143], v[68:69] op_sel:[0,1] op_sel_hi:[1,1]
v_max3_f32 v68, v224, v225, v226
v_max3_f32 v69, -v224, -v225, -v226
v_pk_mul_f32 v[156:157], v[156:157], v[70:71] op_sel:[0,1] op_sel_hi:[1,1]
v_max3_f32 v71, -v248, -v249, -v250
v_cvt_pk_bf16_f32 v124, v152, v153
v_cvt_pk_bf16_f32 v116, v136, v137
v_cvt_pk_bf16_f32 v112, v128, v129
v_cvt_pk_bf16_f32 v98, v164, v165
v_cvt_pk_bf16_f32 v100, v168, v169
v_cvt_pk_bf16_f32 v123, v150, v151
v_cvt_pk_bf16_f32 v126, v156, v157
v_cvt_pk_bf16_f32 v118, v140, v141
v_cvt_pk_bf16_f32 v127, v158, v159
v_cvt_pk_bf16_f32 v102, v172, v173
v_max3_f32 v71, v71, -v251, -v252
v_cvt_pk_bf16_f32 v125, v154, v155
s_add_u32 s83, s79, 128
s_and_b32 s83, s83, 0x380
s_add_u32 m0, s89, 65536
s_mul_i32 s86, s83, 1376
buffer_load_dwordx4 v10, s[36:39], s86 offen lds
v_cvt_pk_bf16_f32 v101, v170, v171
v_cvt_pk_bf16_f32 v110, v188, v189
v_cvt_pk_bf16_f32 v107, v182, v183
v_cvt_pk_bf16_f32 v96, v160, v161
v_mfma_f32_32x32x16_bf16 v[160:175], v[112:115], v[52:55], 0
v_cvt_pk_bf16_f32 v117, v138, v139
v_cvt_pk_bf16_f32 v108, v184, v185
v_max3_f32 v69, v69, -v227, -v228
v_max3_f32 v69, v69, -v229, -v230
v_cvt_pk_bf16_f32 v119, v142, v143
v_max3_f32 v70, v248, v249, v250
v_mfma_f32_32x32x16_bf16 v[176:191], v[120:123], v[52:55], 0
v_max3_f32 v70, v70, v251, v252
v_max3_f32 v71, v71, -v253, -v254
v_max_f32 v71, v71, -v255
v_max_f32 v69, v69, -v231
v_max3_f32 v68, v68, v227, v228
v_max3_f32 v68, v68, v229, v230
buffer_load_dwordx4 v11, s[36:39], s86 offen offset:1024 lds
v_mfma_f32_32x32x16_bf16 v[160:175], v[116:119], v[56:59], v[160:175]
v_max3_f32 v70, v70, v253, v254
v_max_f32 v70, v70, v255
v_max_f32 v68, v68, v231
v_permlane16_swap_b32 v96, v98
v_permlane32_swap_b32 v70, v71
v_mfma_f32_32x32x16_bf16 v[176:191], v[124:127], v[56:59], v[176:191]
v_permlane32_swap_b32 v68, v69
v_max_f32 v70, v70, v71
v_mul_f32 v71, -v70, v50
v_mul_f32 v70, -v70, v50
v_max_f32_e64 v68, v68, v69
v_mul_f32 v69, -v68, v50
v_mul_f32 v68, -v68, v50
v_permlane32_swap_b32_e64 v70, v71
buffer_load_dwordx4 v12, s[36:39], s86 offen offset:2048 lds
v_pk_fma_f32 v[150:151], v[254:255], v[50:51], v[70:71] op_sel_hi:[1,0,0]
v_pk_fma_f32 v[154:155], v[250:251], v[50:51], v[70:71] op_sel:[0,0,1] op_sel_hi:[1,0,1] neg_lo:[1,0,0] neg_hi:[1,0,0]
v_permlane32_swap_b32_e64 v68, v69
v_pk_fma_f32 v[136:137], v[224:225], v[50:51], v[68:69] op_sel:[0,0,1] op_sel_hi:[1,0,1] neg_lo:[1,0,0] neg_hi:[1,0,0]
v_exp_f32_e64 v136, v136
v_pk_fma_f32 v[142:143], v[230:231], v[50:51], v[68:69] op_sel:[0,0,1] op_sel_hi:[1,0,1] neg_lo:[1,0,0] neg_hi:[1,0,0]
v_exp_f32 v143, v143
v_exp_f32 v142, v142
L_pad_KH_2:
s_cbranch_execz L_pad_KH_3
s_nop 0
v_pk_fma_f32 v[148:149], v[252:253], v[50:51], v[70:71] op_sel_hi:[1,0,0]
v_exp_f32 v148, v148
v_exp_f32 v149, v149
v_exp_f32_e64 v155, v155
v_pk_fma_f32 v[132:133], v[228:229], v[50:51], v[68:69] op_sel_hi:[1,0,0]
s_add_u32 m0, s89, 68608
s_nop 0
buffer_load_dwordx4 v10, s[40:43], s86 offen lds
v_exp_f32 v132, v132
v_pk_fma_f32 v[140:141], v[228:229], v[50:51], v[68:69] op_sel:[0,0,1] op_sel_hi:[1,0,1] neg_lo:[1,0,0] neg_hi:[1,0,0]
v_exp_f32 v140, v140
v_exp_f32 v141, v141
v_pk_fma_f32 v[128:129], v[224:225], v[50:51], v[68:69] op_sel_hi:[1,0,0]
v_exp_f32 v129, v129
s_waitcnt lgkmcnt(0)
s_bfe_u32 s97, s68, 524288
s_cmp_lt_u32 s97, 16
s_cbranch_scc1 L_slow_KH0
L_back_KH0:
v_exp_f32_e64 v128, v128
v_pk_fma_f32 v[134:135], v[230:231], v[50:51], v[68:69] op_sel_hi:[1,0,0]
v_exp_f32 v134, v134
v_exp_f32 v135, v135
buffer_load_dwordx4 v11, s[40:43], s86 offen offset:1024 lds
v_pk_fma_f32 v[146:147], v[250:251], v[50:51], v[70:71] op_sel_hi:[1,0,0]
v_exp_f32_e64 v137, v137
v_pk_fma_f32 v[152:153], v[248:249], v[50:51], v[70:71] op_sel:[0,0,1] op_sel_hi:[1,0,1] neg_lo:[1,0,0] neg_hi:[1,0,0]
v_exp_f32_e64 v153, v153
v_pk_fma_f32 v[156:157], v[252:253], v[50:51], v[70:71] op_sel:[0,0,1] op_sel_hi:[1,0,1] neg_lo:[1,0,0] neg_hi:[1,0,0]
v_exp_f32 v157, v157
v_exp_f32 v152, v152
v_exp_f32 v150, v150
v_exp_f32 v151, v151
v_exp_f32_e64 v147, v147
v_pk_fma_f32 v[144:145], v[248:249], v[50:51], v[70:71] op_sel_hi:[1,0,0]
v_exp_f32_e64 v145, v145
buffer_load_dwordx4 v12, s[40:43], s86 offen offset:2048 lds
v_pk_fma_f32 v[130:131], v[226:227], v[50:51], v[68:69] op_sel_hi:[1,0,0]
v_exp_f32_e64 v131, v131
v_pk_fma_f32 v[138:139], v[226:227], v[50:51], v[68:69] op_sel:[0,0,1] op_sel_hi:[1,0,1] neg_lo:[1,0,0] neg_hi:[1,0,0]
v_exp_f32 v138, v138
v_exp_f32 v139, v139
v_exp_f32_e64 v154, v154
v_pk_add_f32 v[228:229], v[136:137], v[138:139]
v_pk_add_f32 v[252:253], v[152:153], v[154:155]
v_pk_fma_f32 v[158:159], v[254:255], v[50:51], v[70:71] op_sel:[0,0,1] op_sel_hi:[1,0,1] neg_lo:[1,0,0] neg_hi:[1,0,0]
v_exp_f32 v158, v158
v_exp_f32 v159, v159
v_pk_add_f32 v[250:251], v[148:149], v[150:151]
v_exp_f32_e64 v144, v144
s_add_u32 s83, s79, 256
s_and_b32 s83, s83, 0x380
s_add_u32 m0, s89, 24576
s_mul_i32 s86, s83, 1376
buffer_load_dwordx4 v10, s[36:39], s86 offen lds
v_exp_f32 v130, v130
v_exp_f32 v133, v133
v_pk_add_f32 v[224:225], v[128:129], v[130:131]
v_exp_f32 v146, v146
v_exp_f32 v156, v156
v_pk_add_f32 v[248:249], v[144:145], v[146:147]
v_pk_add_f32 v[254:255], v[156:157], v[158:159]
v_pk_add_f32 v[248:249], v[248:249], v[250:251]
v_add_f32_e64 v70, v248, v249
v_pk_add_f32 v[230:231], v[140:141], v[142:143]
v_pk_add_f32 v[228:229], v[228:229], v[230:231]
v_add_f32_e64 v69, v228, v229
v_pk_add_f32 v[226:227], v[132:133], v[134:135]
v_pk_add_f32 v[224:225], v[224:225], v[226:227]
v_add_f32_e64 v68, v224, v225
v_pk_add_f32 v[252:253], v[252:253], v[254:255]
buffer_load_dwordx4 v11, s[36:39], s86 offen offset:1024 lds
v_add_f32 v71, v252, v253
v_permlane32_swap_b32 v68, v69
v_cvt_pk_bf16_f32 v83, v166, v167
v_permlane32_swap_b32 v70, v71
v_add_f32 v70, v70, v71
v_rcp_f32 v70, v70
v_add_f32 v68, v68, v69
v_mov_b32 v71, v70
v_rcp_f32 v68, v68
v_cvt_pk_bf16_f32 v90, v180, v181
v_permlane32_swap_b32_e64 v70, v71
v_pk_mul_f32 v[148:149], v[148:149], v[70:71] op_sel_hi:[1,0]
v_cvt_pk_bf16_f32 v122, v148, v149
v_cvt_pk_bf16_f32 v88, v176, v177
v_cvt_pk_bf16_f32 v95, v190, v191
buffer_load_dwordx4 v12, s[36:39], s86 offen offset:2048 lds
v_cvt_pk_bf16_f32 v81, v162, v163
v_pk_add_f32 v[74:75], v[176:177], v[178:179]
v_mov_b32_e64 v69, v68
v_cvt_pk_bf16_f32 v89, v178, v179
v_pk_add_f32 v[72:73], v[160:161], v[162:163]
v_pk_add_f32 v[72:73], v[72:73], v[164:165]
v_cvt_pk_bf16_f32 v91, v182, v183
v_cvt_pk_bf16_f32 v82, v164, v165
v_cvt_pk_bf16_f32 v93, v186, v187
v_cvt_pk_bf16_f32 v92, v184, v185
v_pk_add_f32 v[74:75], v[74:75], v[180:181]
v_pk_add_f32 v[74:75], v[74:75], v[182:183]
v_pk_add_f32 v[74:75], v[74:75], v[184:185]
v_pk_add_f32 v[74:75], v[74:75], v[186:187]
v_pk_add_f32 v[74:75], v[74:75], v[188:189]
v_pk_add_f32 v[74:75], v[74:75], v[190:191]
v_cvt_pk_bf16_f32 v87, v174, v175
v_pk_add_f32 v[72:73], v[72:73], v[166:167]
v_pk_add_f32 v[72:73], v[72:73], v[168:169]
v_pk_add_f32 v[72:73], v[72:73], v[170:171]
s_add_u32 m0, s89, 27648
s_nop 0
buffer_load_dwordx4 v10, s[40:43], s86 offen lds
v_pk_add_f32 v[72:73], v[72:73], v[172:173]
v_permlane32_swap_b32 v68, v69
v_pk_mul_f32 v[132:133], v[132:133], v[68:69] op_sel_hi:[1,0]
v_pk_mul_f32 v[130:131], v[130:131], v[68:69] op_sel_hi:[1,0]
v_pk_mul_f32 v[128:129], v[128:129], v[68:69] op_sel_hi:[1,0]
v_cvt_pk_bf16_f32 v112, v128, v129
v_cvt_pk_bf16_f32 v114, v132, v133
v_cvt_pk_bf16_f32 v113, v130, v131
v_cvt_pk_bf16_f32 v86, v172, v173
v_pk_mul_f32 v[146:147], v[146:147], v[70:71] op_sel_hi:[1,0]
v_cvt_pk_bf16_f32 v121, v146, v147
v_pk_mul_f32 v[144:145], v[144:145], v[70:71] op_sel_hi:[1,0]
v_pk_mul_f32 v[138:139], v[138:139], v[68:69] op_sel:[0,1] op_sel_hi:[1,1]
v_cvt_pk_bf16_f32 v80, v160, v161
v_pk_add_f32 v[72:73], v[72:73], v[174:175]
v_cvt_pk_bf16_f32 v94, v188, v189
v_cvt_pk_bf16_f32 v120, v144, v145
v_pk_mul_f32 v[140:141], v[140:141], v[68:69] op_sel:[0,1] op_sel_hi:[1,1]
v_cvt_pk_bf16_f32 v118, v140, v141
buffer_load_dwordx4 v11, s[40:43], s86 offen offset:1024 lds
v_pk_mul_f32 v[150:151], v[150:151], v[70:71] op_sel_hi:[1,0]
v_cvt_pk_bf16_f32 v123, v150, v151
v_pk_mul_f32 v[142:143], v[142:143], v[68:69] op_sel:[0,1] op_sel_hi:[1,1]
v_pk_mul_f32 v[134:135], v[134:135], v[68:69] op_sel_hi:[1,0]
v_pk_mul_f32 v[158:159], v[158:159], v[70:71] op_sel:[0,1] op_sel_hi:[1,1]
v_pk_mul_f32 v[156:157], v[156:157], v[70:71] op_sel:[0,1] op_sel_hi:[1,1]
v_pk_mul_f32 v[154:155], v[154:155], v[70:71] op_sel:[0,1] op_sel_hi:[1,1]
v_pk_mul_f32 v[136:137], v[136:137], v[68:69] op_sel:[0,1] op_sel_hi:[1,1]
v_pk_mul_f32 v[152:153], v[152:153], v[70:71] op_sel:[0,1] op_sel_hi:[1,1]
v_cvt_pk_bf16_f32 v115, v134, v135
v_mfma_f32_32x32x16_bf16 v[176:191], v[120:123], v[52:55], 0
v_cvt_pk_bf16_f32 v119, v142, v143
v_cvt_pk_bf16_f32 v84, v168, v169
v_cvt_pk_bf16_f32 v85, v170, v171
v_cvt_pk_bf16_f32 v116, v136, v137
v_cvt_pk_bf16_f32 v117, v138, v139
v_cvt_pk_bf16_f32 v124, v152, v153
v_mfma_f32_32x32x16_bf16 v[160:175], v[112:115], v[52:55], 0
buffer_load_dwordx4 v12, s[40:43], s86 offen offset:2048 lds
v_cvt_pk_bf16_f32 v126, v156, v157
v_permlane32_swap_b32 v96, v98
v_permlane16_swap_b32 v97, v99
v_cvt_pk_bf16_f32 v125, v154, v155
v_mfma_f32_32x32x16_bf16 v[160:175], v[116:119], v[56:59], v[160:175]
v_permlane16_swap_b32_e64 v100, v102
v_cvt_pk_bf16_f32 v127, v158, v159
v_permlane16_swap_b32 v101, v103
v_permlane32_swap_b32 v100, v102
v_mfma_f32_32x32x16_bf16 v[176:191], v[124:127], v[56:59], v[176:191]
v_permlane32_swap_b32 v97, v99
v_permlane16_swap_b32 v105, v107
s_add_u32 s83, s79, 384
s_and_b32 s83, s83, 0x380
s_add_u32 m0, s89, 90112
s_mul_i32 s86, s83, 1376
buffer_load_dwordx4 v10, s[36:39], s86 offen lds
v_permlane32_swap_b32_e64 v101, v103
v_mfma_f32_32x32x16_bf16 v[192:207], v[80:83], v[96:99], 0
v_permlane16_swap_b32 v104, v106
v_permlane16_swap_b32 v109, v111
v_permlane16_swap_b32_e64 v108, v110
v_mfma_f32_32x32x16_bf16 v[208:223], v[88:91], v[96:99], 0
v_cvt_pk_bf16_f32 v82, v164, v165
v_cvt_pk_bf16_f32 v81, v162, v163
v_permlane32_swap_b32_e64 v109, v111
v_cvt_pk_bf16_f32 v80, v160, v161
v_cvt_pk_bf16_f32 v91, v182, v183
v_mfma_f32_32x32x16_bf16 v[192:207], v[84:87], v[100:103], v[192:207]
buffer_load_dwordx4 v11, s[36:39], s86 offen offset:1024 lds
v_cvt_pk_bf16_f32 v89, v178, v179
v_cvt_pk_bf16_f32 v88, v176, v177
v_cvt_pk_bf16_f32 v90, v180, v181
v_permlane32_swap_b32_e64 v108, v110
v_cvt_pk_bf16_f32 v83, v166, v167
v_mfma_f32_32x32x16_bf16 v[208:223], v[92:95], v[100:103], v[208:223]
v_cvt_pk_bf16_f32 v92, v184, v185
v_cvt_pk_bf16_f32 v85, v170, v171
v_cvt_pk_bf16_f32 v87, v174, v175
v_permlane32_swap_b32_e64 v105, v107
v_cvt_pk_bf16_f32 v93, v186, v187
v_permlane32_swap_b32_e64 v104, v106
v_cvt_pk_bf16_f32 v84, v168, v169
v_pk_add_f32 v[74:75], v[74:75], v[176:177]
v_pk_add_f32 v[74:75], v[74:75], v[178:179]
v_pk_add_f32 v[74:75], v[74:75], v[180:181]
buffer_load_dwordx4 v12, s[36:39], s86 offen offset:2048 lds
v_pk_add_f32 v[74:75], v[74:75], v[182:183]
v_pk_add_f32 v[72:73], v[72:73], v[160:161]
v_pk_add_f32 v[72:73], v[72:73], v[162:163]
v_pk_add_f32 v[72:73], v[72:73], v[164:165]
v_pk_add_f32 v[72:73], v[72:73], v[166:167]
v_pk_add_f32 v[72:73], v[72:73], v[168:169]
v_pk_add_f32 v[72:73], v[72:73], v[170:171]
v_pk_add_f32 v[72:73], v[72:73], v[172:173]
v_pk_add_f32 v[74:75], v[74:75], v[184:185]
v_pk_add_f32 v[74:75], v[74:75], v[186:187]
v_pk_add_f32 v[74:75], v[74:75], v[188:189]
v_pk_add_f32 v[74:75], v[74:75], v[190:191]
v_pk_add_f32 v[72:73], v[72:73], v[174:175]
v_cvt_pk_bf16_f32 v94, v188, v189
v_mfma_f32_32x32x16_bf16 v[192:207], v[80:83], v[104:107], v[192:207]
v_cvt_pk_bf16_f32 v86, v172, v173
v_cvt_pk_bf16_f32 v95, v190, v191
v_add_f32 v72, v72, v73
v_add_f32 v74, v74, v75
s_add_u32 m0, s89, 93184
s_nop 0
buffer_load_dwordx4 v10, s[40:43], s86 offen lds
v_mfma_f32_32x32x16_bf16 v[192:207], v[84:87], v[108:111], v[192:207]
v_permlane32_swap_b32 v72, v74
v_add_f32_e64 v72, v72, v74
ds_write_b32 v4, v72
v_mfma_f32_32x32x16_bf16 v[208:223], v[88:91], v[104:107], v[208:223]
v_mfma_f32_32x32x16_bf16 v[208:223], v[92:95], v[108:111], v[208:223]
s_nop 11
v_cndmask_b32 v195, v195, v211, s[98:99]
v_cndmask_b32 v205, v205, v221, s[98:99]
v_cndmask_b32 v194, v194, v210, s[98:99]
v_cndmask_b32 v202, v202, v218, s[98:99]
v_cndmask_b32 v193, v193, v209, s[98:99]
v_cndmask_b32 v200, v200, v216, s[98:99]
v_cndmask_b32 v203, v203, v219, s[98:99]
v_cndmask_b32 v131, v203, v195, s[100:101]
v_cndmask_b32 v192, v192, v208, s[98:99]
buffer_load_dwordx4 v11, s[40:43], s86 offen offset:1024 lds
v_cndmask_b32 v128, v200, v192, s[100:101]
v_cndmask_b32 v198, v198, v214, s[98:99]
v_cndmask_b32 v197, v197, v213, s[98:99]
v_cndmask_b32 v237, v197, v205, s[100:101]
v_cndmask_b32 v204, v204, v220, s[98:99]
v_cndmask_b32 v133, v205, v197, s[100:101]
v_cndmask_b32 v206, v206, v222, s[98:99]
v_cndmask_b32 v134, v206, v198, s[100:101]
v_cndmask_b32 v238, v198, v206, s[100:101]
v_cndmask_b32 v232, v192, v200, s[100:101]
v_cndmask_b32 v235, v195, v203, s[100:101]
v_cndmask_b32 v201, v201, v217, s[98:99]
v_cndmask_b32 v233, v193, v201, s[100:101]
v_cndmask_b32 v129, v201, v193, s[100:101]
v_cndmask_b32 v207, v207, v223, s[98:99]
v_cndmask_b32 v130, v202, v194, s[100:101]
ds_write_b128 v2, v[128:131]
v_cndmask_b32 v196, v196, v212, s[98:99]
v_cndmask_b32 v236, v196, v204, s[100:101]
buffer_load_dwordx4 v12, s[40:43], s86 offen offset:2048 lds
v_cndmask_b32 v132, v204, v196, s[100:101]
v_cndmask_b32 v199, v199, v215, s[98:99]
v_cndmask_b32 v239, v199, v207, s[100:101]
v_cndmask_b32 v135, v207, v199, s[100:101]
ds_write_b128 v2, v[132:135] offset:1024
v_cndmask_b32 v234, v194, v202, s[100:101]
s_waitcnt vmcnt(18) lgkmcnt(0)
s_barrier
ds_read_b64_tr_b16 v[80:81], v20 offset:0
ds_read_b64_tr_b16 v[82:83], v20 offset:768
ds_read_b64_tr_b16 v[84:85], v20 offset:3072
ds_read_b64_tr_b16 v[86:87], v20 offset:3840
ds_read_b64_tr_b16 v[88:89], v21 offset:0
ds_read_b64_tr_b16 v[90:91], v21 offset:768
ds_read_b64_tr_b16 v[92:93], v21 offset:3072
ds_read_b64_tr_b16 v[94:95], v21 offset:3840
ds_read_b64_tr_b16 v[96:97], v22 offset:0
ds_read_b64_tr_b16 v[98:99], v22 offset:768
ds_read_b64_tr_b16 v[100:101], v22 offset:3072
ds_read_b64_tr_b16 v[102:103], v22 offset:3840
ds_read_b128 v[240:243], v3
ds_read_b128 v[244:247], v3 offset:1024
ds_read_b64 v[72:73], v5
ds_read_b64 v[74:75], v5 offset:256
s_waitcnt lgkmcnt(14)
v_mfma_f32_16x16x32_bf16 v[128:131], v[80:83], a[0:3], 0
ds_read_b64_tr_b16 v[104:105], v20 offset:12288
s_waitcnt lgkmcnt(4)
v_add_f32 v232, v232, v240
v_mfma_f32_16x16x32_bf16 v[132:135], v[80:83], a[4:7], 0
ds_read_b64_tr_b16 v[106:107], v20 offset:13056
v_add_f32_e64 v233, v233, v241
v_mfma_f32_16x16x32_bf16 v[136:139], v[84:87], a[0:3], 0
ds_read_b64_tr_b16 v[108:109], v20 offset:15360
v_add_f32_e64 v234, v234, v242
v_mfma_f32_16x16x32_bf16 v[140:143], v[84:87], a[4:7], 0
ds_read_b64_tr_b16 v[110:111], v20 offset:16128
v_add_f32_e64 v235, v235, v243
v_mfma_f32_16x16x32_bf16 v[160:163], v[88:91], a[0:3], 0
ds_read_b64_tr_b16 v[112:113], v21 offset:12288
s_waitcnt lgkmcnt(7)
v_add_f32 v236, v236, v244
v_mfma_f32_16x16x32_bf16 v[164:167], v[88:91], a[4:7], 0
ds_read_b64_tr_b16 v[114:115], v21 offset:13056
s_waitcnt lgkmcnt(6)
v_mfma_f32_16x16x32_bf16 v[168:171], v[92:95], a[0:3], 0
v_add_f32 v237, v237, v245
v_add_f32_e64 v238, v238, v246
v_mfma_f32_16x16x32_bf16 v[172:175], v[92:95], a[4:7], 0
v_add_f32 v239, v239, v247
v_add_f32 v72, v72, v74
v_mfma_f32_16x16x32_bf16 v[192:195], v[96:99], a[0:3], 0
v_mfma_f32_16x16x32_bf16 v[196:199], v[96:99], a[4:7], 0
v_mfma_f32_16x16x32_bf16 v[144:147], v[80:83], a[8:11], 0
ds_read_b64_tr_b16 v[116:117], v21 offset:15360
v_add_f32_e64 v73, v73, v75
v_mfma_f32_16x16x32_bf16 v[148:151], v[80:83], a[12:15], 0
ds_read_b64_tr_b16 v[118:119], v21 offset:16128
v_cvt_pk_bf16_f32 v248, v232, v233
v_mfma_f32_16x16x32_bf16 v[152:155], v[84:87], a[8:11], 0
ds_read_b64_tr_b16 v[120:121], v22 offset:12288
v_cvt_pk_bf16_f32 v249, v234, v235
v_mfma_f32_16x16x32_bf16 v[156:159], v[84:87], a[12:15], 0
ds_read_b64_tr_b16 v[122:123], v22 offset:13056
v_cvt_pk_bf16_f32 v250, v236, v237
v_mfma_f32_16x16x32_bf16 v[176:179], v[88:91], a[8:11], 0
ds_read_b64_tr_b16 v[124:125], v22 offset:15360
v_cvt_pk_bf16_f32 v251, v238, v239
v_mfma_f32_16x16x32_bf16 v[180:183], v[88:91], a[12:15], 0
ds_read_b64_tr_b16 v[126:127], v22 offset:16128
v_cvt_pk_bf16_f32 v252, v72, v73
v_mfma_f32_16x16x32_bf16 v[184:187], v[92:95], a[8:11], 0
buffer_store_dwordx4 v[248:251], v38, s[52:55], s84 offen sc1
v_mfma_f32_16x16x32_bf16 v[188:191], v[92:95], a[12:15], 0
v_mfma_f32_16x16x32_bf16 v[200:203], v[100:103], a[0:3], 0
buffer_store_dword v252, v6, s[52:55], s80 offen sc1
v_mfma_f32_16x16x32_bf16 v[204:207], v[100:103], a[4:7], 0
s_waitcnt lgkmcnt(0)
v_mfma_f32_16x16x32_bf16 v[128:131], v[104:107], a[16:19], v[128:131]
s_waitcnt vmcnt(14)
s_barrier
ds_read_b64_tr_b16 v[80:81], v23 offset:0
ds_read_b64_tr_b16 v[82:83], v23 offset:768
v_mfma_f32_16x16x32_bf16 v[132:135], v[104:107], a[20:23], v[132:135]
ds_read_b64_tr_b16 v[84:85], v23 offset:3072
ds_read_b64_tr_b16 v[86:87], v23 offset:3840
v_mfma_f32_16x16x32_bf16 v[136:139], v[108:111], a[16:19], v[136:139]
ds_read_b64_tr_b16 v[88:89], v24 offset:0
s_add_u32 m0, s87, 49152
s_add_u32 s85, s13, 32768
v_mfma_f32_16x16x32_bf16 v[140:143], v[108:111], a[20:23], v[140:143]
buffer_load_dwordx4 v32, s[44:47], s85 offen lds
v_mfma_f32_16x16x32_bf16 v[160:163], v[112:115], a[16:19], v[160:163]
ds_read_b64_tr_b16 v[90:91], v24 offset:768
v_mfma_f32_16x16x32_bf16 v[164:167], v[112:115], a[20:23], v[164:167]
ds_read_b64_tr_b16 a[0:1], v42 offset:0
v_mfma_f32_16x16x32_bf16 v[168:171], v[116:119], a[16:19], v[168:171]
ds_read_b64_tr_b16 a[2:3], v42 offset:1024
v_mfma_f32_16x16x32_bf16 v[172:175], v[116:119], a[20:23], v[172:175]
ds_read_b64_tr_b16 a[4:5], v15 offset:0
v_mfma_f32_16x16x32_bf16 v[192:195], v[120:123], a[16:19], v[192:195]
buffer_load_dwordx4 v33, s[44:47], s85 offen offset:1024 lds
v_mfma_f32_16x16x32_bf16 v[196:199], v[120:123], a[20:23], v[196:199]
ds_read_b64_tr_b16 a[6:7], v15 offset:1024
v_mfma_f32_16x16x32_bf16 v[144:147], v[104:107], a[24:27], v[144:147]
ds_read_b64_tr_b16 v[92:93], v24 offset:3072
ds_read_b64_tr_b16 v[94:95], v24 offset:3840
v_mfma_f32_16x16x32_bf16 v[148:151], v[104:107], a[28:31], v[148:151]
ds_read_b64_tr_b16 v[96:97], v25 offset:0
ds_read_b64_tr_b16 v[98:99], v25 offset:768
v_mfma_f32_16x16x32_bf16 v[152:155], v[108:111], a[24:27], v[152:155]
ds_read_b64_tr_b16 v[100:101], v25 offset:3072
v_mfma_f32_16x16x32_bf16 v[156:159], v[108:111], a[28:31], v[156:159]
buffer_load_dwordx4 v34, s[44:47], s85 offen offset:2048 lds
v_mfma_f32_16x16x32_bf16 v[176:179], v[112:115], a[24:27], v[176:179]
ds_read_b64_tr_b16 v[102:103], v25 offset:3840
v_mfma_f32_16x16x32_bf16 v[180:183], v[112:115], a[28:31], v[180:183]
ds_read_b64_tr_b16 a[8:9], v42 offset:256
v_mfma_f32_16x16x32_bf16 v[184:187], v[116:119], a[24:27], v[184:187]
ds_read_b64_tr_b16 a[10:11], v42 offset:1280
v_mfma_f32_16x16x32_bf16 v[188:191], v[116:119], a[28:31], v[188:191]
ds_read_b64_tr_b16 a[12:13], v15 offset:256
v_mfma_f32_16x16x32_bf16 v[200:203], v[124:127], a[16:19], v[200:203]
buffer_load_dwordx4 v35, s[44:47], s85 offen offset:3072 lds
v_mfma_f32_16x16x32_bf16 v[204:207], v[124:127], a[20:23], v[204:207]
ds_read_b64_tr_b16 a[14:15], v15 offset:1280
s_waitcnt lgkmcnt(10)
v_mfma_f32_16x16x32_bf16 v[128:131], v[80:83], a[32:35], v[128:131]
ds_read_b64_tr_b16 v[104:105], v23 offset:12288
s_add_u32 m0, s87, 114688
v_mfma_f32_16x16x32_bf16 v[132:135], v[80:83], a[36:39], v[132:135]
ds_read_b64_tr_b16 v[106:107], v23 offset:13056
s_add_u32 s85, s23, 0
v_mfma_f32_16x16x32_bf16 v[136:139], v[84:87], a[32:35], v[136:139]
ds_read_b64_tr_b16 v[108:109], v23 offset:15360
v_mfma_f32_16x16x32_bf16 v[140:143], v[84:87], a[36:39], v[140:143]
buffer_load_dwordx4 v32, s[44:47], s85 offen lds
v_mfma_f32_16x16x32_bf16 v[160:163], v[88:91], a[32:35], v[160:163]
ds_read_b64_tr_b16 v[110:111], v23 offset:16128
v_mfma_f32_16x16x32_bf16 v[164:167], v[88:91], a[36:39], v[164:167]
ds_read_b64_tr_b16 v[112:113], v24 offset:12288
s_waitcnt lgkmcnt(5)
v_mfma_f32_16x16x32_bf16 v[168:171], v[92:95], a[32:35], v[168:171]
ds_read_b64_tr_b16 v[114:115], v24 offset:13056
v_mfma_f32_16x16x32_bf16 v[172:175], v[92:95], a[36:39], v[172:175]
v_mfma_f32_16x16x32_bf16 v[192:195], v[96:99], a[32:35], v[192:195]
buffer_load_dwordx4 v33, s[44:47], s85 offen offset:1024 lds
v_mfma_f32_16x16x32_bf16 v[196:199], v[96:99], a[36:39], v[196:199]
v_mfma_f32_16x16x32_bf16 v[144:147], v[80:83], a[40:43], v[144:147]
ds_read_b64_tr_b16 v[116:117], v24 offset:15360
v_mfma_f32_16x16x32_bf16 v[148:151], v[80:83], a[44:47], v[148:151]
ds_read_b64_tr_b16 v[118:119], v24 offset:16128
v_mfma_f32_16x16x32_bf16 v[152:155], v[84:87], a[40:43], v[152:155]
ds_read_b64_tr_b16 v[120:121], v25 offset:12288
v_mfma_f32_16x16x32_bf16 v[156:159], v[84:87], a[44:47], v[156:159]
ds_read_b64_tr_b16 v[122:123], v25 offset:13056
v_mfma_f32_16x16x32_bf16 v[176:179], v[88:91], a[40:43], v[176:179]
ds_read_b64_tr_b16 v[124:125], v25 offset:15360
v_mfma_f32_16x16x32_bf16 v[180:183], v[88:91], a[44:47], v[180:183]
ds_read_b64_tr_b16 v[126:127], v25 offset:16128
v_mfma_f32_16x16x32_bf16 v[184:187], v[92:95], a[40:43], v[184:187]
buffer_load_dwordx4 v34, s[44:47], s85 offen offset:2048 lds
v_mfma_f32_16x16x32_bf16 v[188:191], v[92:95], a[44:47], v[188:191]
v_mfma_f32_16x16x32_bf16 v[200:203], v[100:103], a[32:35], v[200:203]
buffer_load_dwordx4 v35, s[44:47], s85 offen offset:3072 lds
v_mfma_f32_16x16x32_bf16 v[204:207], v[100:103], a[36:39], v[204:207]
s_waitcnt lgkmcnt(0)
v_mfma_f32_16x16x32_bf16 v[128:131], v[104:107], a[48:51], v[128:131]
s_waitcnt vmcnt(16)
s_barrier
ds_read_b64_tr_b16 v[80:81], v20 offset:24576
v_mfma_f32_16x16x32_bf16 v[132:135], v[104:107], a[52:55], v[132:135]
ds_read_b64_tr_b16 v[82:83], v20 offset:25344
s_add_u32 s83, s79, 512
v_mfma_f32_16x16x32_bf16 v[136:139], v[108:111], a[48:51], v[136:139]
ds_read_b64_tr_b16 v[84:85], v20 offset:27648
s_and_b32 s83, s83, 0x380
s_add_u32 m0, s89, 0
s_mul_i32 s86, s83, 1376
v_mfma_f32_16x16x32_bf16 v[140:143], v[108:111], a[52:55], v[140:143]
buffer_load_dwordx4 v10, s[36:39], s86 offen lds
v_mfma_f32_16x16x32_bf16 v[160:163], v[112:115], a[48:51], v[160:163]
ds_read_b64_tr_b16 v[86:87], v20 offset:28416
v_mfma_f32_16x16x32_bf16 v[164:167], v[112:115], a[52:55], v[164:167]
ds_read_b64_tr_b16 v[88:89], v21 offset:24576
v_mfma_f32_16x16x32_bf16 v[168:171], v[116:119], a[48:51], v[168:171]
ds_read_b64_tr_b16 v[90:91], v21 offset:25344
v_mfma_f32_16x16x32_bf16 v[172:175], v[116:119], a[52:55], v[172:175]
v_mfma_f32_16x16x32_bf16 v[192:195], v[120:123], a[48:51], v[192:195]
buffer_load_dwordx4 v11, s[36:39], s86 offen offset:1024 lds
v_mfma_f32_16x16x32_bf16 v[196:199], v[120:123], a[52:55], v[196:199]
v_mfma_f32_16x16x32_bf16 v[144:147], v[104:107], a[56:59], v[144:147]
ds_read_b64_tr_b16 v[92:93], v21 offset:27648
s_waitcnt vmcnt(10)
v_mfma_f32_16x16x32_bf16 v[148:151], v[104:107], a[60:63], v[148:151]
ds_read_b64_tr_b16 v[94:95], v21 offset:28416
s_atomic_add s69, s[26:27], s15
v_mfma_f32_16x16x32_bf16 v[152:155], v[108:111], a[56:59], v[152:155]
ds_read_b64_tr_b16 v[96:97], v22 offset:24576
v_mfma_f32_16x16x32_bf16 v[156:159], v[108:111], a[60:63], v[156:159]
buffer_load_dwordx4 v12, s[36:39], s86 offen offset:2048 lds
v_mfma_f32_16x16x32_bf16 v[176:179], v[112:115], a[56:59], v[176:179]
ds_read_b64_tr_b16 v[98:99], v22 offset:25344
s_add_u32 m0, s89, 3072
v_mfma_f32_16x16x32_bf16 v[180:183], v[112:115], a[60:63], v[180:183]
ds_read_b64_tr_b16 v[100:101], v22 offset:27648
v_mfma_f32_16x16x32_bf16 v[184:187], v[116:119], a[56:59], v[184:187]
ds_read_b64_tr_b16 v[102:103], v22 offset:28416
v_mfma_f32_16x16x32_bf16 v[188:191], v[116:119], a[60:63], v[188:191]
v_mfma_f32_16x16x32_bf16 v[200:203], v[124:127], a[48:51], v[200:203]
buffer_load_dwordx4 v10, s[40:43], s86 offen lds
v_mfma_f32_16x16x32_bf16 v[204:207], v[124:127], a[52:55], v[204:207]
s_waitcnt lgkmcnt(6)
v_mfma_f32_16x16x32_bf16 v[128:131], v[80:83], a[64:67], v[128:131]
ds_read_b64_tr_b16 v[104:105], v20 offset:36864
v_mfma_f32_16x16x32_bf16 v[132:135], v[80:83], a[68:71], v[132:135]
ds_read_b64_tr_b16 v[106:107], v20 offset:37632
v_mfma_f32_16x16x32_bf16 v[136:139], v[84:87], a[64:67], v[136:139]
ds_read_b64_tr_b16 v[108:109], v20 offset:39936
v_mfma_f32_16x16x32_bf16 v[140:143], v[84:87], a[68:71], v[140:143]
buffer_load_dwordx4 v11, s[40:43], s86 offen offset:1024 lds
v_mfma_f32_16x16x32_bf16 v[160:163], v[88:91], a[64:67], v[160:163]
ds_read_b64_tr_b16 v[110:111], v20 offset:40704
v_mfma_f32_16x16x32_bf16 v[164:167], v[88:91], a[68:71], v[164:167]
ds_read_b64_tr_b16 v[112:113], v21 offset:36864
s_waitcnt lgkmcnt(5)
v_mfma_f32_16x16x32_bf16 v[168:171], v[92:95], a[64:67], v[168:171]
ds_read_b64_tr_b16 v[114:115], v21 offset:37632
v_mfma_f32_16x16x32_bf16 v[172:175], v[92:95], a[68:71], v[172:175]
v_mfma_f32_16x16x32_bf16 v[192:195], v[96:99], a[64:67], v[192:195]
buffer_load_dwordx4 v12, s[40:43], s86 offen offset:2048 lds
v_mfma_f32_16x16x32_bf16 v[196:199], v[96:99], a[68:71], v[196:199]
v_mfma_f32_16x16x32_bf16 v[144:147], v[80:83], a[72:75], v[144:147]
ds_read_b64_tr_b16 v[116:117], v21 offset:39936
s_add_u32 m0, s87, 131072
v_mfma_f32_16x16x32_bf16 v[148:151], v[80:83], a[76:79], v[148:151]
ds_read_b64_tr_b16 v[118:119], v21 offset:40704
s_add_u32 s85, s23, 32768
v_mfma_f32_16x16x32_bf16 v[152:155], v[84:87], a[72:75], v[152:155]
ds_read_b64_tr_b16 v[120:121], v22 offset:36864
v_mfma_f32_16x16x32_bf16 v[156:159], v[84:87], a[76:79], v[156:159]
ds_read_b64_tr_b16 v[122:123], v22 offset:37632
v_mfma_f32_16x16x32_bf16 v[176:179], v[88:91], a[72:75], v[176:179]
ds_read_b64_tr_b16 v[124:125], v22 offset:39936
v_mfma_f32_16x16x32_bf16 v[180:183], v[88:91], a[76:79], v[180:183]
ds_read_b64_tr_b16 v[126:127], v22 offset:40704
v_mfma_f32_16x16x32_bf16 v[184:187], v[92:95], a[72:75], v[184:187]
buffer_load_dwordx4 v32, s[44:47], s85 offen lds
v_mfma_f32_16x16x32_bf16 v[188:191], v[92:95], a[76:79], v[188:191]
ds_read_b32 v47, v43
v_mfma_f32_16x16x32_bf16 v[200:203], v[100:103], a[64:67], v[200:203]
buffer_load_dwordx4 v33, s[44:47], s85 offen offset:1024 lds
v_mfma_f32_16x16x32_bf16 v[204:207], v[100:103], a[68:71], v[204:207]
s_waitcnt lgkmcnt(1)
v_mfma_f32_16x16x32_bf16 v[128:131], v[104:107], a[80:83], v[128:131]
s_barrier
ds_read_b64_tr_b16 v[80:81], v23 offset:24576
v_mfma_f32_16x16x32_bf16 v[132:135], v[104:107], a[84:87], v[132:135]
ds_read_b64_tr_b16 v[82:83], v23 offset:25344
v_mfma_f32_16x16x32_bf16 v[136:139], v[108:111], a[80:83], v[136:139]
ds_read_b64_tr_b16 v[84:85], v23 offset:27648
v_mfma_f32_16x16x32_bf16 v[140:143], v[108:111], a[84:87], v[140:143]
buffer_load_dwordx4 v34, s[44:47], s85 offen offset:2048 lds
v_mfma_f32_16x16x32_bf16 v[160:163], v[112:115], a[80:83], v[160:163]
ds_read_b64_tr_b16 v[86:87], v23 offset:28416
v_mfma_f32_16x16x32_bf16 v[164:167], v[112:115], a[84:87], v[164:167]
ds_read_b64_tr_b16 v[88:89], v24 offset:24576
v_mfma_f32_16x16x32_bf16 v[168:171], v[116:119], a[80:83], v[168:171]
ds_read_b64_tr_b16 v[90:91], v24 offset:25344
v_mfma_f32_16x16x32_bf16 v[172:175], v[116:119], a[84:87], v[172:175]
v_mfma_f32_16x16x32_bf16 v[192:195], v[120:123], a[80:83], v[192:195]
buffer_load_dwordx4 v35, s[44:47], s85 offen offset:3072 lds
v_mfma_f32_16x16x32_bf16 v[196:199], v[120:123], a[84:87], v[196:199]
v_mfma_f32_16x16x32_bf16 v[144:147], v[104:107], a[88:91], v[144:147]
s_waitcnt vmcnt(14)
ds_read_b64_tr_b16 v[92:93], v24 offset:27648
ds_read_b64_tr_b16 v[94:95], v24 offset:28416
v_mfma_f32_16x16x32_bf16 v[148:151], v[104:107], a[92:95], v[148:151]
ds_read_b64_tr_b16 v[96:97], v25 offset:24576
ds_read_b64_tr_b16 v[98:99], v25 offset:25344
v_mfma_f32_16x16x32_bf16 v[152:155], v[108:111], a[88:91], v[152:155]
ds_read_b64_tr_b16 v[100:101], v25 offset:27648
s_add_u32 s83, s79, 640
s_and_b32 s83, s83, 0x380
s_add_u32 m0, s89, 65536
s_mul_i32 s86, s83, 1376
v_mfma_f32_16x16x32_bf16 v[156:159], v[108:111], a[92:95], v[156:159]
buffer_load_dwordx4 v10, s[36:39], s86 offen lds
v_mfma_f32_16x16x32_bf16 v[176:179], v[112:115], a[88:91], v[176:179]
ds_read_b64_tr_b16 v[102:103], v25 offset:28416
v_mfma_f32_16x16x32_bf16 v[180:183], v[112:115], a[92:95], v[180:183]
ds_read_b64_tr_b16 a[16:17], v40 offset:49152
v_mfma_f32_16x16x32_bf16 v[184:187], v[116:119], a[88:91], v[184:187]
L_pad_KH_3:
s_cbranch_execz L_pad_KH_4
s_nop 0
ds_read_b64_tr_b16 a[18:19], v40 offset:50176
v_mfma_f32_16x16x32_bf16 v[188:191], v[116:119], a[92:95], v[188:191]
ds_read_b64_tr_b16 a[20:21], v13 offset:49152
v_mfma_f32_16x16x32_bf16 v[200:203], v[124:127], a[80:83], v[200:203]
buffer_load_dwordx4 v11, s[36:39], s86 offen offset:1024 lds
v_mfma_f32_16x16x32_bf16 v[204:207], v[124:127], a[84:87], v[204:207]
ds_read_b64_tr_b16 a[22:23], v13 offset:50176
s_waitcnt lgkmcnt(10)
v_mfma_f32_16x16x32_bf16 v[128:131], v[80:83], a[96:99], v[128:131]
ds_read_b64_tr_b16 v[104:105], v23 offset:36864
ds_read_b64_tr_b16 v[106:107], v23 offset:37632
v_mfma_f32_16x16x32_bf16 v[132:135], v[80:83], a[100:103], v[132:135]
ds_read_b64_tr_b16 v[108:109], v23 offset:39936
ds_read_b64_tr_b16 v[110:111], v23 offset:40704
v_mfma_f32_16x16x32_bf16 v[136:139], v[84:87], a[96:99], v[136:139]
ds_read_b64_tr_b16 v[112:113], v24 offset:36864
v_mfma_f32_16x16x32_bf16 v[140:143], v[84:87], a[100:103], v[140:143]
buffer_load_dwordx4 v12, s[36:39], s86 offen offset:2048 lds
v_mfma_f32_16x16x32_bf16 v[160:163], v[88:91], a[96:99], v[160:163]
ds_read_b64_tr_b16 v[114:115], v24 offset:37632
s_add_u32 m0, s89, 68608
v_mfma_f32_16x16x32_bf16 v[164:167], v[88:91], a[100:103], v[164:167]
ds_read_b64_tr_b16 a[24:25], v40 offset:49408
s_waitcnt lgkmcnt(7)
v_mfma_f32_16x16x32_bf16 v[168:171], v[92:95], a[96:99], v[168:171]
ds_read_b64_tr_b16 a[26:27], v40 offset:50432
v_mfma_f32_16x16x32_bf16 v[172:175], v[92:95], a[100:103], v[172:175]
ds_read_b64_tr_b16 a[28:29], v13 offset:49408
v_mfma_f32_16x16x32_bf16 v[192:195], v[96:99], a[96:99], v[192:195]
buffer_load_dwordx4 v10, s[40:43], s86 offen lds
v_mfma_f32_16x16x32_bf16 v[196:199], v[96:99], a[100:103], v[196:199]
ds_read_b64_tr_b16 a[30:31], v13 offset:50432
v_mfma_f32_16x16x32_bf16 v[144:147], v[80:83], a[104:107], v[144:147]
s_waitcnt vmcnt(14)
ds_read_b64_tr_b16 v[116:117], v24 offset:39936
ds_read_b64_tr_b16 v[118:119], v24 offset:40704
v_mfma_f32_16x16x32_bf16 v[148:151], v[80:83], a[108:111], v[148:151]
ds_read_b64_tr_b16 v[120:121], v25 offset:36864
ds_read_b64_tr_b16 v[122:123], v25 offset:37632
v_mfma_f32_16x16x32_bf16 v[152:155], v[84:87], a[104:107], v[152:155]
ds_read_b64_tr_b16 v[124:125], v25 offset:39936
v_mfma_f32_16x16x32_bf16 v[156:159], v[84:87], a[108:111], v[156:159]
ds_read_b64_tr_b16 v[126:127], v25 offset:40704
v_mfma_f32_16x16x32_bf16 v[176:179], v[88:91], a[104:107], v[176:179]
ds_read_b64_tr_b16 a[32:33], v41 offset:49152
v_mfma_f32_16x16x32_bf16 v[180:183], v[88:91], a[108:111], v[180:183]
ds_read_b64_tr_b16 a[34:35], v41 offset:50176
v_mfma_f32_16x16x32_bf16 v[184:187], v[92:95], a[104:107], v[184:187]
buffer_load_dwordx4 v11, s[40:43], s86 offen offset:1024 lds
v_mfma_f32_16x16x32_bf16 v[188:191], v[92:95], a[108:111], v[188:191]
ds_read_b64_tr_b16 a[36:37], v14 offset:49152
v_mfma_f32_16x16x32_bf16 v[200:203], v[100:103], a[96:99], v[200:203]
buffer_load_dwordx4 v12, s[40:43], s86 offen offset:2048 lds
v_mfma_f32_16x16x32_bf16 v[204:207], v[100:103], a[100:103], v[204:207]
ds_read_b64_tr_b16 a[38:39], v14 offset:50176
s_waitcnt lgkmcnt(0)
v_mfma_f32_16x16x32_bf16 v[128:131], v[104:107], a[112:115], v[128:131]
s_waitcnt vmcnt(10)
s_barrier
ds_read_b64_tr_b16 v[80:81], v20 offset:0
ds_read_b64_tr_b16 v[82:83], v20 offset:768
v_mfma_f32_16x16x32_bf16 v[132:135], v[104:107], a[116:119], v[132:135]
ds_read_b64_tr_b16 v[84:85], v20 offset:3072
ds_read_b64_tr_b16 v[86:87], v20 offset:3840
v_mfma_f32_16x16x32_bf16 v[136:139], v[108:111], a[112:115], v[136:139]
ds_read_b64_tr_b16 v[88:89], v21 offset:0
s_add_u32 s83, s79, 768
s_and_b32 s83, s83, 0x380
s_add_u32 m0, s89, 24576
s_mul_i32 s86, s83, 1376
v_mfma_f32_16x16x32_bf16 v[140:143], v[108:111], a[116:119], v[140:143]
buffer_load_dwordx4 v10, s[36:39], s86 offen lds
v_mfma_f32_16x16x32_bf16 v[160:163], v[112:115], a[112:115], v[160:163]
ds_read_b64_tr_b16 v[90:91], v21 offset:768
v_mfma_f32_16x16x32_bf16 v[164:167], v[112:115], a[116:119], v[164:167]
ds_read_b64_tr_b16 a[40:41], v41 offset:49408
v_mfma_f32_16x16x32_bf16 v[168:171], v[116:119], a[112:115], v[168:171]
ds_read_b64_tr_b16 a[42:43], v41 offset:50432
v_mfma_f32_16x16x32_bf16 v[172:175], v[116:119], a[116:119], v[172:175]
ds_read_b64_tr_b16 a[44:45], v14 offset:49408
v_mfma_f32_16x16x32_bf16 v[192:195], v[120:123], a[112:115], v[192:195]
buffer_load_dwordx4 v11, s[36:39], s86 offen offset:1024 lds
v_mfma_f32_16x16x32_bf16 v[196:199], v[120:123], a[116:119], v[196:199]
ds_read_b64_tr_b16 a[46:47], v14 offset:50432
v_mfma_f32_16x16x32_bf16 v[144:147], v[104:107], a[120:123], v[144:147]
ds_read_b64_tr_b16 v[92:93], v21 offset:3072
v_mfma_f32_16x16x32_bf16 v[148:151], v[104:107], a[124:127], v[148:151]
ds_read_b64_tr_b16 v[94:95], v21 offset:3840
v_mfma_f32_16x16x32_bf16 v[152:155], v[108:111], a[120:123], v[152:155]
ds_read_b64_tr_b16 v[96:97], v22 offset:0
v_mfma_f32_16x16x32_bf16 v[156:159], v[108:111], a[124:127], v[156:159]
buffer_load_dwordx4 v12, s[36:39], s86 offen offset:2048 lds
v_mfma_f32_16x16x32_bf16 v[176:179], v[112:115], a[120:123], v[176:179]
ds_read_b64_tr_b16 v[98:99], v22 offset:768
s_add_u32 m0, s89, 27648
v_mfma_f32_16x16x32_bf16 v[180:183], v[112:115], a[124:127], v[180:183]
ds_read_b64_tr_b16 v[100:101], v22 offset:3072
v_mfma_f32_16x16x32_bf16 v[184:187], v[116:119], a[120:123], v[184:187]
ds_read_b64_tr_b16 v[102:103], v22 offset:3840
v_mfma_f32_16x16x32_bf16 v[188:191], v[116:119], a[124:127], v[188:191]
v_mfma_f32_16x16x32_bf16 v[200:203], v[124:127], a[112:115], v[200:203]
buffer_load_dwordx4 v10, s[40:43], s86 offen lds
v_mfma_f32_16x16x32_bf16 v[204:207], v[124:127], a[116:119], v[204:207]
s_waitcnt lgkmcnt(6)
v_mfma_f32_16x16x32_bf16 v[128:131], v[80:83], a[128:131], v[128:131]
ds_read_b64_tr_b16 v[104:105], v20 offset:12288
v_mfma_f32_16x16x32_bf16 v[132:135], v[80:83], a[132:135], v[132:135]
ds_read_b64_tr_b16 v[106:107], v20 offset:13056
v_mfma_f32_16x16x32_bf16 v[136:139], v[84:87], a[128:131], v[136:139]
ds_read_b64_tr_b16 v[108:109], v20 offset:15360
v_mfma_f32_16x16x32_bf16 v[140:143], v[84:87], a[132:135], v[140:143]
buffer_load_dwordx4 v11, s[40:43], s86 offen offset:1024 lds
v_mfma_f32_16x16x32_bf16 v[160:163], v[88:91], a[128:131], v[160:163]
ds_read_b64_tr_b16 v[110:111], v20 offset:16128
v_mfma_f32_16x16x32_bf16 v[164:167], v[88:91], a[132:135], v[164:167]
ds_read_b64_tr_b16 v[112:113], v21 offset:12288
s_waitcnt lgkmcnt(5)
v_mfma_f32_16x16x32_bf16 v[168:171], v[92:95], a[128:131], v[168:171]
ds_read_b64_tr_b16 v[114:115], v21 offset:13056
v_mfma_f32_16x16x32_bf16 v[172:175], v[92:95], a[132:135], v[172:175]
v_mfma_f32_16x16x32_bf16 v[192:195], v[96:99], a[128:131], v[192:195]
buffer_load_dwordx4 v12, s[40:43], s86 offen offset:2048 lds
v_mfma_f32_16x16x32_bf16 v[196:199], v[96:99], a[132:135], v[196:199]
v_mfma_f32_16x16x32_bf16 v[144:147], v[80:83], a[136:139], v[144:147]
ds_read_b64_tr_b16 v[116:117], v21 offset:15360
s_add_u32 s83, s79, 896
v_mfma_f32_16x16x32_bf16 v[148:151], v[80:83], a[140:143], v[148:151]
ds_read_b64_tr_b16 v[118:119], v21 offset:16128
s_and_b32 s83, s83, 0x380
v_mfma_f32_16x16x32_bf16 v[152:155], v[84:87], a[136:139], v[152:155]
ds_read_b64_tr_b16 v[120:121], v22 offset:12288
s_add_u32 m0, s89, 90112
v_mfma_f32_16x16x32_bf16 v[156:159], v[84:87], a[140:143], v[156:159]
ds_read_b64_tr_b16 v[122:123], v22 offset:13056
s_mul_i32 s86, s83, 1376
v_mfma_f32_16x16x32_bf16 v[176:179], v[88:91], a[136:139], v[176:179]
ds_read_b64_tr_b16 v[124:125], v22 offset:15360
v_mfma_f32_16x16x32_bf16 v[180:183], v[88:91], a[140:143], v[180:183]
ds_read_b64_tr_b16 v[126:127], v22 offset:16128
v_mfma_f32_16x16x32_bf16 v[184:187], v[92:95], a[136:139], v[184:187]
buffer_load_dwordx4 v10, s[36:39], s86 offen lds
v_mfma_f32_16x16x32_bf16 v[188:191], v[92:95], a[140:143], v[188:191]
v_mfma_f32_16x16x32_bf16 v[200:203], v[100:103], a[128:131], v[200:203]
buffer_load_dwordx4 v11, s[36:39], s86 offen offset:1024 lds
v_mfma_f32_16x16x32_bf16 v[204:207], v[100:103], a[132:135], v[204:207]
s_waitcnt lgkmcnt(0)
v_mfma_f32_16x16x32_bf16 v[128:131], v[104:107], a[144:147], v[128:131]
s_waitcnt vmcnt(8)
s_barrier
ds_read_b64_tr_b16 v[80:81], v23 offset:0
ds_read_b64_tr_b16 v[82:83], v23 offset:768
v_mfma_f32_16x16x32_bf16 v[132:135], v[104:107], a[148:151], v[132:135]
ds_read_b64_tr_b16 v[84:85], v23 offset:3072
ds_read_b64_tr_b16 v[86:87], v23 offset:3840
v_mfma_f32_16x16x32_bf16 v[136:139], v[108:111], a[144:147], v[136:139]
ds_read_b64_tr_b16 v[88:89], v24 offset:0
v_mfma_f32_16x16x32_bf16 v[140:143], v[108:111], a[148:151], v[140:143]
buffer_load_dwordx4 v12, s[36:39], s86 offen offset:2048 lds
v_mfma_f32_16x16x32_bf16 v[160:163], v[112:115], a[144:147], v[160:163]
ds_read_b64_tr_b16 v[90:91], v24 offset:768
s_add_u32 m0, s89, 93184
v_mfma_f32_16x16x32_bf16 v[164:167], v[112:115], a[148:151], v[164:167]
ds_read_b64_tr_b16 a[48:49], v42 offset:0
v_mfma_f32_16x16x32_bf16 v[168:171], v[116:119], a[144:147], v[168:171]
ds_read_b64_tr_b16 a[50:51], v42 offset:1024
v_mfma_f32_16x16x32_bf16 v[172:175], v[116:119], a[148:151], v[172:175]
ds_read_b64_tr_b16 a[52:53], v15 offset:0
v_mfma_f32_16x16x32_bf16 v[192:195], v[120:123], a[144:147], v[192:195]
buffer_load_dwordx4 v10, s[40:43], s86 offen lds
v_mfma_f32_16x16x32_bf16 v[196:199], v[120:123], a[148:151], v[196:199]
ds_read_b64_tr_b16 a[54:55], v15 offset:1024
v_mfma_f32_16x16x32_bf16 v[144:147], v[104:107], a[152:155], v[144:147]
ds_read_b64_tr_b16 v[92:93], v24 offset:3072
ds_read_b64_tr_b16 v[94:95], v24 offset:3840
v_mfma_f32_16x16x32_bf16 v[148:151], v[104:107], a[156:159], v[148:151]
ds_read_b64_tr_b16 v[96:97], v25 offset:0
ds_read_b64_tr_b16 v[98:99], v25 offset:768
v_mfma_f32_16x16x32_bf16 v[152:155], v[108:111], a[152:155], v[152:155]
ds_read_b64_tr_b16 v[100:101], v25 offset:3072
v_mfma_f32_16x16x32_bf16 v[156:159], v[108:111], a[156:159], v[156:159]
buffer_load_dwordx4 v11, s[40:43], s86 offen offset:1024 lds
v_mfma_f32_16x16x32_bf16 v[176:179], v[112:115], a[152:155], v[176:179]
ds_read_b64_tr_b16 v[102:103], v25 offset:3840
v_mfma_f32_16x16x32_bf16 v[180:183], v[112:115], a[156:159], v[180:183]
ds_read_b64_tr_b16 a[56:57], v42 offset:256
v_mfma_f32_16x16x32_bf16 v[184:187], v[116:119], a[152:155], v[184:187]
ds_read_b64_tr_b16 a[58:59], v42 offset:1280
v_mfma_f32_16x16x32_bf16 v[188:191], v[116:119], a[156:159], v[188:191]
ds_read_b64_tr_b16 a[60:61], v15 offset:256
v_mfma_f32_16x16x32_bf16 v[200:203], v[124:127], a[144:147], v[200:203]
buffer_load_dwordx4 v12, s[40:43], s86 offen offset:2048 lds
v_mfma_f32_16x16x32_bf16 v[204:207], v[124:127], a[148:151], v[204:207]
ds_read_b64_tr_b16 a[62:63], v15 offset:1280
s_waitcnt lgkmcnt(10)
v_mfma_f32_16x16x32_bf16 v[128:131], v[80:83], a[160:163], v[128:131]
ds_read_b64_tr_b16 v[104:105], v23 offset:12288
s_add_u32 m0, s87, 49152
s_add_u32 s85, s4, 0
v_mfma_f32_16x16x32_bf16 v[132:135], v[80:83], a[164:167], v[132:135]
buffer_load_dwordx4 v32, s[48:51], s85 offen lds
v_mfma_f32_16x16x32_bf16 v[136:139], v[84:87], a[160:163], v[136:139]
ds_read_b64_tr_b16 v[106:107], v23 offset:13056
v_mfma_f32_16x16x32_bf16 v[140:143], v[84:87], a[164:167], v[140:143]
ds_read_b64_tr_b16 v[108:109], v23 offset:15360
v_mfma_f32_16x16x32_bf16 v[160:163], v[88:91], a[160:163], v[160:163]
buffer_load_dwordx4 v33, s[48:51], s85 offen offset:1024 lds
v_mfma_f32_16x16x32_bf16 v[164:167], v[88:91], a[164:167], v[164:167]
ds_read_b64_tr_b16 v[110:111], v23 offset:16128
s_waitcnt lgkmcnt(4)
v_mfma_f32_16x16x32_bf16 v[168:171], v[92:95], a[160:163], v[168:171]
ds_read_b64_tr_b16 v[112:113], v24 offset:12288
v_mfma_f32_16x16x32_bf16 v[172:175], v[92:95], a[164:167], v[172:175]
ds_read_b64_tr_b16 v[114:115], v24 offset:13056
v_mfma_f32_16x16x32_bf16 v[192:195], v[96:99], a[160:163], v[192:195]
buffer_load_dwordx4 v34, s[48:51], s85 offen offset:2048 lds
v_mfma_f32_16x16x32_bf16 v[196:199], v[96:99], a[164:167], v[196:199]
v_mfma_f32_16x16x32_bf16 v[144:147], v[80:83], a[168:171], v[144:147]
ds_read_b64_tr_b16 v[116:117], v24 offset:15360
v_mfma_f32_16x16x32_bf16 v[148:151], v[80:83], a[172:175], v[148:151]
ds_read_b64_tr_b16 v[118:119], v24 offset:16128
v_mfma_f32_16x16x32_bf16 v[152:155], v[84:87], a[168:171], v[152:155]
ds_read_b64_tr_b16 v[120:121], v25 offset:12288
v_mfma_f32_16x16x32_bf16 v[156:159], v[84:87], a[172:175], v[156:159]
ds_read_b64_tr_b16 v[122:123], v25 offset:13056
v_mfma_f32_16x16x32_bf16 v[176:179], v[88:91], a[168:171], v[176:179]
ds_read_b64_tr_b16 v[124:125], v25 offset:15360
v_mfma_f32_16x16x32_bf16 v[180:183], v[88:91], a[172:175], v[180:183]
ds_read_b64_tr_b16 v[126:127], v25 offset:16128
v_mfma_f32_16x16x32_bf16 v[184:187], v[92:95], a[168:171], v[184:187]
buffer_load_dwordx4 v35, s[48:51], s85 offen offset:3072 lds
v_mfma_f32_16x16x32_bf16 v[188:191], v[92:95], a[172:175], v[188:191]
s_add_u32 m0, s87, 131072
s_add_u32 s85, s4, 32768
v_mfma_f32_16x16x32_bf16 v[200:203], v[100:103], a[160:163], v[200:203]
buffer_load_dwordx4 v32, s[48:51], s85 offen lds
v_mfma_f32_16x16x32_bf16 v[204:207], v[100:103], a[164:167], v[204:207]
s_waitcnt lgkmcnt(0)
v_mfma_f32_16x16x32_bf16 v[128:131], v[104:107], a[176:179], v[128:131]
s_waitcnt vmcnt(11)
s_barrier
ds_read_b64_tr_b16 v[80:81], v20 offset:24576
v_mfma_f32_16x16x32_bf16 v[132:135], v[104:107], a[180:183], v[132:135]
buffer_load_dwordx4 v33, s[48:51], s85 offen offset:1024 lds
v_mfma_f32_16x16x32_bf16 v[136:139], v[108:111], a[176:179], v[136:139]
ds_read_b64_tr_b16 v[82:83], v20 offset:25344
v_mfma_f32_16x16x32_bf16 v[140:143], v[108:111], a[180:183], v[140:143]
ds_read_b64_tr_b16 v[84:85], v20 offset:27648
v_mfma_f32_16x16x32_bf16 v[160:163], v[112:115], a[176:179], v[160:163]
buffer_load_dwordx4 v34, s[48:51], s85 offen offset:2048 lds
v_mfma_f32_16x16x32_bf16 v[164:167], v[112:115], a[180:183], v[164:167]
ds_read_b64_tr_b16 v[86:87], v20 offset:28416
v_mfma_f32_16x16x32_bf16 v[168:171], v[116:119], a[176:179], v[168:171]
ds_read_b64_tr_b16 v[88:89], v21 offset:24576
v_mfma_f32_16x16x32_bf16 v[172:175], v[116:119], a[180:183], v[172:175]
ds_read_b64_tr_b16 v[90:91], v21 offset:25344
v_mfma_f32_16x16x32_bf16 v[192:195], v[120:123], a[176:179], v[192:195]
buffer_load_dwordx4 v35, s[48:51], s85 offen offset:3072 lds
v_mfma_f32_16x16x32_bf16 v[196:199], v[120:123], a[180:183], v[196:199]
v_mfma_f32_16x16x32_bf16 v[144:147], v[104:107], a[184:187], v[144:147]
ds_read_b64_tr_b16 v[92:93], v21 offset:27648
s_add_u32 m0, s87, 114688
v_mfma_f32_16x16x32_bf16 v[148:151], v[104:107], a[188:191], v[148:151]
ds_read_b64_tr_b16 v[94:95], v21 offset:28416
s_add_u32 s85, s4, 65536
v_mfma_f32_16x16x32_bf16 v[152:155], v[108:111], a[184:187], v[152:155]
ds_read_b64_tr_b16 v[96:97], v22 offset:24576
v_mfma_f32_16x16x32_bf16 v[156:159], v[108:111], a[188:191], v[156:159]
buffer_load_dwordx4 v32, s[48:51], s85 offen lds
v_mfma_f32_16x16x32_bf16 v[176:179], v[112:115], a[184:187], v[176:179]
ds_read_b64_tr_b16 v[98:99], v22 offset:25344
v_mfma_f32_16x16x32_bf16 v[180:183], v[112:115], a[188:191], v[180:183]
ds_read_b64_tr_b16 v[100:101], v22 offset:27648
v_mfma_f32_16x16x32_bf16 v[184:187], v[116:119], a[184:187], v[184:187]
ds_read_b64_tr_b16 v[102:103], v22 offset:28416
v_mfma_f32_16x16x32_bf16 v[188:191], v[116:119], a[188:191], v[188:191]
v_mfma_f32_16x16x32_bf16 v[200:203], v[124:127], a[176:179], v[200:203]
buffer_load_dwordx4 v33, s[48:51], s85 offen offset:1024 lds
v_mfma_f32_16x16x32_bf16 v[204:207], v[124:127], a[180:183], v[204:207]
s_waitcnt lgkmcnt(6)
v_mfma_f32_16x16x32_bf16 v[128:131], v[80:83], a[192:195], v[128:131]
ds_read_b64_tr_b16 v[104:105], v20 offset:36864
v_mfma_f32_16x16x32_bf16 v[132:135], v[80:83], a[196:199], v[132:135]
buffer_load_dwordx4 v34, s[48:51], s85 offen offset:2048 lds
v_mfma_f32_16x16x32_bf16 v[136:139], v[84:87], a[192:195], v[136:139]
ds_read_b64_tr_b16 v[106:107], v20 offset:37632
v_mfma_f32_16x16x32_bf16 v[140:143], v[84:87], a[196:199], v[140:143]
ds_read_b64_tr_b16 v[108:109], v20 offset:39936
v_mfma_f32_16x16x32_bf16 v[160:163], v[88:91], a[192:195], v[160:163]
buffer_load_dwordx4 v35, s[48:51], s85 offen offset:3072 lds
v_mfma_f32_16x16x32_bf16 v[164:167], v[88:91], a[196:199], v[164:167]
ds_read_b64_tr_b16 v[110:111], v20 offset:40704
s_waitcnt lgkmcnt(4)
v_mfma_f32_16x16x32_bf16 v[168:171], v[92:95], a[192:195], v[168:171]
ds_read_b64_tr_b16 v[112:113], v21 offset:36864
s_add_u32 m0, s87, 0
v_mfma_f32_16x16x32_bf16 v[172:175], v[92:95], a[196:199], v[172:175]
ds_read_b64_tr_b16 v[114:115], v21 offset:37632
s_add_u32 s85, s5, 0
v_mfma_f32_16x16x32_bf16 v[192:195], v[96:99], a[192:195], v[192:195]
buffer_load_dwordx4 v32, s[48:51], s85 offen lds
v_mfma_f32_16x16x32_bf16 v[196:199], v[96:99], a[196:199], v[196:199]
v_mfma_f32_16x16x32_bf16 v[144:147], v[80:83], a[200:203], v[144:147]
ds_read_b64_tr_b16 v[116:117], v21 offset:39936
v_mfma_f32_16x16x32_bf16 v[148:151], v[80:83], a[204:207], v[148:151]
ds_read_b64_tr_b16 v[118:119], v21 offset:40704
v_mfma_f32_16x16x32_bf16 v[152:155], v[84:87], a[200:203], v[152:155]
ds_read_b64_tr_b16 v[120:121], v22 offset:36864
v_mfma_f32_16x16x32_bf16 v[156:159], v[84:87], a[204:207], v[156:159]
ds_read_b64_tr_b16 v[122:123], v22 offset:37632
v_mfma_f32_16x16x32_bf16 v[176:179], v[88:91], a[200:203], v[176:179]
ds_read_b64_tr_b16 v[124:125], v22 offset:39936
v_mfma_f32_16x16x32_bf16 v[180:183], v[88:91], a[204:207], v[180:183]
ds_read_b64_tr_b16 v[126:127], v22 offset:40704
v_mfma_f32_16x16x32_bf16 v[184:187], v[92:95], a[200:203], v[184:187]
buffer_load_dwordx4 v33, s[48:51], s85 offen offset:1024 lds
v_mfma_f32_16x16x32_bf16 v[188:191], v[92:95], a[204:207], v[188:191]
v_mfma_f32_16x16x32_bf16 v[200:203], v[100:103], a[192:195], v[200:203]
buffer_load_dwordx4 v34, s[48:51], s85 offen offset:2048 lds
v_mfma_f32_16x16x32_bf16 v[204:207], v[100:103], a[196:199], v[204:207]
s_waitcnt lgkmcnt(0)
v_mfma_f32_16x16x32_bf16 v[128:131], v[104:107], a[208:211], v[128:131]
s_waitcnt vmcnt(15)
s_barrier
ds_read_b64_tr_b16 v[80:81], v23 offset:24576
v_mfma_f32_16x16x32_bf16 v[132:135], v[104:107], a[212:215], v[132:135]
buffer_load_dwordx4 v35, s[48:51], s85 offen offset:3072 lds
v_mfma_f32_16x16x32_bf16 v[136:139], v[108:111], a[208:211], v[136:139]
ds_read_b64_tr_b16 v[82:83], v23 offset:25344
s_add_u32 m0, s87, 16384
v_mfma_f32_16x16x32_bf16 v[140:143], v[108:111], a[212:215], v[140:143]
ds_read_b64_tr_b16 v[84:85], v23 offset:27648
s_add_u32 s85, s5, 32768
v_mfma_f32_16x16x32_bf16 v[160:163], v[112:115], a[208:211], v[160:163]
buffer_load_dwordx4 v32, s[48:51], s85 offen lds
v_mfma_f32_16x16x32_bf16 v[164:167], v[112:115], a[212:215], v[164:167]
ds_read_b64_tr_b16 v[86:87], v23 offset:28416
v_mfma_f32_16x16x32_bf16 v[168:171], v[116:119], a[208:211], v[168:171]
ds_read_b64_tr_b16 v[88:89], v24 offset:24576
v_mfma_f32_16x16x32_bf16 v[172:175], v[116:119], a[212:215], v[172:175]
ds_read_b64_tr_b16 v[90:91], v24 offset:25344
v_mfma_f32_16x16x32_bf16 v[192:195], v[120:123], a[208:211], v[192:195]
buffer_load_dwordx4 v33, s[48:51], s85 offen offset:1024 lds
v_mfma_f32_16x16x32_bf16 v[196:199], v[120:123], a[212:215], v[196:199]
v_mfma_f32_16x16x32_bf16 v[144:147], v[104:107], a[216:219], v[144:147]
ds_read_b64_tr_b16 v[92:93], v24 offset:27648
v_mfma_f32_16x16x32_bf16 v[148:151], v[104:107], a[220:223], v[148:151]
ds_read_b64_tr_b16 v[94:95], v24 offset:28416
v_mfma_f32_16x16x32_bf16 v[152:155], v[108:111], a[216:219], v[152:155]
ds_read_b64_tr_b16 v[96:97], v25 offset:24576
v_mfma_f32_16x16x32_bf16 v[156:159], v[108:111], a[220:223], v[156:159]
buffer_load_dwordx4 v34, s[48:51], s85 offen offset:2048 lds
v_mfma_f32_16x16x32_bf16 v[176:179], v[112:115], a[216:219], v[176:179]
ds_read_b64_tr_b16 v[98:99], v25 offset:25344
v_mfma_f32_16x16x32_bf16 v[180:183], v[112:115], a[220:223], v[180:183]
ds_read_b64_tr_b16 v[100:101], v25 offset:27648
v_mfma_f32_16x16x32_bf16 v[184:187], v[116:119], a[216:219], v[184:187]
ds_read_b64_tr_b16 v[102:103], v25 offset:28416
v_mfma_f32_16x16x32_bf16 v[188:191], v[116:119], a[220:223], v[188:191]
v_mfma_f32_16x16x32_bf16 v[200:203], v[124:127], a[208:211], v[200:203]
buffer_load_dwordx4 v35, s[48:51], s85 offen offset:3072 lds
v_mfma_f32_16x16x32_bf16 v[204:207], v[124:127], a[212:215], v[204:207]
s_waitcnt lgkmcnt(6)
v_mfma_f32_16x16x32_bf16 v[128:131], v[80:83], a[224:227], v[128:131]
ds_read_b64_tr_b16 v[104:105], v23 offset:36864
s_load_dword s68, s[26:27], s14 glc
s_add_u32 m0, s87, 32768
s_add_u32 s85, s5, 65536
v_mfma_f32_16x16x32_bf16 v[132:135], v[80:83], a[228:231], v[132:135]
buffer_load_dwordx4 v32, s[48:51], s85 offen lds
v_mfma_f32_16x16x32_bf16 v[136:139], v[84:87], a[224:227], v[136:139]
ds_read_b64_tr_b16 v[106:107], v23 offset:37632
v_mfma_f32_16x16x32_bf16 v[140:143], v[84:87], a[228:231], v[140:143]
ds_read_b64_tr_b16 v[108:109], v23 offset:39936
v_mfma_f32_16x16x32_bf16 v[160:163], v[88:91], a[224:227], v[160:163]
buffer_load_dwordx4 v33, s[48:51], s85 offen offset:1024 lds
v_mfma_f32_16x16x32_bf16 v[164:167], v[88:91], a[228:231], v[164:167]
ds_read_b64_tr_b16 v[110:111], v23 offset:40704
s_waitcnt lgkmcnt(4)
v_mfma_f32_16x16x32_bf16 v[168:171], v[92:95], a[224:227], v[168:171]
ds_read_b64_tr_b16 v[112:113], v24 offset:36864
v_mfma_f32_16x16x32_bf16 v[172:175], v[92:95], a[228:231], v[172:175]
ds_read_b64_tr_b16 v[114:115], v24 offset:37632
v_mfma_f32_16x16x32_bf16 v[192:195], v[96:99], a[224:227], v[192:195]
buffer_load_dwordx4 v34, s[48:51], s85 offen offset:2048 lds
v_mfma_f32_16x16x32_bf16 v[196:199], v[96:99], a[228:231], v[196:199]
v_mfma_f32_16x16x32_bf16 v[144:147], v[80:83], a[232:235], v[144:147]
s_waitcnt vmcnt(19)
ds_read_b64_tr_b16 v[116:117], v24 offset:39936
ds_read_b64_tr_b16 v[118:119], v24 offset:40704
v_mfma_f32_16x16x32_bf16 v[148:151], v[80:83], a[236:239], v[148:151]
ds_read_b64_tr_b16 v[120:121], v25 offset:36864
ds_read_b64_tr_b16 v[122:123], v25 offset:37632
v_mfma_f32_16x16x32_bf16 v[152:155], v[84:87], a[232:235], v[152:155]
ds_read_b64_tr_b16 v[124:125], v25 offset:39936
ds_read_b64_tr_b16 v[126:127], v25 offset:40704
v_mfma_f32_16x16x32_bf16 v[156:159], v[84:87], a[236:239], v[156:159]
ds_read_b64_tr_b16 a[64:65], v40 offset:49152
v_mfma_f32_16x16x32_bf16 v[176:179], v[88:91], a[232:235], v[176:179]
ds_read_b64_tr_b16 a[66:67], v40 offset:50176
v_mfma_f32_16x16x32_bf16 v[180:183], v[88:91], a[236:239], v[180:183]
ds_read_b64_tr_b16 a[68:69], v13 offset:49152
v_mfma_f32_16x16x32_bf16 v[184:187], v[92:95], a[232:235], v[184:187]
buffer_load_dwordx4 v35, s[48:51], s85 offen offset:3072 lds
v_mfma_f32_16x16x32_bf16 v[188:191], v[92:95], a[236:239], v[188:191]
ds_read_b64_tr_b16 a[70:71], v13 offset:50176
s_add_u32 m0, s87, 65536
s_add_u32 s85, s6, 0
v_mfma_f32_16x16x32_bf16 v[200:203], v[100:103], a[224:227], v[200:203]
buffer_load_dwordx4 v32, s[48:51], s85 offen lds
v_mfma_f32_16x16x32_bf16 v[204:207], v[100:103], a[228:231], v[204:207]
ds_read_b32 v47, v43
s_waitcnt lgkmcnt(1)
v_mfma_f32_16x16x32_bf16 v[128:131], v[104:107], a[240:243], v[128:131]
s_barrier
ds_read_b64_tr_b16 a[72:73], v40 offset:49408
v_mfma_f32_16x16x32_bf16 v[132:135], v[104:107], a[244:247], v[132:135]
buffer_load_dwordx4 v33, s[48:51], s85 offen offset:1024 lds
v_mfma_f32_16x16x32_bf16 v[136:139], v[108:111], a[240:243], v[136:139]
ds_read_b64_tr_b16 a[74:75], v40 offset:50432
v_mfma_f32_16x16x32_bf16 v[140:143], v[108:111], a[244:247], v[140:143]
ds_read_b64_tr_b16 a[76:77], v13 offset:49408
v_mfma_f32_16x16x32_bf16 v[160:163], v[112:115], a[240:243], v[160:163]
buffer_load_dwordx4 v34, s[48:51], s85 offen offset:2048 lds
v_mfma_f32_16x16x32_bf16 v[164:167], v[112:115], a[244:247], v[164:167]
ds_read_b64_tr_b16 a[78:79], v13 offset:50432
v_mfma_f32_16x16x32_bf16 v[168:171], v[116:119], a[240:243], v[168:171]
v_mfma_f32_16x16x32_bf16 v[172:175], v[116:119], a[244:247], v[172:175]
v_mfma_f32_16x16x32_bf16 v[192:195], v[120:123], a[240:243], v[192:195]
buffer_load_dwordx4 v35, s[48:51], s85 offen offset:3072 lds
v_mfma_f32_16x16x32_bf16 v[196:199], v[120:123], a[244:247], v[196:199]
v_mfma_f32_16x16x32_bf16 v[144:147], v[104:107], a[248:251], v[144:147]
s_waitcnt vmcnt(20)
ds_read_b64_tr_b16 a[80:81], v42 offset:0
s_add_u32 m0, s87, 81920
v_mfma_f32_16x16x32_bf16 v[148:151], v[104:107], a[252:255], v[148:151]
ds_read_b64_tr_b16 a[82:83], v42 offset:1024
s_add_u32 s85, s6, 32768
v_mfma_f32_16x16x32_bf16 v[152:155], v[108:111], a[248:251], v[152:155]
ds_read_b64_tr_b16 a[84:85], v15 offset:0
v_mfma_f32_16x16x32_bf16 v[156:159], v[108:111], a[252:255], v[156:159]
buffer_load_dwordx4 v32, s[48:51], s85 offen lds
v_mfma_f32_16x16x32_bf16 v[176:179], v[112:115], a[248:251], v[176:179]
ds_read_b64_tr_b16 a[86:87], v15 offset:1024
v_mfma_f32_16x16x32_bf16 v[180:183], v[112:115], a[252:255], v[180:183]
v_mfma_f32_16x16x32_bf16 v[184:187], v[116:119], a[248:251], v[184:187]
v_mfma_f32_16x16x32_bf16 v[188:191], v[116:119], a[252:255], v[188:191]
v_mfma_f32_16x16x32_bf16 v[200:203], v[124:127], a[240:243], v[200:203]
buffer_load_dwordx4 v33, s[48:51], s85 offen offset:1024 lds
v_mfma_f32_16x16x32_bf16 v[204:207], v[124:127], a[244:247], v[204:207]
s_lshl_b32 s90, s76, 1
s_add_u32 s90, s90, s95
s_lshl_b32 s90, s90, 11
s_add_u32 s90, s90, s94
s_lshl_b32 s91, s76, 10
s_add_u32 s84, s90, s91
s_xor_b32 s83, s84, 1024
s_add_u32 s90, s95, 4
s_lshl_b32 s90, s90, 11
s_add_u32 s90, s90, s94
s_add_u32 s82, s90, s91
s_waitcnt lgkmcnt(0)
s_bfe_u32 s97, s68, 524288
s_cmp_lt_u32 s97, 4
s_cbranch_scc1 L_slow_KH1
L_back_KH1:
v_pk_mul_f32 v[80:81], v[128:129], v[128:129]
v_pk_mul_f32 v[82:83], v[130:131], v[130:131]
v_pk_mul_f32 v[84:85], v[132:133], v[132:133]
v_pk_mul_f32 v[86:87], v[134:135], v[134:135]
v_pk_fma_f32 v[80:81], v[80:81], v[48:49], v[48:49] op_sel:[0,0,1] op_sel_hi:[1,0,1]
v_pk_fma_f32 v[82:83], v[82:83], v[48:49], v[48:49] op_sel:[0,0,1] op_sel_hi:[1,0,1]
v_pk_fma_f32 v[84:85], v[84:85], v[48:49], v[48:49] op_sel:[0,0,1] op_sel_hi:[1,0,1]
v_pk_fma_f32 v[86:87], v[86:87], v[48:49], v[48:49] op_sel:[0,0,1] op_sel_hi:[1,0,1]
v_pk_mul_f32 v[80:81], v[80:81], v[128:129]
v_pk_mul_f32 v[82:83], v[82:83], v[130:131]
v_pk_mul_f32 v[84:85], v[84:85], v[132:133]
v_pk_mul_f32 v[86:87], v[86:87], v[134:135]
v_exp_f32_e64 v80, v80
buffer_load_dwordx4 v34, s[48:51], s85 offen offset:2048 lds
v_exp_f32_e64 v81, v81
v_pk_mul_f32 v[88:89], v[128:129], v[136:137]
v_exp_f32 v82, v82
v_exp_f32 v83, v83
v_pk_mul_f32 v[90:91], v[130:131], v[138:139]
v_exp_f32 v84, v84
v_exp_f32 v85, v85
v_pk_mul_f32 v[92:93], v[132:133], v[140:141]
v_exp_f32 v86, v86
v_exp_f32 v87, v87
buffer_load_dwordx4 v35, s[48:51], s85 offen offset:3072 lds
v_pk_mul_f32 v[94:95], v[134:135], v[142:143]
v_pk_add_f32 v[80:81], v[80:81], 1.0 op_sel_hi:[1,0]
v_pk_add_f32 v[82:83], v[82:83], 1.0 op_sel_hi:[1,0]
v_pk_add_f32 v[84:85], v[84:85], 1.0 op_sel_hi:[1,0]
v_pk_add_f32 v[86:87], v[86:87], 1.0 op_sel_hi:[1,0]
v_rcp_f32 v80, v80
v_rcp_f32 v81, v81
v_rcp_f32 v82, v82
v_rcp_f32 v83, v83
v_rcp_f32_e64 v84, v84
v_rcp_f32 v85, v85
s_add_u32 s86, s8, 0
buffer_load_dwordx4 a[96:99], v77, s[52:55], s86 offen offset:0 sc1
v_rcp_f32 v86, v86
v_rcp_f32 v87, v87
v_pk_mul_f32 v[88:89], v[88:89], v[80:81]
v_pk_mul_f32 v[90:91], v[90:91], v[82:83]
v_pk_mul_f32 v[92:93], v[92:93], v[84:85]
v_pk_mul_f32 v[94:95], v[94:95], v[86:87]
v_cvt_pk_bf16_f32 v128, v88, v89
v_cvt_pk_bf16_f32 v129, v90, v91
v_cvt_pk_bf16_f32 v130, v92, v93
v_cvt_pk_bf16_f32 v131, v94, v95
ds_read_b64_tr_b16 a[88:89], v42 offset:256
ds_read_b64_tr_b16 a[90:91], v42 offset:1280
ds_read_b64_tr_b16 a[92:93], v15 offset:256
ds_read_b64_tr_b16 a[94:95], v15 offset:1280
v_pk_mul_f32 v[80:81], v[144:145], v[144:145]
v_pk_mul_f32 v[82:83], v[146:147], v[146:147]
v_pk_mul_f32 v[84:85], v[148:149], v[148:149]
v_pk_mul_f32 v[86:87], v[150:151], v[150:151]
buffer_load_dwordx4 a[100:103], v77, s[52:55], s86 offen offset:256 sc1
v_pk_fma_f32 v[80:81], v[80:81], v[48:49], v[48:49] op_sel:[0,0,1] op_sel_hi:[1,0,1]
v_pk_fma_f32 v[82:83], v[82:83], v[48:49], v[48:49] op_sel:[0,0,1] op_sel_hi:[1,0,1]
v_pk_fma_f32 v[84:85], v[84:85], v[48:49], v[48:49] op_sel:[0,0,1] op_sel_hi:[1,0,1]
v_pk_fma_f32 v[86:87], v[86:87], v[48:49], v[48:49] op_sel:[0,0,1] op_sel_hi:[1,0,1]
v_pk_mul_f32 v[80:81], v[80:81], v[144:145]
v_pk_mul_f32 v[82:83], v[82:83], v[146:147]
v_pk_mul_f32 v[84:85], v[84:85], v[148:149]
v_pk_mul_f32 v[86:87], v[86:87], v[150:151]
v_exp_f32 v80, v80
v_exp_f32 v81, v81
v_pk_mul_f32 v[88:89], v[144:145], v[152:153]
v_exp_f32 v82, v82
v_exp_f32 v83, v83
buffer_load_dwordx4 a[104:107], v77, s[52:55], s86 offen offset:1024 sc1
v_pk_mul_f32 v[90:91], v[146:147], v[154:155]
v_exp_f32 v84, v84
v_exp_f32 v85, v85
v_pk_mul_f32 v[92:93], v[148:149], v[156:157]
v_exp_f32 v86, v86
v_exp_f32 v87, v87
v_pk_mul_f32 v[94:95], v[150:151], v[158:159]
v_pk_add_f32 v[80:81], v[80:81], 1.0 op_sel_hi:[1,0]
v_pk_add_f32 v[82:83], v[82:83], 1.0 op_sel_hi:[1,0]
L_pad_KH_4:
s_cbranch_execz L_pad_KH_5
s_nop 0
v_pk_add_f32 v[84:85], v[84:85], 1.0 op_sel_hi:[1,0]
v_pk_add_f32 v[86:87], v[86:87], 1.0 op_sel_hi:[1,0]
v_rcp_f32_e64 v80, v80
buffer_load_dwordx4 a[108:111], v77, s[52:55], s86 offen offset:1280 sc1
v_rcp_f32 v81, v81
v_rcp_f32 v82, v82
v_rcp_f32 v83, v83
v_rcp_f32 v84, v84
v_rcp_f32 v85, v85
v_rcp_f32 v86, v86
v_rcp_f32_e64 v87, v87
v_pk_mul_f32 v[88:89], v[88:89], v[80:81]
v_pk_mul_f32 v[90:91], v[90:91], v[82:83]
s_add_u32 s86, s8, 4096
buffer_load_dwordx4 a[112:115], v77, s[52:55], s86 offen offset:0 sc1
v_pk_mul_f32 v[92:93], v[92:93], v[84:85]
v_pk_mul_f32 v[94:95], v[94:95], v[86:87]
v_cvt_pk_bf16_f32 v144, v88, v89
v_cvt_pk_bf16_f32 v145, v90, v91
v_cvt_pk_bf16_f32 v146, v92, v93
v_cvt_pk_bf16_f32 v147, v94, v95
s_waitcnt lgkmcnt(0)
v_pk_mul_f32 v[80:81], v[160:161], v[160:161]
v_pk_mul_f32 v[82:83], v[162:163], v[162:163]
v_pk_mul_f32 v[84:85], v[164:165], v[164:165]
v_pk_mul_f32 v[86:87], v[166:167], v[166:167]
v_pk_fma_f32 v[80:81], v[80:81], v[48:49], v[48:49] op_sel:[0,0,1] op_sel_hi:[1,0,1]
v_pk_fma_f32 v[82:83], v[82:83], v[48:49], v[48:49] op_sel:[0,0,1] op_sel_hi:[1,0,1]
v_pk_fma_f32 v[84:85], v[84:85], v[48:49], v[48:49] op_sel:[0,0,1] op_sel_hi:[1,0,1]
v_pk_fma_f32 v[86:87], v[86:87], v[48:49], v[48:49] op_sel:[0,0,1] op_sel_hi:[1,0,1]
v_pk_mul_f32 v[80:81], v[80:81], v[160:161]
v_pk_mul_f32 v[82:83], v[82:83], v[162:163]
buffer_load_dwordx4 a[116:119], v77, s[52:55], s86 offen offset:256 sc1
v_pk_mul_f32 v[84:85], v[84:85], v[164:165]
v_pk_mul_f32 v[86:87], v[86:87], v[166:167]
v_exp_f32 v80, v80
v_exp_f32_e64 v81, v81
v_pk_mul_f32 v[88:89], v[160:161], v[168:169]
v_exp_f32 v82, v82
v_exp_f32 v83, v83
v_pk_mul_f32 v[90:91], v[162:163], v[170:171]
v_exp_f32 v84, v84
v_exp_f32 v85, v85
buffer_load_dwordx4 a[120:123], v77, s[52:55], s86 offen offset:1024 sc1
v_pk_mul_f32 v[92:93], v[164:165], v[172:173]
v_exp_f32 v86, v86
v_exp_f32 v87, v87
v_pk_mul_f32 v[94:95], v[166:167], v[174:175]
v_pk_add_f32 v[80:81], v[80:81], 1.0 op_sel_hi:[1,0]
v_pk_add_f32 v[82:83], v[82:83], 1.0 op_sel_hi:[1,0]
v_pk_add_f32 v[84:85], v[84:85], 1.0 op_sel_hi:[1,0]
v_pk_add_f32 v[86:87], v[86:87], 1.0 op_sel_hi:[1,0]
v_rcp_f32 v80, v80
v_rcp_f32 v81, v81
v_rcp_f32_e64 v82, v82
buffer_load_dwordx4 a[124:127], v77, s[52:55], s86 offen offset:1280 sc1
v_rcp_f32 v83, v83
v_rcp_f32 v84, v84
v_rcp_f32 v85, v85
v_rcp_f32 v86, v86
v_rcp_f32_e64 v87, v87
v_pk_mul_f32 v[88:89], v[88:89], v[80:81]
v_pk_mul_f32 v[90:91], v[90:91], v[82:83]
v_pk_mul_f32 v[92:93], v[92:93], v[84:85]
v_pk_mul_f32 v[94:95], v[94:95], v[86:87]
v_cvt_pk_bf16_f32 v160, v88, v89
v_cvt_pk_bf16_f32 v161, v90, v91
s_add_u32 s86, s8, 8192
buffer_load_dwordx4 a[128:131], v77, s[52:55], s86 offen offset:0 sc1
v_cvt_pk_bf16_f32 v162, v92, v93
v_cvt_pk_bf16_f32 v163, v94, v95
v_pk_mul_f32 v[80:81], v[176:177], v[176:177]
v_pk_mul_f32 v[82:83], v[178:179], v[178:179]
v_pk_mul_f32 v[84:85], v[180:181], v[180:181]
v_pk_mul_f32 v[86:87], v[182:183], v[182:183]
v_pk_fma_f32 v[80:81], v[80:81], v[48:49], v[48:49] op_sel:[0,0,1] op_sel_hi:[1,0,1]
v_pk_fma_f32 v[82:83], v[82:83], v[48:49], v[48:49] op_sel:[0,0,1] op_sel_hi:[1,0,1]
v_pk_fma_f32 v[84:85], v[84:85], v[48:49], v[48:49] op_sel:[0,0,1] op_sel_hi:[1,0,1]
v_pk_fma_f32 v[86:87], v[86:87], v[48:49], v[48:49] op_sel:[0,0,1] op_sel_hi:[1,0,1]
v_pk_mul_f32 v[80:81], v[80:81], v[176:177]
v_pk_mul_f32 v[82:83], v[82:83], v[178:179]
v_pk_mul_f32 v[84:85], v[84:85], v[180:181]
v_pk_mul_f32 v[86:87], v[86:87], v[182:183]
v_exp_f32_e64 v80, v80
buffer_load_dwordx4 a[132:135], v77, s[52:55], s86 offen offset:256 sc1
v_exp_f32_e64 v81, v81
v_pk_mul_f32 v[88:89], v[176:177], v[184:185]
v_exp_f32 v82, v82
v_exp_f32 v83, v83
v_pk_mul_f32 v[90:91], v[178:179], v[186:187]
v_exp_f32 v84, v84
v_exp_f32 v85, v85
v_pk_mul_f32 v[92:93], v[180:181], v[188:189]
v_exp_f32 v86, v86
v_exp_f32 v87, v87
buffer_load_dwordx4 a[136:139], v77, s[52:55], s86 offen offset:1024 sc1
v_pk_mul_f32 v[94:95], v[182:183], v[190:191]
v_pk_add_f32 v[80:81], v[80:81], 1.0 op_sel_hi:[1,0]
v_pk_add_f32 v[82:83], v[82:83], 1.0 op_sel_hi:[1,0]
v_pk_add_f32 v[84:85], v[84:85], 1.0 op_sel_hi:[1,0]
v_pk_add_f32 v[86:87], v[86:87], 1.0 op_sel_hi:[1,0]
v_rcp_f32 v80, v80
v_rcp_f32 v81, v81
v_rcp_f32 v82, v82
v_rcp_f32 v83, v83
v_rcp_f32 v84, v84
v_rcp_f32 v85, v85
buffer_load_dwordx4 a[140:143], v77, s[52:55], s86 offen offset:1280 sc1
v_rcp_f32 v86, v86
v_rcp_f32 v87, v87
v_pk_mul_f32 v[88:89], v[88:89], v[80:81]
v_pk_mul_f32 v[90:91], v[90:91], v[82:83]
v_pk_mul_f32 v[92:93], v[92:93], v[84:85]
v_pk_mul_f32 v[94:95], v[94:95], v[86:87]
v_cvt_pk_bf16_f32 v176, v88, v89
v_cvt_pk_bf16_f32 v177, v90, v91
v_cvt_pk_bf16_f32 v178, v92, v93
v_cvt_pk_bf16_f32 v179, v94, v95
v_pk_mul_f32 v[80:81], v[192:193], v[192:193]
v_pk_mul_f32 v[82:83], v[194:195], v[194:195]
v_pk_mul_f32 v[84:85], v[196:197], v[196:197]
v_pk_mul_f32 v[86:87], v[198:199], v[198:199]
s_add_u32 s86, s9, 0
buffer_load_dwordx4 a[144:147], v77, s[52:55], s86 offen offset:0 sc1
v_pk_fma_f32 v[80:81], v[80:81], v[48:49], v[48:49] op_sel:[0,0,1] op_sel_hi:[1,0,1]
v_pk_fma_f32 v[82:83], v[82:83], v[48:49], v[48:49] op_sel:[0,0,1] op_sel_hi:[1,0,1]
v_pk_fma_f32 v[84:85], v[84:85], v[48:49], v[48:49] op_sel:[0,0,1] op_sel_hi:[1,0,1]
v_pk_fma_f32 v[86:87], v[86:87], v[48:49], v[48:49] op_sel:[0,0,1] op_sel_hi:[1,0,1]
v_pk_mul_f32 v[80:81], v[80:81], v[192:193]
v_pk_mul_f32 v[82:83], v[82:83], v[194:195]
v_pk_mul_f32 v[84:85], v[84:85], v[196:197]
v_pk_mul_f32 v[86:87], v[86:87], v[198:199]
v_exp_f32 v80, v80
v_exp_f32_e64 v81, v81
v_pk_mul_f32 v[88:89], v[192:193], v[200:201]
v_exp_f32 v82, v82
v_exp_f32 v83, v83
buffer_load_dwordx4 a[148:151], v77, s[52:55], s86 offen offset:256 sc1
v_pk_mul_f32 v[90:91], v[194:195], v[202:203]
v_exp_f32 v84, v84
v_exp_f32 v85, v85
v_pk_mul_f32 v[92:93], v[196:197], v[204:205]
v_exp_f32 v86, v86
v_exp_f32 v87, v87
v_pk_mul_f32 v[94:95], v[198:199], v[206:207]
v_pk_add_f32 v[80:81], v[80:81], 1.0 op_sel_hi:[1,0]
v_pk_add_f32 v[82:83], v[82:83], 1.0 op_sel_hi:[1,0]
v_pk_add_f32 v[84:85], v[84:85], 1.0 op_sel_hi:[1,0]
v_pk_add_f32 v[86:87], v[86:87], 1.0 op_sel_hi:[1,0]
v_rcp_f32 v80, v80
v_rcp_f32 v81, v81
v_rcp_f32 v82, v82
v_rcp_f32 v83, v83
v_rcp_f32 v84, v84
v_rcp_f32 v85, v85
v_rcp_f32 v86, v86
v_rcp_f32 v87, v87
v_pk_mul_f32 v[88:89], v[88:89], v[80:81]
v_pk_mul_f32 v[90:91], v[90:91], v[82:83]
v_pk_mul_f32 v[92:93], v[92:93], v[84:85]
v_pk_mul_f32 v[94:95], v[94:95], v[86:87]
v_cvt_pk_bf16_f32 v192, v88, v89
v_cvt_pk_bf16_f32 v193, v90, v91
v_cvt_pk_bf16_f32 v194, v92, v93
v_cvt_pk_bf16_f32 v195, v94, v95
v_permlane16_swap_b32 v128, v130
v_permlane16_swap_b32 v129, v131
buffer_store_dwordx4 v[128:131], v38, s[52:55], s84 offen offset:0 sc1
v_permlane16_swap_b32 v144, v146
v_permlane16_swap_b32 v145, v147
buffer_store_dwordx4 v[144:147], v38, s[52:55], s83 offen offset:0 sc1
v_permlane16_swap_b32 v160, v162
v_permlane16_swap_b32 v161, v163
buffer_store_dwordx4 v[160:163], v38, s[52:55], s84 offen offset:2048 sc1
v_permlane16_swap_b32 v176, v178
v_permlane16_swap_b32 v177, v179
buffer_store_dwordx4 v[176:179], v38, s[52:55], s83 offen offset:2048 sc1
v_permlane16_swap_b32 v192, v194
v_permlane16_swap_b32 v193, v195
buffer_store_dwordx4 v[192:195], v38, s[52:55], s82 offen offset:0 sc1
s_waitcnt vmcnt(18)
v_mfma_f32_16x16x32_bf16 v[128:131], a[64:67], a[96:99], 0
s_waitcnt vmcnt(17)
v_mfma_f32_16x16x32_bf16 v[144:147], a[64:67], a[100:103], 0
v_mfma_f32_16x16x32_bf16 v[132:135], a[68:71], a[96:99], 0
buffer_load_dwordx4 a[152:155], v77, s[52:55], s86 offen offset:1024 sc1
v_mfma_f32_16x16x32_bf16 v[148:151], a[68:71], a[100:103], 0
v_mfma_f32_16x16x32_bf16 v[136:139], a[72:75], a[96:99], 0
v_mfma_f32_16x16x32_bf16 v[152:155], a[72:75], a[100:103], 0
v_mfma_f32_16x16x32_bf16 v[140:143], a[76:79], a[96:99], 0
buffer_load_dwordx4 a[156:159], v77, s[52:55], s86 offen offset:1280 sc1
v_mfma_f32_16x16x32_bf16 v[156:159], a[76:79], a[100:103], 0
v_and_b32 v72, 15, v1
v_lshrrev_b32 v73, 4, v1
v_xor_b32_e64 v73, v73, v1
v_and_b32 v73, 7, v73
s_waitcnt vmcnt(18)
v_mfma_f32_16x16x32_bf16 v[160:163], a[64:67], a[104:107], 0
s_add_u32 s86, s9, 4096
s_waitcnt vmcnt(17)
v_mfma_f32_16x16x32_bf16 v[176:179], a[64:67], a[108:111], 0
v_mfma_f32_16x16x32_bf16 v[164:167], a[68:71], a[104:107], 0
buffer_load_dwordx4 a[160:163], v77, s[52:55], s86 offen offset:0 sc1
v_mfma_f32_16x16x32_bf16 v[180:183], a[68:71], a[108:111], 0
v_mfma_f32_16x16x32_bf16 v[168:171], a[72:75], a[104:107], 0
v_mfma_f32_16x16x32_bf16 v[184:187], a[72:75], a[108:111], 0
v_mfma_f32_16x16x32_bf16 v[172:175], a[76:79], a[104:107], 0
buffer_load_dwordx4 a[164:167], v77, s[52:55], s86 offen offset:256 sc1
v_mfma_f32_16x16x32_bf16 v[188:191], a[76:79], a[108:111], 0
v_lshlrev_b32 v73, 4, v73
v_lshl_add_u32 v72, v72, 8, v73
v_add_u32_e64 v112, s87, v72
v_xor_b32 v113, 64, v112
s_waitcnt vmcnt(18)
v_mfma_f32_16x16x32_bf16 v[128:131], a[80:83], a[112:115], v[128:131]
ds_read_b64_tr_b16 v[80:81], v41 offset:49152
s_waitcnt vmcnt(17)
v_mfma_f32_16x16x32_bf16 v[144:147], a[80:83], a[116:119], v[144:147]
ds_read_b64_tr_b16 v[82:83], v41 offset:50176
v_mfma_f32_16x16x32_bf16 v[132:135], a[84:87], a[112:115], v[132:135]
buffer_load_dwordx4 a[168:171], v77, s[52:55], s86 offen offset:1024 sc1
v_mfma_f32_16x16x32_bf16 v[148:151], a[84:87], a[116:119], v[148:151]
ds_read_b64_tr_b16 v[84:85], v14 offset:49152
v_mfma_f32_16x16x32_bf16 v[136:139], a[88:91], a[112:115], v[136:139]
ds_read_b64_tr_b16 v[86:87], v14 offset:50176
v_mfma_f32_16x16x32_bf16 v[152:155], a[88:91], a[116:119], v[152:155]
v_mfma_f32_16x16x32_bf16 v[140:143], a[92:95], a[112:115], v[140:143]
buffer_load_dwordx4 a[172:175], v77, s[52:55], s86 offen offset:1280 sc1
v_mfma_f32_16x16x32_bf16 v[156:159], a[92:95], a[116:119], v[156:159]
v_lshlrev_b32 v75, 2, v1
v_lshrrev_b32 v72, 3, v0
v_and_b32 v73, 7, v0
v_lshlrev_b32 v74, 10, v72
s_waitcnt vmcnt(18)
v_mfma_f32_16x16x32_bf16 v[160:163], a[80:83], a[120:123], v[160:163]
ds_read_b64_tr_b16 v[88:89], v41 offset:49408
v_lshl_add_u32 v118, v73, 4, v74
s_waitcnt vmcnt(17)
v_mfma_f32_16x16x32_bf16 v[176:179], a[80:83], a[124:127], v[176:179]
ds_read_b64_tr_b16 v[90:91], v41 offset:50432
v_lshlrev_b32 v73, 1, v73
v_mfma_f32_16x16x32_bf16 v[164:167], a[84:87], a[120:123], v[164:167]
ds_read_b64_tr_b16 v[92:93], v14 offset:49408
v_and_b32_e64 v74, 7, v72
v_mfma_f32_16x16x32_bf16 v[180:183], a[84:87], a[124:127], v[180:183]
ds_read_b64_tr_b16 v[94:95], v14 offset:50432
v_xor_b32_e64 v73, v73, v74
v_mfma_f32_16x16x32_bf16 v[168:171], a[88:91], a[120:123], v[168:171]
v_mfma_f32_16x16x32_bf16 v[184:187], a[88:91], a[124:127], v[184:187]
v_mfma_f32_16x16x32_bf16 v[172:175], a[92:95], a[120:123], v[172:175]
v_mfma_f32_16x16x32_bf16 v[188:191], a[92:95], a[124:127], v[188:191]
s_waitcnt lgkmcnt(4)
s_waitcnt vmcnt(16)
v_mfma_f32_16x16x32_bf16 v[128:131], v[80:83], a[128:131], v[128:131]
ds_read_b64_tr_b16 v[96:97], v40 offset:0
s_waitcnt vmcnt(15)
v_mfma_f32_16x16x32_bf16 v[144:147], v[80:83], a[132:135], v[144:147]
ds_read_b64_tr_b16 v[98:99], v40 offset:1024
v_and_b32 v74, 15, v72
v_mfma_f32_16x16x32_bf16 v[132:135], v[84:87], a[128:131], v[132:135]
ds_read_b64_tr_b16 v[100:101], v13 offset:0
v_lshlrev_b32_e64 v74, 8, v74
v_mfma_f32_16x16x32_bf16 v[148:151], v[84:87], a[132:135], v[148:151]
ds_read_b64_tr_b16 v[102:103], v13 offset:1024
s_waitcnt lgkmcnt(4)
v_mfma_f32_16x16x32_bf16 v[136:139], v[88:91], a[128:131], v[136:139]
v_lshl_add_u32 v73, v73, 4, v74
v_lshrrev_b32 v72, 4, v72
v_mfma_f32_16x16x32_bf16 v[152:155], v[88:91], a[132:135], v[152:155]
v_mfma_f32_16x16x32_bf16 v[140:143], v[92:95], a[128:131], v[140:143]
v_mfma_f32_16x16x32_bf16 v[156:159], v[92:95], a[132:135], v[156:159]
s_waitcnt vmcnt(14)
v_mfma_f32_16x16x32_bf16 v[160:163], v[80:83], a[136:139], v[160:163]
ds_read_b64_tr_b16 v[104:105], v40 offset:256
v_lshl_add_u32 v116, v72, 14, v73
s_waitcnt vmcnt(13)
v_mfma_f32_16x16x32_bf16 v[176:179], v[80:83], a[140:143], v[176:179]
ds_read_b64_tr_b16 v[106:107], v40 offset:1280
v_xor_b32_e64 v117, 16, v116
v_mfma_f32_16x16x32_bf16 v[164:167], v[84:87], a[136:139], v[164:167]
ds_read_b64_tr_b16 v[108:109], v13 offset:256
s_lshl_b32 s90, s77, 16
v_mfma_f32_16x16x32_bf16 v[180:183], v[84:87], a[140:143], v[180:183]
ds_read_b64_tr_b16 v[110:111], v13 offset:1280
s_lshl_b32 s91, s78, 7
v_mfma_f32_16x16x32_bf16 v[168:171], v[88:91], a[136:139], v[168:171]
v_mfma_f32_16x16x32_bf16 v[184:187], v[88:91], a[140:143], v[184:187]
v_mfma_f32_16x16x32_bf16 v[172:175], v[92:95], a[136:139], v[172:175]
v_mfma_f32_16x16x32_bf16 v[188:191], v[92:95], a[140:143], v[188:191]
s_waitcnt lgkmcnt(4)
s_waitcnt vmcnt(12)
v_mfma_f32_16x16x32_bf16 v[128:131], v[96:99], a[144:147], v[128:131]
ds_read_b64_tr_b16 v[80:81], v40 offset:16384
s_waitcnt vmcnt(11)
v_mfma_f32_16x16x32_bf16 v[144:147], v[96:99], a[148:151], v[144:147]
ds_read_b64_tr_b16 v[82:83], v40 offset:17408
s_waitcnt vmcnt(6)
s_atomic_add s70, s[26:27], s17
s_add_u32 s86, s9, 8192
v_mfma_f32_16x16x32_bf16 v[132:135], v[100:103], a[144:147], v[132:135]
buffer_load_dwordx4 a[176:179], v77, s[52:55], s86 offen offset:0 sc1
v_mfma_f32_16x16x32_bf16 v[148:151], v[100:103], a[148:151], v[148:151]
ds_read_b64_tr_b16 v[84:85], v13 offset:16384
s_waitcnt lgkmcnt(3)
v_mfma_f32_16x16x32_bf16 v[136:139], v[104:107], a[144:147], v[136:139]
ds_read_b64_tr_b16 v[86:87], v13 offset:17408
v_mfma_f32_16x16x32_bf16 v[152:155], v[104:107], a[148:151], v[152:155]
ds_read_b32 v47, v43
v_mfma_f32_16x16x32_bf16 v[140:143], v[108:111], a[144:147], v[140:143]
buffer_load_dwordx4 a[180:183], v77, s[52:55], s86 offen offset:256 sc1
v_mfma_f32_16x16x32_bf16 v[156:159], v[108:111], a[148:151], v[156:159]
s_add_u32 s90, s90, s91
s_add_u32 s91, s90, 32768
s_lshl_b32 s93, s77, 8
s_add_u32 s93, s93, 8454144
s_waitcnt vmcnt(7)
v_mfma_f32_16x16x32_bf16 v[160:163], v[96:99], a[152:155], v[160:163]
ds_read_b64_tr_b16 v[88:89], v40 offset:16640
s_waitcnt vmcnt(6)
v_mfma_f32_16x16x32_bf16 v[176:179], v[96:99], a[156:159], v[176:179]
ds_read_b64_tr_b16 v[90:91], v40 offset:17664
v_mfma_f32_16x16x32_bf16 v[164:167], v[100:103], a[152:155], v[164:167]
buffer_load_dwordx4 a[184:187], v77, s[52:55], s86 offen offset:1024 sc1
v_mfma_f32_16x16x32_bf16 v[180:183], v[100:103], a[156:159], v[180:183]
ds_read_b64_tr_b16 v[92:93], v13 offset:16640
v_mfma_f32_16x16x32_bf16 v[168:171], v[104:107], a[152:155], v[168:171]
ds_read_b64_tr_b16 v[94:95], v13 offset:17664
v_mfma_f32_16x16x32_bf16 v[184:187], v[104:107], a[156:159], v[184:187]
ds_read_b32 v47, v43
v_mfma_f32_16x16x32_bf16 v[172:175], v[108:111], a[152:155], v[172:175]
buffer_load_dwordx4 a[188:191], v77, s[52:55], s86 offen offset:1280 sc1
v_mfma_f32_16x16x32_bf16 v[188:191], v[108:111], a[156:159], v[188:191]
s_waitcnt lgkmcnt(5)
s_waitcnt vmcnt(7)
v_mfma_f32_16x16x32_bf16 v[128:131], v[80:83], a[160:163], v[128:131]
ds_read_b64_tr_b16 v[96:97], v40 offset:32768
s_waitcnt vmcnt(6)
v_mfma_f32_16x16x32_bf16 v[144:147], v[80:83], a[164:167], v[144:147]
ds_read_b64_tr_b16 v[98:99], v40 offset:33792
s_load_dword s68, s[26:27], s14 glc
s_add_u32 m0, s87, 131072
s_add_u32 s85, s18, 65536
v_mfma_f32_16x16x32_bf16 v[132:135], v[84:87], a[160:163], v[132:135]
buffer_load_dwordx4 v32, s[48:51], s85 offen lds
v_mfma_f32_16x16x32_bf16 v[148:151], v[84:87], a[164:167], v[148:151]
ds_read_b64_tr_b16 v[100:101], v13 offset:32768
s_waitcnt lgkmcnt(3)
v_mfma_f32_16x16x32_bf16 v[136:139], v[88:91], a[160:163], v[136:139]
ds_read_b64_tr_b16 v[102:103], v13 offset:33792
v_mfma_f32_16x16x32_bf16 v[152:155], v[88:91], a[164:167], v[152:155]
ds_read_b32 v47, v43
v_mfma_f32_16x16x32_bf16 v[140:143], v[92:95], a[160:163], v[140:143]
buffer_load_dwordx4 v33, s[48:51], s85 offen offset:1024 lds
v_mfma_f32_16x16x32_bf16 v[156:159], v[92:95], a[164:167], v[156:159]
ds_read_b32 v47, v43
s_waitcnt vmcnt(7)
v_mfma_f32_16x16x32_bf16 v[160:163], v[80:83], a[168:171], v[160:163]
ds_read_b64_tr_b16 v[104:105], v40 offset:33024
s_add_u32 s85, s19, 49152
s_waitcnt vmcnt(6)
v_mfma_f32_16x16x32_bf16 v[176:179], v[80:83], a[172:175], v[176:179]
ds_read_b64_tr_b16 v[106:107], v40 offset:34048
v_mfma_f32_16x16x32_bf16 v[164:167], v[84:87], a[168:171], v[164:167]
buffer_load_dwordx4 v36, s[48:51], s85 offen offset:2048 lds
v_mfma_f32_16x16x32_bf16 v[180:183], v[84:87], a[172:175], v[180:183]
ds_read_b64_tr_b16 v[108:109], v13 offset:33024
v_mfma_f32_16x16x32_bf16 v[168:171], v[88:91], a[168:171], v[168:171]
ds_read_b64_tr_b16 v[110:111], v13 offset:34048
v_mfma_f32_16x16x32_bf16 v[184:187], v[88:91], a[172:175], v[184:187]
ds_read_b32 v47, v43
v_mfma_f32_16x16x32_bf16 v[172:175], v[92:95], a[168:171], v[172:175]
buffer_load_dwordx4 v37, s[48:51], s85 offen offset:3072 lds
v_mfma_f32_16x16x32_bf16 v[188:191], v[92:95], a[172:175], v[188:191]
ds_read_b32 v47, v43
s_waitcnt lgkmcnt(6)
s_waitcnt vmcnt(7)
v_mfma_f32_16x16x32_bf16 v[128:131], v[96:99], a[176:179], v[128:131]
ds_read_b64_tr_b16 v[80:81], v41 offset:0
s_waitcnt vmcnt(6)
v_mfma_f32_16x16x32_bf16 v[144:147], v[96:99], a[180:183], v[144:147]
ds_read_b64_tr_b16 v[82:83], v41 offset:1024
s_add_u32 m0, s87, 49152
s_add_u32 s85, s7, 0
v_mfma_f32_16x16x32_bf16 v[132:135], v[100:103], a[176:179], v[132:135]
buffer_load_dwordx4 v32, s[48:51], s85 offen lds
v_mfma_f32_16x16x32_bf16 v[148:151], v[100:103], a[180:183], v[148:151]
ds_read_b64_tr_b16 v[84:85], v14 offset:0
s_waitcnt lgkmcnt(3)
v_mfma_f32_16x16x32_bf16 v[136:139], v[104:107], a[176:179], v[136:139]
ds_read_b64_tr_b16 v[86:87], v14 offset:1024
v_mfma_f32_16x16x32_bf16 v[152:155], v[104:107], a[180:183], v[152:155]
ds_read_b32 v47, v43
v_mfma_f32_16x16x32_bf16 v[140:143], v[108:111], a[176:179], v[140:143]
buffer_load_dwordx4 v33, s[48:51], s85 offen offset:1024 lds
v_mfma_f32_16x16x32_bf16 v[156:159], v[108:111], a[180:183], v[156:159]
ds_read_b32 v47, v43
s_waitcnt vmcnt(7)
v_mfma_f32_16x16x32_bf16 v[160:163], v[96:99], a[184:187], v[160:163]
ds_read_b64_tr_b16 v[88:89], v41 offset:256
s_waitcnt vmcnt(6)
v_mfma_f32_16x16x32_bf16 v[176:179], v[96:99], a[188:191], v[176:179]
ds_read_b64_tr_b16 v[90:91], v41 offset:1280
v_mfma_f32_16x16x32_bf16 v[164:167], v[100:103], a[184:187], v[164:167]
buffer_load_dwordx4 v34, s[48:51], s85 offen offset:2048 lds
v_mfma_f32_16x16x32_bf16 v[180:183], v[100:103], a[188:191], v[180:183]
ds_read_b64_tr_b16 v[92:93], v14 offset:256
v_mfma_f32_16x16x32_bf16 v[168:171], v[104:107], a[184:187], v[168:171]
ds_read_b64_tr_b16 v[94:95], v14 offset:1280
v_mfma_f32_16x16x32_bf16 v[184:187], v[104:107], a[188:191], v[184:187]
ds_read_b32 v47, v43
v_mfma_f32_16x16x32_bf16 v[172:175], v[108:111], a[184:187], v[172:175]
buffer_load_dwordx4 v35, s[48:51], s85 offen offset:3072 lds
v_mfma_f32_16x16x32_bf16 v[188:191], v[108:111], a[188:191], v[188:191]
ds_read_b32 v47, v43
s_waitcnt lgkmcnt(0)
s_bfe_u32 s97, s68, 524304
s_cmp_lt_u32 s97, 6
s_cbranch_scc1 L_slow_KH2
L_back_KH2:
buffer_load_dword v120, v75, s[52:55], s93 offen sc1
s_add_u32 s86, s10, 0
buffer_load_dwordx4 a[192:195], v77, s[52:55], s86 offen offset:0 sc1
buffer_load_dwordx4 a[196:199], v77, s[52:55], s86 offen offset:256 sc1
buffer_load_dwordx4 a[200:203], v77, s[52:55], s86 offen offset:1024 sc1
buffer_load_dwordx4 a[204:207], v77, s[52:55], s86 offen offset:1280 sc1
s_add_u32 s86, s10, 4096
buffer_load_dwordx4 a[208:211], v77, s[52:55], s86 offen offset:0 sc1
buffer_load_dwordx4 a[212:215], v77, s[52:55], s86 offen offset:256 sc1
buffer_load_dwordx4 a[216:219], v77, s[52:55], s86 offen offset:1024 sc1
s_waitcnt vmcnt(6)
v_mfma_f32_16x16x32_bf16 v[128:131], v[80:83], a[192:195], v[128:131]
ds_read_b64_tr_b16 v[96:97], v41 offset:16384
s_waitcnt vmcnt(5)
v_mfma_f32_16x16x32_bf16 v[144:147], v[80:83], a[196:199], v[144:147]
ds_read_b64_tr_b16 v[98:99], v41 offset:17408
v_mfma_f32_16x16x32_bf16 v[132:135], v[84:87], a[192:195], v[132:135]
buffer_load_dwordx4 a[220:223], v77, s[52:55], s86 offen offset:1280 sc1
v_mfma_f32_16x16x32_bf16 v[148:151], v[84:87], a[196:199], v[148:151]
ds_read_b64_tr_b16 v[100:101], v14 offset:16384
v_mfma_f32_16x16x32_bf16 v[136:139], v[88:91], a[192:195], v[136:139]
ds_read_b64_tr_b16 v[102:103], v14 offset:17408
s_add_u32 s86, s20, 8192
v_mfma_f32_16x16x32_bf16 v[152:155], v[88:91], a[196:199], v[152:155]
v_mfma_f32_16x16x32_bf16 v[140:143], v[92:95], a[192:195], v[140:143]
buffer_load_dwordx4 a[224:227], v39, s[52:55], s86 offen offset:0 sc1
v_mfma_f32_16x16x32_bf16 v[156:159], v[92:95], a[196:199], v[156:159]
s_waitcnt vmcnt(6)
v_mfma_f32_16x16x32_bf16 v[160:163], v[80:83], a[200:203], v[160:163]
ds_read_b64_tr_b16 v[104:105], v41 offset:16640
s_load_dword s68, s[26:27], s14 glc
s_waitcnt vmcnt(5)
v_mfma_f32_16x16x32_bf16 v[176:179], v[80:83], a[204:207], v[176:179]
ds_read_b64_tr_b16 v[106:107], v41 offset:17664
v_mfma_f32_16x16x32_bf16 v[164:167], v[84:87], a[200:203], v[164:167]
buffer_load_dwordx4 a[228:231], v39, s[52:55], s86 offen offset:256 sc1
v_mfma_f32_16x16x32_bf16 v[180:183], v[84:87], a[204:207], v[180:183]
ds_read_b64_tr_b16 v[108:109], v14 offset:16640
v_mfma_f32_16x16x32_bf16 v[168:171], v[88:91], a[200:203], v[168:171]
ds_read_b64_tr_b16 v[110:111], v14 offset:17664
v_mfma_f32_16x16x32_bf16 v[184:187], v[88:91], a[204:207], v[184:187]
ds_read_b32 v47, v43
v_mfma_f32_16x16x32_bf16 v[172:175], v[92:95], a[200:203], v[172:175]
buffer_load_dwordx4 a[232:235], v39, s[52:55], s86 offen offset:1024 sc1
v_mfma_f32_16x16x32_bf16 v[188:191], v[92:95], a[204:207], v[188:191]
s_waitcnt lgkmcnt(5)
s_waitcnt vmcnt(6)
v_mfma_f32_16x16x32_bf16 v[128:131], v[96:99], a[208:211], v[128:131]
ds_read_b64_tr_b16 v[80:81], v42 offset:0
s_waitcnt vmcnt(5)
v_mfma_f32_16x16x32_bf16 v[144:147], v[96:99], a[212:215], v[144:147]
ds_read_b64_tr_b16 v[82:83], v42 offset:1024
v_mfma_f32_16x16x32_bf16 v[132:135], v[100:103], a[208:211], v[132:135]
buffer_load_dwordx4 a[236:239], v39, s[52:55], s86 offen offset:1280 sc1
v_mfma_f32_16x16x32_bf16 v[148:151], v[100:103], a[212:215], v[148:151]
ds_read_b64_tr_b16 v[84:85], v15 offset:0
s_waitcnt lgkmcnt(3)
v_mfma_f32_16x16x32_bf16 v[136:139], v[104:107], a[208:211], v[136:139]
ds_read_b64_tr_b16 v[86:87], v15 offset:1024
s_add_u32 s86, s11, 0
v_mfma_f32_16x16x32_bf16 v[152:155], v[104:107], a[212:215], v[152:155]
ds_read_b32 v47, v43
v_mfma_f32_16x16x32_bf16 v[140:143], v[108:111], a[208:211], v[140:143]
buffer_load_dwordx4 a[240:243], v77, s[52:55], s86 offen offset:0 sc1
v_mfma_f32_16x16x32_bf16 v[156:159], v[108:111], a[212:215], v[156:159]
s_waitcnt vmcnt(6)
v_mfma_f32_16x16x32_bf16 v[160:163], v[96:99], a[216:219], v[160:163]
ds_read_b64_tr_b16 v[88:89], v42 offset:256
s_waitcnt vmcnt(5)
v_mfma_f32_16x16x32_bf16 v[176:179], v[96:99], a[220:223], v[176:179]
ds_read_b64_tr_b16 v[90:91], v42 offset:1280
v_mfma_f32_16x16x32_bf16 v[164:167], v[100:103], a[216:219], v[164:167]
buffer_load_dwordx4 a[244:247], v77, s[52:55], s86 offen offset:256 sc1
v_mfma_f32_16x16x32_bf16 v[180:183], v[100:103], a[220:223], v[180:183]
ds_read_b64_tr_b16 v[92:93], v15 offset:256
v_mfma_f32_16x16x32_bf16 v[168:171], v[104:107], a[216:219], v[168:171]
ds_read_b64_tr_b16 v[94:95], v15 offset:1280
v_mfma_f32_16x16x32_bf16 v[184:187], v[104:107], a[220:223], v[184:187]
ds_read_b32 v47, v43
v_mfma_f32_16x16x32_bf16 v[172:175], v[108:111], a[216:219], v[172:175]
buffer_load_dwordx4 a[248:251], v77, s[52:55], s86 offen offset:1024 sc1
v_mfma_f32_16x16x32_bf16 v[188:191], v[108:111], a[220:223], v[188:191]
s_waitcnt lgkmcnt(5)
s_waitcnt vmcnt(6)
v_mfma_f32_16x16x32_bf16 v[128:131], v[80:83], a[224:227], v[128:131]
ds_read_b64_tr_b16 v[96:97], v40 offset:49152
s_waitcnt vmcnt(5)
v_mfma_f32_16x16x32_bf16 v[144:147], v[80:83], a[228:231], v[144:147]
ds_read_b64_tr_b16 v[98:99], v40 offset:50176
v_mfma_f32_16x16x32_bf16 v[132:135], v[84:87], a[224:227], v[132:135]
buffer_load_dwordx4 a[252:255], v77, s[52:55], s86 offen offset:1280 sc1
v_mfma_f32_16x16x32_bf16 v[148:151], v[84:87], a[228:231], v[148:151]
ds_read_b64_tr_b16 v[100:101], v13 offset:49152
s_waitcnt lgkmcnt(3)
v_mfma_f32_16x16x32_bf16 v[136:139], v[88:91], a[224:227], v[136:139]
ds_read_b64_tr_b16 v[102:103], v13 offset:50176
s_add_u32 s86, s11, 4096
v_mfma_f32_16x16x32_bf16 v[152:155], v[88:91], a[228:231], v[152:155]
ds_read_b32 v47, v43
v_mfma_f32_16x16x32_bf16 v[140:143], v[92:95], a[224:227], v[140:143]
buffer_load_dwordx4 a[96:99], v77, s[52:55], s86 offen offset:0 sc1
v_mfma_f32_16x16x32_bf16 v[156:159], v[92:95], a[228:231], v[156:159]
s_waitcnt lgkmcnt(0)
s_bfe_u32 s97, s68, 524296
s_cmp_lt_u32 s97, 4
s_cbranch_scc1 L_slow_KH3
L_back_KH3:
buffer_load_dwordx4 a[100:103], v77, s[52:55], s86 offen offset:256 sc1
buffer_load_dwordx4 a[104:107], v77, s[52:55], s86 offen offset:1024 sc1
buffer_load_dwordx4 a[108:111], v77, s[52:55], s86 offen offset:1280 sc1
s_add_u32 m0, s87, 131072
s_add_u32 s85, s7, 32768
buffer_load_dwordx4 v32, s[48:51], s85 offen lds
buffer_load_dwordx4 v33, s[48:51], s85 offen offset:1024 lds
buffer_load_dwordx4 v34, s[48:51], s85 offen offset:2048 lds
buffer_load_dwordx4 v35, s[48:51], s85 offen offset:3072 lds
s_add_u32 s86, s12, 0
buffer_load_dwordx4 a[112:115], v77, s[52:55], s86 offen offset:0 sc1
s_waitcnt vmcnt(14)
v_mfma_f32_16x16x32_bf16 v[160:163], v[80:83], a[232:235], v[160:163]
ds_read_b64_tr_b16 v[104:105], v40 offset:49408
s_waitcnt vmcnt(13)
v_mfma_f32_16x16x32_bf16 v[176:179], v[80:83], a[236:239], v[176:179]
ds_read_b64_tr_b16 v[106:107], v40 offset:50432
v_mfma_f32_16x16x32_bf16 v[164:167], v[84:87], a[232:235], v[164:167]
buffer_load_dwordx4 a[116:119], v77, s[52:55], s86 offen offset:256 sc1
v_mfma_f32_16x16x32_bf16 v[180:183], v[84:87], a[236:239], v[180:183]
ds_read_b64_tr_b16 v[108:109], v13 offset:49408
s_add_u32 s86, s12, 4096
v_mfma_f32_16x16x32_bf16 v[168:171], v[88:91], a[232:235], v[168:171]
ds_read_b64_tr_b16 v[110:111], v13 offset:50432
v_mfma_f32_16x16x32_bf16 v[184:187], v[88:91], a[236:239], v[184:187]
v_mfma_f32_16x16x32_bf16 v[172:175], v[92:95], a[232:235], v[172:175]
buffer_load_dwordx4 a[128:131], v77, s[52:55], s86 offen offset:0 sc1
v_mfma_f32_16x16x32_bf16 v[188:191], v[92:95], a[236:239], v[188:191]
s_waitcnt vmcnt(14)
v_mfma_f32_16x16x32_bf16 v[128:131], v[96:99], a[240:243], v[128:131]
s_waitcnt vmcnt(3)
ds_read_b64_tr_b16 v[80:81], v42 offset:0
v_mfma_f32_16x16x32_bf16 v[144:147], v[96:99], a[244:247], v[144:147]
ds_read_b64_tr_b16 v[82:83], v42 offset:1024
v_mfma_f32_16x16x32_bf16 v[132:135], v[100:103], a[240:243], v[132:135]
buffer_load_dwordx4 a[132:135], v77, s[52:55], s86 offen offset:256 sc1
v_mfma_f32_16x16x32_bf16 v[148:151], v[100:103], a[244:247], v[148:151]
ds_read_b64_tr_b16 v[84:85], v15 offset:0
s_waitcnt lgkmcnt(3)
v_mfma_f32_16x16x32_bf16 v[136:139], v[104:107], a[240:243], v[136:139]
ds_read_b64_tr_b16 v[86:87], v15 offset:1024
s_add_u32 s86, s22, 0
v_mfma_f32_16x16x32_bf16 v[152:155], v[104:107], a[244:247], v[152:155]
v_mfma_f32_16x16x32_bf16 v[140:143], v[108:111], a[240:243], v[140:143]
buffer_load_dwordx4 a[144:147], v77, s[52:55], s86 offen offset:0 sc1
v_mfma_f32_16x16x32_bf16 v[156:159], v[108:111], a[244:247], v[156:159]
v_mul_f32 v120, -v120, v50
v_exp_f32 v120, v120
s_nop 0
v_add_f32 v120, 1.0, v120
v_rcp_f32_e64 v120, v120
v_mfma_f32_16x16x32_bf16 v[160:163], v[96:99], a[248:251], v[160:163]
ds_read_b64_tr_b16 v[88:89], v42 offset:256
v_mfma_f32_16x16x32_bf16 v[176:179], v[96:99], a[252:255], v[176:179]
ds_read_b64_tr_b16 v[90:91], v42 offset:1280
v_mfma_f32_16x16x32_bf16 v[164:167], v[100:103], a[248:251], v[164:167]
buffer_load_dwordx4 a[148:151], v77, s[52:55], s86 offen offset:256 sc1
v_mfma_f32_16x16x32_bf16 v[180:183], v[100:103], a[252:255], v[180:183]
L_pad_KH_5:
s_cbranch_execz L_padslow_KH
s_nop 0
ds_read_b64_tr_b16 v[92:93], v15 offset:256
s_add_u32 s86, s22, 4096
v_mfma_f32_16x16x32_bf16 v[168:171], v[104:107], a[248:251], v[168:171]
ds_read_b64_tr_b16 v[94:95], v15 offset:1280
v_mfma_f32_16x16x32_bf16 v[184:187], v[104:107], a[252:255], v[184:187]
v_mfma_f32_16x16x32_bf16 v[172:175], v[108:111], a[248:251], v[172:175]
buffer_load_dwordx4 a[160:163], v77, s[52:55], s86 offen offset:0 sc1
v_mfma_f32_16x16x32_bf16 v[188:191], v[108:111], a[252:255], v[188:191]
v_mov_b32 v121, v120
s_nop 1
v_permlane16_swap_b32 v120, v121
v_mov_b32 v122, v120
v_mov_b32 v123, v121
s_waitcnt lgkmcnt(4)
v_mfma_f32_16x16x32_bf16 v[128:131], v[80:83], a[96:99], v[128:131]
buffer_load_dwordx4 a[164:167], v77, s[52:55], s86 offen offset:256 sc1
v_mfma_f32_16x16x32_bf16 v[144:147], v[80:83], a[100:103], v[144:147]
s_add_u32 s86, s12, 0
v_mfma_f32_16x16x32_bf16 v[132:135], v[84:87], a[96:99], v[132:135]
buffer_load_dwordx4 a[120:123], v77, s[52:55], s86 offen offset:1024 sc1
v_mfma_f32_16x16x32_bf16 v[148:151], v[84:87], a[100:103], v[148:151]
s_waitcnt lgkmcnt(0)
v_mfma_f32_16x16x32_bf16 v[136:139], v[88:91], a[96:99], v[136:139]
buffer_load_dwordx4 a[124:127], v77, s[52:55], s86 offen offset:1280 sc1
v_mfma_f32_16x16x32_bf16 v[152:155], v[88:91], a[100:103], v[152:155]
s_add_u32 s86, s12, 4096
v_mfma_f32_16x16x32_bf16 v[140:143], v[92:95], a[96:99], v[140:143]
buffer_load_dwordx4 a[136:139], v77, s[52:55], s86 offen offset:1024 sc1
v_mfma_f32_16x16x32_bf16 v[156:159], v[92:95], a[100:103], v[156:159]
v_permlane32_swap_b32 v120, v122
v_permlane32_swap_b32 v121, v123
v_sub_f32 v124, 1.0, v120
v_sub_f32 v125, 1.0, v121
v_mfma_f32_16x16x32_bf16 v[160:163], v[80:83], a[104:107], v[160:163]
buffer_load_dwordx4 a[140:143], v77, s[52:55], s86 offen offset:1280 sc1
v_mfma_f32_16x16x32_bf16 v[176:179], v[80:83], a[108:111], v[176:179]
s_add_u32 s86, s22, 0
v_mfma_f32_16x16x32_bf16 v[164:167], v[84:87], a[104:107], v[164:167]
buffer_load_dwordx4 a[152:155], v77, s[52:55], s86 offen offset:1024 sc1
v_mfma_f32_16x16x32_bf16 v[180:183], v[84:87], a[108:111], v[180:183]
v_mfma_f32_16x16x32_bf16 v[168:171], v[88:91], a[104:107], v[168:171]
buffer_load_dwordx4 a[156:159], v77, s[52:55], s86 offen offset:1280 sc1
v_mfma_f32_16x16x32_bf16 v[184:187], v[88:91], a[108:111], v[184:187]
s_add_u32 s86, s22, 4096
v_mfma_f32_16x16x32_bf16 v[172:175], v[92:95], a[104:107], v[172:175]
buffer_load_dwordx4 a[168:171], v77, s[52:55], s86 offen offset:1024 sc1
v_mfma_f32_16x16x32_bf16 v[188:191], v[92:95], a[108:111], v[188:191]
v_sub_f32 v126, 1.0, v122
v_sub_f32 v127, 1.0, v123
s_waitcnt vmcnt(14)
v_mfma_f32_16x16x32_bf16 v[192:195], a[0:3], a[112:115], 0
v_mfma_f32_16x16x32_bf16 v[196:199], a[4:7], a[112:115], 0
v_mfma_f32_16x16x32_bf16 v[200:203], a[8:11], a[112:115], 0
v_mfma_f32_16x16x32_bf16 v[204:207], a[12:15], a[112:115], 0
s_waitcnt vmcnt(13)
v_mfma_f32_16x16x32_bf16 v[208:211], a[0:3], a[116:119], 0
v_mfma_f32_16x16x32_bf16 v[212:215], a[4:7], a[116:119], 0
v_mfma_f32_16x16x32_bf16 v[216:219], a[8:11], a[116:119], 0
buffer_load_dwordx4 a[172:175], v77, s[52:55], s86 offen offset:1280 sc1
v_mfma_f32_16x16x32_bf16 v[220:223], a[12:15], a[116:119], 0
v_mul_f32 v128, v128, v124
v_mul_f32 v129, v129, v124
v_mul_f32 v130, v130, v124
v_mul_f32 v131, v131, v124
v_mul_f32 v132, v132, v124
v_mul_f32 v133, v133, v124
v_mul_f32 v134, v134, v124
v_mul_f32 v135, v135, v124
v_mul_f32 v136, v136, v124
v_mul_f32 v137, v137, v124
v_mul_f32 v138, v138, v124
v_mul_f32_e64 v139, v139, v124
v_mul_f32 v140, v140, v124
s_waitcnt vmcnt(13)
v_mfma_f32_16x16x32_bf16 v[192:195], a[16:19], a[128:131], v[192:195]
v_mul_f32 v141, v141, v124
v_mul_f32 v142, v142, v124
v_mfma_f32_16x16x32_bf16 v[196:199], a[20:23], a[128:131], v[196:199]
v_mul_f32 v143, v143, v124
v_mul_f32 v144, v144, v125
v_mfma_f32_16x16x32_bf16 v[200:203], a[24:27], a[128:131], v[200:203]
v_mul_f32 v145, v145, v125
v_mul_f32 v146, v146, v125
v_mfma_f32_16x16x32_bf16 v[204:207], a[28:31], a[128:131], v[204:207]
v_mul_f32_e64 v147, v147, v125
v_mul_f32 v148, v148, v125
s_waitcnt vmcnt(12)
v_mfma_f32_16x16x32_bf16 v[208:211], a[16:19], a[132:135], v[208:211]
v_mul_f32 v149, v149, v125
v_mul_f32 v150, v150, v125
v_mfma_f32_16x16x32_bf16 v[212:215], a[20:23], a[132:135], v[212:215]
v_mul_f32 v151, v151, v125
v_mul_f32 v152, v152, v125
v_mfma_f32_16x16x32_bf16 v[216:219], a[24:27], a[132:135], v[216:219]
v_mul_f32_e64 v153, v153, v125
v_mfma_f32_16x16x32_bf16 v[220:223], a[28:31], a[132:135], v[220:223]
s_waitcnt vmcnt(11)
v_mfma_f32_16x16x32_bf16 v[192:195], a[32:35], a[144:147], v[192:195]
v_mul_f32 v154, v154, v125
v_mul_f32_e64 v155, v155, v125
v_mfma_f32_16x16x32_bf16 v[196:199], a[36:39], a[144:147], v[196:199]
v_mul_f32 v156, v156, v125
v_mul_f32 v157, v157, v125
v_mfma_f32_16x16x32_bf16 v[200:203], a[40:43], a[144:147], v[200:203]
v_mul_f32 v158, v158, v125
v_mul_f32 v159, v159, v125
v_mfma_f32_16x16x32_bf16 v[204:207], a[44:47], a[144:147], v[204:207]
v_mul_f32_e64 v160, v160, v126
v_mul_f32 v161, v161, v126
s_waitcnt vmcnt(10)
v_mfma_f32_16x16x32_bf16 v[208:211], a[32:35], a[148:151], v[208:211]
v_mul_f32 v162, v162, v126
v_mul_f32 v163, v163, v126
v_mfma_f32_16x16x32_bf16 v[212:215], a[36:39], a[148:151], v[212:215]
v_mul_f32 v164, v164, v126
v_mul_f32 v165, v165, v126
v_mfma_f32_16x16x32_bf16 v[216:219], a[40:43], a[148:151], v[216:219]
v_mul_f32_e64 v166, v166, v126
v_mfma_f32_16x16x32_bf16 v[220:223], a[44:47], a[148:151], v[220:223]
s_waitcnt vmcnt(9)
v_mfma_f32_16x16x32_bf16 v[192:195], a[48:51], a[160:163], v[192:195]
v_mul_f32 v167, v167, v126
v_mul_f32_e64 v168, v168, v126
v_mfma_f32_16x16x32_bf16 v[196:199], a[52:55], a[160:163], v[196:199]
v_mul_f32 v169, v169, v126
v_mul_f32 v170, v170, v126
v_mfma_f32_16x16x32_bf16 v[200:203], a[56:59], a[160:163], v[200:203]
v_mul_f32 v171, v171, v126
v_mul_f32 v172, v172, v126
v_mfma_f32_16x16x32_bf16 v[204:207], a[60:63], a[160:163], v[204:207]
v_mul_f32_e64 v173, v173, v126
v_mul_f32 v174, v174, v126
s_waitcnt vmcnt(8)
v_mfma_f32_16x16x32_bf16 v[208:211], a[48:51], a[164:167], v[208:211]
v_mul_f32 v175, v175, v126
v_mul_f32 v176, v176, v127
v_mfma_f32_16x16x32_bf16 v[212:215], a[52:55], a[164:167], v[212:215]
v_mul_f32 v177, v177, v127
v_mul_f32 v178, v178, v127
v_mfma_f32_16x16x32_bf16 v[216:219], a[56:59], a[164:167], v[216:219]
v_mul_f32_e64 v179, v179, v127
v_mfma_f32_16x16x32_bf16 v[220:223], a[60:63], a[164:167], v[220:223]
s_waitcnt vmcnt(7)
v_mfma_f32_16x16x32_bf16 v[224:227], a[0:3], a[120:123], 0
v_mul_f32 v180, v180, v127
v_mul_f32_e64 v181, v181, v127
v_mfma_f32_16x16x32_bf16 v[228:231], a[4:7], a[120:123], 0
v_mul_f32 v182, v182, v127
v_mul_f32 v183, v183, v127
v_mfma_f32_16x16x32_bf16 v[232:235], a[8:11], a[120:123], 0
v_mul_f32 v184, v184, v127
v_mul_f32 v185, v185, v127
v_mfma_f32_16x16x32_bf16 v[236:239], a[12:15], a[120:123], 0
v_mul_f32_e64 v186, v186, v127
v_mul_f32 v187, v187, v127
s_waitcnt vmcnt(6)
v_mfma_f32_16x16x32_bf16 v[240:243], a[0:3], a[124:127], 0
v_mul_f32 v188, v188, v127
v_mul_f32 v189, v189, v127
v_mfma_f32_16x16x32_bf16 v[244:247], a[4:7], a[124:127], 0
v_mul_f32 v190, v190, v127
v_mul_f32 v191, v191, v127
v_mfma_f32_16x16x32_bf16 v[248:251], a[8:11], a[124:127], 0
v_mfma_f32_16x16x32_bf16 v[252:255], a[12:15], a[124:127], 0
s_waitcnt vmcnt(5)
v_mfma_f32_16x16x32_bf16 v[224:227], a[16:19], a[136:139], v[224:227]
v_fmac_f32 v128, v192, v120
v_fmac_f32_e64 v129, v193, v120
v_mfma_f32_16x16x32_bf16 v[228:231], a[20:23], a[136:139], v[228:231]
v_fmac_f32 v130, v194, v120
v_fmac_f32 v131, v195, v120
v_mfma_f32_16x16x32_bf16 v[232:235], a[24:27], a[136:139], v[232:235]
ds_write_b128 v112, v[128:131] offset:0
v_fmac_f32_e64 v132, v196, v120
v_mfma_f32_16x16x32_bf16 v[236:239], a[28:31], a[136:139], v[236:239]
v_fmac_f32_e64 v133, v197, v120
v_fmac_f32 v134, v198, v120
s_waitcnt vmcnt(4)
v_mfma_f32_16x16x32_bf16 v[240:243], a[16:19], a[140:143], v[240:243]
v_fmac_f32_e64 v135, v199, v120
v_mfma_f32_16x16x32_bf16 v[244:247], a[20:23], a[140:143], v[244:247]
ds_write_b128 v113, v[132:135] offset:0
v_fmac_f32_e64 v136, v200, v120
v_mfma_f32_16x16x32_bf16 v[248:251], a[24:27], a[140:143], v[248:251]
v_fmac_f32 v137, v201, v120
v_fmac_f32 v138, v202, v120
v_mfma_f32_16x16x32_bf16 v[252:255], a[28:31], a[140:143], v[252:255]
v_fmac_f32_e64 v139, v203, v120
ds_write_b128 v112, v[136:139] offset:128
s_waitcnt vmcnt(3)
v_mfma_f32_16x16x32_bf16 v[224:227], a[32:35], a[152:155], v[224:227]
v_fmac_f32 v140, v204, v120
v_fmac_f32_e64 v141, v205, v120
v_mfma_f32_16x16x32_bf16 v[228:231], a[36:39], a[152:155], v[228:231]
v_fmac_f32 v142, v206, v120
v_fmac_f32 v143, v207, v120
v_mfma_f32_16x16x32_bf16 v[232:235], a[40:43], a[152:155], v[232:235]
ds_write_b128 v113, v[140:143] offset:128
v_fmac_f32_e64 v144, v208, v121
v_mfma_f32_16x16x32_bf16 v[236:239], a[44:47], a[152:155], v[236:239]
v_fmac_f32_e64 v145, v209, v121
v_fmac_f32 v146, v210, v121
s_waitcnt vmcnt(2)
v_mfma_f32_16x16x32_bf16 v[240:243], a[32:35], a[156:159], v[240:243]
v_fmac_f32_e64 v147, v211, v121
v_mfma_f32_16x16x32_bf16 v[244:247], a[36:39], a[156:159], v[244:247]
ds_write_b128 v112, v[144:147] offset:16384
v_fmac_f32_e64 v148, v212, v121
v_mfma_f32_16x16x32_bf16 v[248:251], a[40:43], a[156:159], v[248:251]
v_fmac_f32 v149, v213, v121
v_fmac_f32 v150, v214, v121
v_mfma_f32_16x16x32_bf16 v[252:255], a[44:47], a[156:159], v[252:255]
v_fmac_f32_e64 v151, v215, v121
ds_write_b128 v113, v[148:151] offset:16384
s_waitcnt vmcnt(1)
v_mfma_f32_16x16x32_bf16 v[224:227], a[48:51], a[168:171], v[224:227]
v_fmac_f32 v152, v216, v121
v_fmac_f32_e64 v153, v217, v121
v_mfma_f32_16x16x32_bf16 v[228:231], a[52:55], a[168:171], v[228:231]
v_fmac_f32 v154, v218, v121
v_fmac_f32 v155, v219, v121
v_mfma_f32_16x16x32_bf16 v[232:235], a[56:59], a[168:171], v[232:235]
ds_write_b128 v112, v[152:155] offset:16512
v_fmac_f32_e64 v156, v220, v121
v_mfma_f32_16x16x32_bf16 v[236:239], a[60:63], a[168:171], v[236:239]
v_fmac_f32_e64 v157, v221, v121
v_fmac_f32 v158, v222, v121
s_waitcnt vmcnt(0)
v_mfma_f32_16x16x32_bf16 v[240:243], a[48:51], a[172:175], v[240:243]
v_fmac_f32_e64 v159, v223, v121
v_mfma_f32_16x16x32_bf16 v[244:247], a[52:55], a[172:175], v[244:247]
ds_write_b128 v113, v[156:159] offset:16512
v_mfma_f32_16x16x32_bf16 v[248:251], a[56:59], a[172:175], v[248:251]
v_mfma_f32_16x16x32_bf16 v[252:255], a[60:63], a[172:175], v[252:255]
v_pk_fma_f32 v[160:161], v[224:225], v[122:123], v[160:161] op_sel_hi:[1,0,1]
v_pk_fma_f32 v[162:163], v[226:227], v[122:123], v[162:163] op_sel_hi:[1,0,1]
ds_write_b128 v112, v[160:163] offset:32768
v_pk_fma_f32 v[164:165], v[228:229], v[122:123], v[164:165] op_sel_hi:[1,0,1]
v_pk_fma_f32 v[166:167], v[230:231], v[122:123], v[166:167] op_sel_hi:[1,0,1]
ds_write_b128 v113, v[164:167] offset:32768
v_pk_fma_f32 v[168:169], v[232:233], v[122:123], v[168:169] op_sel_hi:[1,0,1]
v_pk_fma_f32 v[170:171], v[234:235], v[122:123], v[170:171] op_sel_hi:[1,0,1]
ds_write_b128 v112, v[168:171] offset:32896
v_pk_fma_f32 v[172:173], v[236:237], v[122:123], v[172:173] op_sel_hi:[1,0,1]
v_pk_fma_f32 v[174:175], v[238:239], v[122:123], v[174:175] op_sel_hi:[1,0,1]
ds_write_b128 v113, v[172:175] offset:32896
v_pk_fma_f32 v[176:177], v[240:241], v[122:123], v[176:177] op_sel:[0,1,0] op_sel_hi:[1,1,1]
v_pk_fma_f32 v[178:179], v[242:243], v[122:123], v[178:179] op_sel:[0,1,0] op_sel_hi:[1,1,1]
ds_write_b128 v112, v[176:179] offset:49152
v_pk_fma_f32 v[180:181], v[244:245], v[122:123], v[180:181] op_sel:[0,1,0] op_sel_hi:[1,1,1]
v_pk_fma_f32 v[182:183], v[246:247], v[122:123], v[182:183] op_sel:[0,1,0] op_sel_hi:[1,1,1]
ds_write_b128 v113, v[180:183] offset:49152
v_pk_fma_f32 v[184:185], v[248:249], v[122:123], v[184:185] op_sel:[0,1,0] op_sel_hi:[1,1,1]
v_pk_fma_f32 v[186:187], v[250:251], v[122:123], v[186:187] op_sel:[0,1,0] op_sel_hi:[1,1,1]
ds_write_b128 v112, v[184:187] offset:49280
v_pk_fma_f32 v[188:189], v[252:253], v[122:123], v[188:189] op_sel:[0,1,0] op_sel_hi:[1,1,1]
v_pk_fma_f32 v[190:191], v[254:255], v[122:123], v[190:191] op_sel:[0,1,0] op_sel_hi:[1,1,1]
ds_write_b128 v113, v[188:191] offset:49280
s_waitcnt lgkmcnt(0)
s_barrier
ds_read_b128 v[192:195], v116 offset:0
ds_read_b128 v[196:199], v117 offset:0
ds_read_b128 v[200:203], v116 offset:4096
ds_read_b128 v[204:207], v117 offset:4096
ds_read_b128 v[208:211], v116 offset:8192
ds_read_b128 v[212:215], v117 offset:8192
ds_read_b128 v[216:219], v116 offset:12288
ds_read_b128 v[220:223], v117 offset:12288
ds_read_b128 v[128:131], v116 offset:32768
ds_read_b128 v[132:135], v117 offset:32768
ds_read_b128 v[136:139], v116 offset:36864
ds_read_b128 v[140:143], v117 offset:36864
ds_read_b128 v[144:147], v116 offset:40960
ds_read_b128 v[148:151], v117 offset:40960
ds_read_b128 v[152:155], v116 offset:45056
ds_read_b128 v[156:159], v117 offset:45056
s_waitcnt lgkmcnt(13)
v_pk_add_f32 v[192:193], v[192:193], v[200:201]
v_pk_add_f32 v[194:195], v[194:195], v[202:203]
s_waitcnt lgkmcnt(12)
v_pk_add_f32 v[196:197], v[196:197], v[204:205]
v_pk_add_f32 v[198:199], v[198:199], v[206:207]
s_waitcnt lgkmcnt(9)
v_pk_add_f32 v[208:209], v[208:209], v[216:217]
v_pk_add_f32 v[210:211], v[210:211], v[218:219]
s_waitcnt lgkmcnt(8)
v_pk_add_f32 v[212:213], v[212:213], v[220:221]
v_pk_add_f32 v[214:215], v[214:215], v[222:223]
v_pk_add_f32 v[192:193], v[192:193], v[208:209]
v_pk_add_f32 v[194:195], v[194:195], v[210:211]
v_pk_add_f32 v[196:197], v[196:197], v[212:213]
v_pk_add_f32 v[198:199], v[198:199], v[214:215]
v_cvt_pk_bf16_f32 v200, v192, v193
v_cvt_pk_bf16_f32 v201, v194, v195
v_cvt_pk_bf16_f32 v202, v196, v197
v_cvt_pk_bf16_f32 v203, v198, v199
buffer_store_dwordx4 v[200:203], v118, s[56:59], s90 offen
s_waitcnt lgkmcnt(5)
v_pk_add_f32 v[128:129], v[128:129], v[136:137]
v_pk_add_f32 v[130:131], v[130:131], v[138:139]
s_waitcnt lgkmcnt(4)
v_pk_add_f32 v[132:133], v[132:133], v[140:141]
v_pk_add_f32 v[134:135], v[134:135], v[142:143]
s_waitcnt lgkmcnt(1)
v_pk_add_f32 v[144:145], v[144:145], v[152:153]
v_pk_add_f32 v[146:147], v[146:147], v[154:155]
s_waitcnt lgkmcnt(0)
v_pk_add_f32 v[148:149], v[148:149], v[156:157]
v_pk_add_f32 v[150:151], v[150:151], v[158:159]
v_pk_add_f32 v[128:129], v[128:129], v[144:145]
v_pk_add_f32 v[130:131], v[130:131], v[146:147]
v_pk_add_f32 v[132:133], v[132:133], v[148:149]
v_pk_add_f32 v[134:135], v[134:135], v[150:151]
v_cvt_pk_bf16_f32 v136, v128, v129
v_cvt_pk_bf16_f32 v137, v130, v131
v_cvt_pk_bf16_f32 v138, v132, v133
v_cvt_pk_bf16_f32 v139, v134, v135
buffer_store_dwordx4 v[136:139], v118, s[56:59], s91 offen
s_endpgm
L_padslow_KH:
s_branch L_warm_KH
L_slow_KH0:
s_mov_b32 s96, 0
L_spin_KH0:
s_add_u32 s96, s96, 1
v_mov_b32 v47, 0
global_load_dword v47, v47, s[24:25] sc1
s_waitcnt vmcnt(0)
v_readfirstlane_b32 s68, v47
s_nop 3
s_bfe_u32 s97, s68, 524288
s_cmp_lt_u32 s97, 16
s_cbranch_scc0 L_back_KH0
s_cmp_ge_u32 s96, 0x8000
s_cbranch_scc1 L_back_KH0
s_sleep 16
s_branch L_spin_KH0
L_slow_KH1:
s_mov_b32 s96, 0
L_spin_KH1:
s_add_u32 s96, s96, 1
s_load_dword s68, s[26:27], s14 glc
s_waitcnt lgkmcnt(0)
s_bfe_u32 s97, s68, 524288
s_cmp_lt_u32 s97, 4
s_cbranch_scc0 L_back_KH1
s_cmp_ge_u32 s96, 0x8000
s_cbranch_scc1 L_back_KH1
s_sleep 3
s_branch L_spin_KH1
L_slow_KH2:
s_mov_b32 s96, 0
L_spin_KH2:
s_add_u32 s96, s96, 1
s_load_dword s68, s[26:27], s14 glc
s_waitcnt lgkmcnt(0)
s_bfe_u32 s97, s68, 524304
s_cmp_lt_u32 s97, 6
s_cbranch_scc0 L_back_KH2
s_cmp_ge_u32 s96, 0x8000
s_cbranch_scc1 L_back_KH2
s_sleep 1
s_branch L_spin_KH2
L_slow_KH3:
s_mov_b32 s96, 0
L_spin_KH3:
s_add_u32 s96, s96, 1
s_load_dword s68, s[26:27], s14 glc
s_waitcnt lgkmcnt(0)
s_bfe_u32 s97, s68, 524296
s_cmp_lt_u32 s97, 4
s_cbranch_scc0 L_back_KH3
s_cmp_ge_u32 s96, 0x8000
s_cbranch_scc1 L_back_KH3
s_sleep 1
s_branch L_spin_KH3
.p2align 12
L_KL:
s_and_b32 s75, s74, 1
s_lshr_b32 s76, s74, 1
v_lshlrev_b32_e64 v38, 4, v1
s_bfe_u32 s77, s2, 0x20001
s_bitcmp1_b32 s2, 0
s_cselect_b32 s90, 0, 4
s_add_u32 s77, s77, s90
s_lshl_b32 s77, s77, 2
s_and_b32 s90, s78, 1
s_xor_b32 s90, s90, s92
s_add_u32 s77, s77, s90
v_bfe_u32 v68, v1, 2, 2
v_and_b32 v69, 3, v1
v_lshlrev_b32_e64 v69, 3, v69
v_lshl_add_u32 v43, v68, 6, v69
v_lshrrev_b32_e64 v70, 5, v1
v_bfe_u32 v71, v1, 4, 1
v_and_b32_e64 v72, 15, v1
v_bfe_u32 v73, v1, 1, 3
v_lshrrev_b32 v75, 4, v1
v_xor_b32 v73, v73, v75
v_lshlrev_b32_e64 v73, 4, v73
v_lshl_add_u32 v73, v72, 7, v73
s_lshl_b32 s90, s75, 13
s_lshl_b32 s91, s76, 12
s_add_u32 s90, s90, s91
v_add_u32 v16, s90, v73
v_xor_b32_e64 v17, 64, v16
v_xor_b32 v18, 0x1000, v16
v_xor_b32 v19, 0x1040, v16
v_lshl_add_u32 v74, v71, 5, v43
v_lshl_add_u32 v40, v70, 11, v74
v_add_u32_e64 v40, s87, v40
v_lshl_add_u32 v40, v71, 9, v40
v_add_u32 v41, 0x10000, v40
v_add_u32 v42, 0x20000, v40
v_xor_b32 v13, 32, v40
v_xor_b32 v14, 32, v41
v_xor_b32 v15, 32, v42
v_lshrrev_b32 v75, 1, v1
v_xor_b32 v75, v75, v1
v_and_b32 v75, 1, v75
v_mul_u32_u24_e64 v75, 24, v75
v_xor_b32 v75, v75, v74
s_lshl_b32 s90, s76, 8
s_add_u32 s90, s90, 65536
v_lshrrev_b32_e64 v76, 4, v1
v_mul_u32_u24 v76, 2048, v76
v_add3_u32 v60, v76, v75, s90
v_xor_b32_e64 v61, 32, v60
v_add3_u32 v62, v76, v74, s90
v_xor_b32_e64 v63, 32, v62
s_mov_b64 exec, 0
s_cmp_eq_u32 s74, 0
s_cbranch_scc1 L_pad_KL_1
s_cmp_eq_u32 s74, 1
s_cbranch_scc1 L_pad_KL_2
s_cmp_eq_u32 s74, 2
s_cbranch_scc1 L_pad_KL_3
s_branch L_pad_KL_4
L_warm_KL:
s_mov_b64 exec, -1
s_mov_b64 s[60:61], s[8:9]
s_mov_b32 s62, 16384
s_mov_b32 s63, 0x20000
s_mov_b64 s[64:65], s[20:21]
s_mov_b32 s66, 1024
s_mov_b32 s67, 0x20000
s_mov_b64 s[52:53], s[26:27]
s_mov_b32 s54, 9109504
s_mov_b32 s55, 0x20000
s_mov_b64 s[36:37], s[14:15]
s_mov_b32 s38, 1409024
s_mov_b32 s39, 0x20000
s_mov_b64 s[40:41], s[16:17]
s_mov_b32 s42, 1409024
s_mov_b32 s43, 0x20000
s_mov_b64 s[44:45], s[10:11]
s_mov_b32 s46, 524288
s_mov_b32 s47, 0x20000
s_mov_b64 s[48:49], s[18:19]
s_mov_b32 s50, 1409024
s_mov_b32 s51, 0x20000
s_mov_b64 s[56:57], s[22:23]
s_mov_b32 s58, 2097152
s_mov_b32 s59, 0x20000
s_add_u32 s26, s52, 8519680
s_addc_u32 s27, s53, 0
s_lshr_b32 s95, s73, 1
s_mul_i32 s95, s95, 22
s_and_b32 s90, s73, 1
s_mul_i32 s90, s90, 5
s_add_u32 s95, s95, s90
s_cmp_eq_u32 s73, 7
s_cselect_b32 s90, 1, 0
s_sub_u32 s95, s95, s90
s_lshr_b32 s82, s95, 1
s_lshl_b32 s82, s82, 6
s_mul_i32 s89, s74, 4096
v_lshl_add_u32 v76, v70, 2, v71
v_mul_u32_u24 v76, 1024, v76
v_add_u32 v76, v76, v75
s_and_b32 s93, s95, 1
s_lshl_b32 s90, s76, 1
s_add_u32 s90, s90, s93
s_lshr_b32 s91, s90, 1
s_lshl_b32 s91, s91, 8
s_and_b32 s92, s90, 1
s_lshl_b32 s92, s92, 5
v_xor_b32 v20, s92, v76
v_add_u32 v20, s91, v20
v_add_u32 v23, 0x10000, v20
v_add_u32 v26, 0x20000, v20
s_add_u32 s90, s90, 1
s_lshr_b32 s91, s90, 1
s_lshl_b32 s91, s91, 8
s_and_b32 s92, s90, 1
s_lshl_b32 s92, s92, 5
v_xor_b32 v21, s92, v76
v_add_u32_e64 v21, s91, v21
v_add_u32 v24, 0x10000, v21
v_add_u32 v27, 0x20000, v21
s_lshr_b32 s91, s87, 2
s_add_u32 s91, s91, 159744
v_lshrrev_b32 v30, 4, v1
v_lshl_add_u32 v30, v30, 4, s91
v_bfe_u32 v68, v1, 2, 2
v_and_b32 v69, 3, v1
v_lshlrev_b32 v69, 4, v69
v_lshrrev_b32 v70, 4, v1
v_lshrrev_b32 v71, 5, v1
v_lshl_add_u32 v71, v71, 2, v68
s_lshl_b32 s90, s74, 4
v_add_u32 v71, s90, v71
v_mul_u32_u24 v71, 2752, v71
v_and_b32_e64 v72, 1, v70
v_lshl_add_u32 v72, v72, 6, v69
v_add3_u32 v10, v71, v72, s82
v_add_u32 v11, 20992, v10
v_xor_b32_e64 v11, 32, v11
v_mov_b32 v48, 0xbdd2d3e8
v_mov_b32 v49, 0xc0135761
v_mov_b32 v50, 0x3fb8aa3b
v_mov_b32 v51, 0x358637bd
s_mov_b32 s69, 1
s_mov_b32 s70, 65536
s_mov_b32 s98, 0xffff0000
s_mov_b32 s99, 0xffff0000
v_lshrrev_b32 v68, 5, v1
v_bfe_u32 v69, v1, 1, 4
v_lshlrev_b32 v68, 1, v68
v_sub_u32 v68, v69, v68
v_and_b32 v69, 1, v1
v_lshlrev_b32 v69, 4, v69
v_mov_b32 v70, 0x3f80
v_lshlrev_b32_e64 v70, v69, v70
v_cmp_eq_u32 s[16:17], 0, v68
v_cmp_eq_u32 s[18:19], 1, v68
v_cmp_eq_u32 s[20:21], 4, v68
v_cmp_eq_u32 s[22:23], 5, v68
v_cndmask_b32 v52, 0, v70, s[16:17]
v_cndmask_b32 v53, 0, v70, s[18:19]
v_cndmask_b32 v54, 0, v70, s[20:21]
v_cndmask_b32 v55, 0, v70, s[22:23]
v_cmp_eq_u32 s[16:17], 8, v68
v_cmp_eq_u32 s[18:19], 9, v68
v_cmp_eq_u32 s[20:21], 12, v68
v_cmp_eq_u32 s[22:23], 13, v68
v_cndmask_b32 v56, 0, v70, s[16:17]
v_cndmask_b32 v57, 0, v70, s[18:19]
v_cndmask_b32 v58, 0, v70, s[20:21]
v_cndmask_b32 v59, 0, v70, s[22:23]
s_lshl_b32 s91, s74, 3
s_or_b32 s91, s91, 0x80000
s_bfe_u32 s4, 0x2620100a, s91
s_bfe_u32 s5, 0x504a3c36, s91
s_bfe_u32 s6, 0x1b160500, s91
s_bfe_u32 s7, 0x4642312c, s91
s_mul_i32 s90, s77, 118
s_lshl_b32 s92, s78, 7
s_add_u32 s8, s4, s90
s_lshl_b32 s8, s8, 11
s_lshl_b32 s4, s4, 14
s_add_u32 s4, s4, s92
s_add_u32 s9, s5, s90
s_lshl_b32 s9, s9, 11
s_lshl_b32 s5, s5, 14
s_add_u32 s5, s5, s92
s_add_u32 s10, s6, s90
s_lshl_b32 s10, s10, 11
s_lshl_b32 s6, s6, 14
s_add_u32 s6, s6, s92
s_add_u32 s11, s7, s90
s_lshl_b32 s11, s11, 11
s_lshl_b32 s7, s7, 14
s_add_u32 s7, s7, s92
s_lshl_b32 s91, s74, 2
s_add_u32 s12, s91, s90
s_add_u32 s12, s12, 86
s_lshl_b32 s12, s12, 11
s_lshl_b32 s13, s74, 16
s_add_u32 s13, s13, s92
s_lshl_b32 s14, s77, 2
s_add_u32 s14, s14, s74
s_lshl_b32 s14, s14, 8
s_add_u32 s14, s14, 8192
s_mov_b64 s[18:19], s[6:7]
s_mov_b64 s[20:21], s[10:11]
s_add_u32 s22, s12, 32768
s_add_u32 s23, s13, 262144
s_xor_b32 s90, s78, s77
s_bitcmp1_b32 s90, 1
s_cselect_b32 s90, s5, s4
s_cselect_b32 s5, s4, s5
s_mov_b32 s4, s90
s_cselect_b32 s90, s7, s6
s_cselect_b32 s7, s6, s7
s_mov_b32 s6, s90
s_cselect_b32 s90, s9, s8
s_cselect_b32 s9, s8, s9
s_mov_b32 s8, s90
s_cselect_b32 s90, s11, s10
s_cselect_b32 s11, s10, s11
s_mov_b32 s10, s90
s_cselect_b32 s90, s22, s12
s_cselect_b32 s22, s12, s22
s_mov_b32 s12, s90
s_cselect_b32 s90, s23, s13
s_cselect_b32 s23, s13, s23
s_mov_b32 s13, s90
v_bfe_u32 v68, v1, 2, 2
v_and_b32 v69, 3, v1
v_lshlrev_b32 v69, 4, v69
v_lshrrev_b32 v70, 4, v1
v_and_b32 v71, 32, v1
v_xor_b32 v69, v69, v71
v_lshrrev_b32 v71, 5, v1
v_lshl_add_u32 v71, v71, 2, v68
v_mul_u32_u24 v71, 1024, v71
v_and_b32_e64 v72, 1, v70
v_lshl_add_u32 v72, v72, 6, v69
v_add3_u32 v32, v71, v72, 0
v_add_u32 v33, 7168, v32
v_add_u32 v34, 14336, v32
v_add_u32 v35, 21504, v32
s_cmp_ge_u32 s74, 2
s_cselect_b32 s90, 2146435072, 0
v_add_u32 v36, s90, v34
v_add_u32 v37, s90, v35
v_add_u32 v39, s90, v38
s_sub_u32 s91, s21, s20
s_add_u32 s90, s90, s91
v_and_b32_e64 v68, 15, v1
v_bfe_u32 v69, v1, 4, 1
v_lshlrev_b32_e64 v68, 4, v68
v_lshl_add_u32 v68, v69, 9, v68
v_lshrrev_b32_e64 v69, 5, v1
v_lshl_add_u32 v77, v69, 11, v68
v_mul_lo_u32 v69, v69, s90
v_add_u32_e64 v39, v68, v69
s_lshl_b32 s94, s72, 1
s_add_u32 s94, s94, s75
s_mul_i32 s94, s94, 241664
s_lshl_b32 s15, s73, 2
s_add_u32 s15, s15, s74
s_lshl_b32 s15, s15, 8
s_lshl_b32 s16, s72, 1
s_add_u32 s16, s16, s75
s_lshl_b32 s16, s16, 10
s_add_u32 s16, s16, 8192
s_and_b32 s17, s73, 3
s_lshl_b32 s17, s17, 8
s_add_u32 s17, s17, s16
s_and_b32 s90, s2, 63
s_lshr_b32 s91, s2, 7
s_lshl_b32 s91, s91, 6
s_add_u32 s90, s90, s91
s_lshl_b32 s90, s90, 2
s_add_u32 s90, s90, s74
s_mul_i32 s91, s90, 2816
s_lshl_b32 s90, s90, 10
v_mov_b32 v68, 2146435072
v_lshl_add_u32 v69, v1, 7, s91
s_mov_b64 vcc, 0x3fffff
s_mov_b64 s[100:101], 0xff
v_lshl_add_u32 v70, v1, 7, s90
v_cndmask_b32_e64 v44, v68, v69, vcc
v_cndmask_b32 v46, v68, v70, s[100:101]
s_add_u32 m0, s87, 16384
s_add_u32 s84, s79, 128
s_and_b32 s84, s84, 0x380
buffer_load_dwordx4 v2, s[28:31], s84 offen lds
buffer_load_dwordx4 v3, s[28:31], s84 offen offset:1024 lds
buffer_load_dwordx4 v4, s[28:31], s84 offen offset:2048 lds
buffer_load_dwordx4 v5, s[28:31], s84 offen offset:3072 lds
s_add_u32 m0, s87, 81920
s_mul_i32 s85, s84, 1536
buffer_load_dwordx4 v6, s[32:35], s85 offen lds
buffer_load_dwordx4 v7, s[32:35], s85 offen offset:1024 lds
buffer_load_dwordx4 v8, s[32:35], s85 offen offset:2048 lds
buffer_load_dwordx4 v9, s[32:35], s85 offen offset:3072 lds
s_waitcnt vmcnt(8)
s_barrier
ds_read_b128 a[0:3], v16 offset:0
ds_read_b128 a[4:7], v16 offset:2048
ds_read_b64_tr_b16 v[80:81], v60 offset:0
ds_read_b64_tr_b16 v[82:83], v60 offset:1024
ds_read_b64_tr_b16 v[84:85], v61 offset:0
ds_read_b64_tr_b16 v[86:87], v61 offset:1024
ds_read_b128 a[8:11], v18 offset:0
ds_read_b128 a[12:15], v18 offset:2048
ds_read_b64_tr_b16 v[88:89], v62 offset:512
ds_read_b64_tr_b16 v[90:91], v62 offset:1536
ds_read_b64_tr_b16 v[92:93], v63 offset:512
ds_read_b64_tr_b16 v[94:95], v63 offset:1536
s_waitcnt lgkmcnt(8)
v_mfma_f32_16x16x32_bf16 v[128:131], v[80:83], a[0:3], 0
ds_read_b128 a[16:19], v17 offset:0
ds_read_b128 a[20:23], v17 offset:2048
s_add_u32 m0, s87, 32768
s_add_u32 s84, s79, 256
s_and_b32 s84, s84, 0x380
v_mfma_f32_16x16x32_bf16 v[132:135], v[80:83], a[4:7], 0
buffer_load_dwordx4 v2, s[28:31], s84 offen lds
s_waitcnt lgkmcnt(8)
v_mfma_f32_16x16x32_bf16 v[136:139], v[84:87], a[0:3], 0
buffer_load_dwordx4 v3, s[28:31], s84 offen offset:1024 lds
v_mfma_f32_16x16x32_bf16 v[140:143], v[84:87], a[4:7], 0
ds_read_b64_tr_b16 v[96:97], v60 offset:8192
ds_read_b64_tr_b16 v[98:99], v60 offset:9216
s_waitcnt lgkmcnt(4)
v_mfma_f32_16x16x32_bf16 v[160:163], a[0:3], v[88:91], 0
buffer_load_dwordx4 v4, s[28:31], s84 offen offset:2048 lds
v_mfma_f32_16x16x32_bf16 v[168:171], a[4:7], v[88:91], 0
ds_read_b64_tr_b16 v[100:101], v61 offset:8192
v_mfma_f32_16x16x32_bf16 v[164:167], a[0:3], v[92:95], 0
buffer_load_dwordx4 v5, s[28:31], s84 offen offset:3072 lds
v_mfma_f32_16x16x32_bf16 v[172:175], a[4:7], v[92:95], 0
ds_read_b64_tr_b16 v[102:103], v61 offset:9216
v_mfma_f32_16x16x32_bf16 v[144:147], v[80:83], a[8:11], 0
ds_read_b128 a[24:27], v19 offset:0
ds_read_b128 a[28:31], v19 offset:2048
s_add_u32 m0, s87, 98304
s_mul_i32 s85, s84, 1536
v_mfma_f32_16x16x32_bf16 v[148:151], v[80:83], a[12:15], 0
buffer_load_dwordx4 v6, s[32:35], s85 offen lds
v_mfma_f32_16x16x32_bf16 v[152:155], v[84:87], a[8:11], 0
buffer_load_dwordx4 v7, s[32:35], s85 offen offset:1024 lds
v_mfma_f32_16x16x32_bf16 v[156:159], v[84:87], a[12:15], 0
ds_read_b64_tr_b16 v[104:105], v62 offset:8704
ds_read_b64_tr_b16 v[106:107], v62 offset:9728
v_mfma_f32_16x16x32_bf16 v[176:179], a[8:11], v[88:91], 0
buffer_load_dwordx4 v8, s[32:35], s85 offen offset:2048 lds
v_mfma_f32_16x16x32_bf16 v[184:187], a[12:15], v[88:91], 0
ds_read_b64_tr_b16 v[108:109], v63 offset:8704
v_mfma_f32_16x16x32_bf16 v[180:183], a[8:11], v[92:95], 0
buffer_load_dwordx4 v9, s[32:35], s85 offen offset:3072 lds
v_mfma_f32_16x16x32_bf16 v[188:191], a[12:15], v[92:95], 0
ds_read_b64_tr_b16 v[110:111], v63 offset:9728
s_waitcnt lgkmcnt(0)
v_mfma_f32_16x16x32_bf16 v[128:131], v[96:99], a[16:19], v[128:131]
s_waitcnt vmcnt(8)
s_barrier
ds_read_b128 a[32:35], v16 offset:16384
ds_read_b128 a[36:39], v16 offset:18432
s_add_u32 m0, s87, 49152
s_add_u32 s84, s79, 384
s_and_b32 s84, s84, 0x380
v_mfma_f32_16x16x32_bf16 v[132:135], v[96:99], a[20:23], v[132:135]
buffer_load_dwordx4 v2, s[28:31], s84 offen lds
v_mfma_f32_16x16x32_bf16 v[136:139], v[100:103], a[16:19], v[136:139]
buffer_load_dwordx4 v3, s[28:31], s84 offen offset:1024 lds
v_mfma_f32_16x16x32_bf16 v[140:143], v[100:103], a[20:23], v[140:143]
ds_read_b64_tr_b16 v[80:81], v60 offset:16384
ds_read_b64_tr_b16 v[82:83], v60 offset:17408
v_mfma_f32_16x16x32_bf16 v[160:163], a[16:19], v[104:107], v[160:163]
buffer_load_dwordx4 v4, s[28:31], s84 offen offset:2048 lds
v_mfma_f32_16x16x32_bf16 v[168:171], a[20:23], v[104:107], v[168:171]
ds_read_b64_tr_b16 v[84:85], v61 offset:16384
v_mfma_f32_16x16x32_bf16 v[164:167], a[16:19], v[108:111], v[164:167]
buffer_load_dwordx4 v5, s[28:31], s84 offen offset:3072 lds
v_mfma_f32_16x16x32_bf16 v[172:175], a[20:23], v[108:111], v[172:175]
ds_read_b64_tr_b16 v[86:87], v61 offset:17408
v_mfma_f32_16x16x32_bf16 v[144:147], v[96:99], a[24:27], v[144:147]
ds_read_b128 a[40:43], v18 offset:16384
ds_read_b128 a[44:47], v18 offset:18432
s_add_u32 m0, s87, 114688
s_mul_i32 s85, s84, 1536
v_mfma_f32_16x16x32_bf16 v[148:151], v[96:99], a[28:31], v[148:151]
buffer_load_dwordx4 v6, s[32:35], s85 offen lds
v_mfma_f32_16x16x32_bf16 v[152:155], v[100:103], a[24:27], v[152:155]
buffer_load_dwordx4 v7, s[32:35], s85 offen offset:1024 lds
v_mfma_f32_16x16x32_bf16 v[156:159], v[100:103], a[28:31], v[156:159]
ds_read_b64_tr_b16 v[88:89], v62 offset:16896
ds_read_b64_tr_b16 v[90:91], v62 offset:17920
v_mfma_f32_16x16x32_bf16 v[176:179], a[24:27], v[104:107], v[176:179]
buffer_load_dwordx4 v8, s[32:35], s85 offen offset:2048 lds
v_mfma_f32_16x16x32_bf16 v[184:187], a[28:31], v[104:107], v[184:187]
ds_read_b64_tr_b16 v[92:93], v63 offset:16896
v_mfma_f32_16x16x32_bf16 v[180:183], a[24:27], v[108:111], v[180:183]
buffer_load_dwordx4 v9, s[32:35], s85 offen offset:3072 lds
v_mfma_f32_16x16x32_bf16 v[188:191], a[28:31], v[108:111], v[188:191]
ds_read_b64_tr_b16 v[94:95], v63 offset:17920
s_waitcnt lgkmcnt(6)
v_mfma_f32_16x16x32_bf16 v[128:131], v[80:83], a[32:35], v[128:131]
ds_read_b128 a[48:51], v17 offset:16384
s_add_u32 m0, s87, 0
v_mfma_f32_16x16x32_bf16 v[132:135], v[80:83], a[36:39], v[132:135]
ds_read_b128 a[52:55], v17 offset:18432
s_add_u32 s84, s79, 512
s_and_b32 s84, s84, 0x380
v_mfma_f32_16x16x32_bf16 v[136:139], v[84:87], a[32:35], v[136:139]
buffer_load_dwordx4 v2, s[28:31], s84 offen lds
v_mfma_f32_16x16x32_bf16 v[140:143], v[84:87], a[36:39], v[140:143]
ds_read_b64_tr_b16 v[96:97], v60 offset:24576
s_waitcnt lgkmcnt(3)
v_mfma_f32_16x16x32_bf16 v[160:163], a[32:35], v[88:91], v[160:163]
ds_read_b64_tr_b16 v[98:99], v60 offset:25600
v_mfma_f32_16x16x32_bf16 v[168:171], a[36:39], v[88:91], v[168:171]
ds_read_b64_tr_b16 v[100:101], v61 offset:24576
v_mfma_f32_16x16x32_bf16 v[164:167], a[32:35], v[92:95], v[164:167]
buffer_load_dwordx4 v3, s[28:31], s84 offen offset:1024 lds
v_mfma_f32_16x16x32_bf16 v[172:175], a[36:39], v[92:95], v[172:175]
ds_read_b64_tr_b16 v[102:103], v61 offset:25600
v_mfma_f32_16x16x32_bf16 v[144:147], v[80:83], a[40:43], v[144:147]
ds_read_b128 a[56:59], v19 offset:16384
v_mfma_f32_16x16x32_bf16 v[148:151], v[80:83], a[44:47], v[148:151]
ds_read_b128 a[60:63], v19 offset:18432
v_mfma_f32_16x16x32_bf16 v[152:155], v[84:87], a[40:43], v[152:155]
ds_read_b64_tr_b16 v[104:105], v62 offset:25088
v_mfma_f32_16x16x32_bf16 v[156:159], v[84:87], a[44:47], v[156:159]
ds_read_b64_tr_b16 v[106:107], v62 offset:26112
v_mfma_f32_16x16x32_bf16 v[176:179], a[40:43], v[88:91], v[176:179]
buffer_load_dwordx4 v4, s[28:31], s84 offen offset:2048 lds
v_mfma_f32_16x16x32_bf16 v[184:187], a[44:47], v[88:91], v[184:187]
ds_read_b64_tr_b16 v[108:109], v63 offset:25088
v_mfma_f32_16x16x32_bf16 v[180:183], a[40:43], v[92:95], v[180:183]
buffer_load_dwordx4 v5, s[28:31], s84 offen offset:3072 lds
v_mfma_f32_16x16x32_bf16 v[188:191], a[44:47], v[92:95], v[188:191]
ds_read_b64_tr_b16 v[110:111], v63 offset:26112
s_waitcnt lgkmcnt(0)
v_mfma_f32_16x16x32_bf16 v[128:131], v[96:99], a[48:51], v[128:131]
s_waitcnt vmcnt(12)
s_barrier
ds_read_b128 a[64:67], v16 offset:32768
v_mfma_f32_16x16x32_bf16 v[132:135], v[96:99], a[52:55], v[132:135]
ds_read_b128 a[68:71], v16 offset:34816
s_add_u32 m0, s87, 65536
s_mul_i32 s85, s84, 1536
v_mfma_f32_16x16x32_bf16 v[136:139], v[100:103], a[48:51], v[136:139]
buffer_load_dwordx4 v6, s[32:35], s85 offen lds
v_mfma_f32_16x16x32_bf16 v[140:143], v[100:103], a[52:55], v[140:143]
ds_read_b64_tr_b16 v[80:81], v60 offset:32768
v_mfma_f32_16x16x32_bf16 v[160:163], a[48:51], v[104:107], v[160:163]
ds_read_b64_tr_b16 v[82:83], v60 offset:33792
v_mfma_f32_16x16x32_bf16 v[168:171], a[52:55], v[104:107], v[168:171]
ds_read_b64_tr_b16 v[84:85], v61 offset:32768
v_mfma_f32_16x16x32_bf16 v[164:167], a[48:51], v[108:111], v[164:167]
buffer_load_dwordx4 v7, s[32:35], s85 offen offset:1024 lds
v_mfma_f32_16x16x32_bf16 v[172:175], a[52:55], v[108:111], v[172:175]
ds_read_b64_tr_b16 v[86:87], v61 offset:33792
v_mfma_f32_16x16x32_bf16 v[144:147], v[96:99], a[56:59], v[144:147]
ds_read_b128 a[72:75], v18 offset:32768
v_mfma_f32_16x16x32_bf16 v[148:151], v[96:99], a[60:63], v[148:151]
ds_read_b128 a[76:79], v18 offset:34816
v_mfma_f32_16x16x32_bf16 v[152:155], v[100:103], a[56:59], v[152:155]
buffer_load_dwordx4 v8, s[32:35], s85 offen offset:2048 lds
v_mfma_f32_16x16x32_bf16 v[156:159], v[100:103], a[60:63], v[156:159]
ds_read_b64_tr_b16 v[88:89], v62 offset:33280
v_mfma_f32_16x16x32_bf16 v[176:179], a[56:59], v[104:107], v[176:179]
ds_read_b64_tr_b16 v[90:91], v62 offset:34304
v_mfma_f32_16x16x32_bf16 v[184:187], a[60:63], v[104:107], v[184:187]
ds_read_b64_tr_b16 v[92:93], v63 offset:33280
v_mfma_f32_16x16x32_bf16 v[180:183], a[56:59], v[108:111], v[180:183]
buffer_load_dwordx4 v9, s[32:35], s85 offen offset:3072 lds
v_mfma_f32_16x16x32_bf16 v[188:191], a[60:63], v[108:111], v[188:191]
ds_read_b64_tr_b16 v[94:95], v63 offset:34304
s_waitcnt lgkmcnt(6)
v_mfma_f32_16x16x32_bf16 v[128:131], v[80:83], a[64:67], v[128:131]
ds_read_b128 a[80:83], v17 offset:32768
s_add_u32 m0, s87, 16384
v_mfma_f32_16x16x32_bf16 v[132:135], v[80:83], a[68:71], v[132:135]
ds_read_b128 a[84:87], v17 offset:34816
s_add_u32 s84, s79, 640
s_and_b32 s84, s84, 0x380
v_mfma_f32_16x16x32_bf16 v[136:139], v[84:87], a[64:67], v[136:139]
buffer_load_dwordx4 v2, s[28:31], s84 offen lds
v_mfma_f32_16x16x32_bf16 v[140:143], v[84:87], a[68:71], v[140:143]
ds_read_b64_tr_b16 v[96:97], v60 offset:40960
s_waitcnt lgkmcnt(3)
v_mfma_f32_16x16x32_bf16 v[160:163], a[64:67], v[88:91], v[160:163]
ds_read_b64_tr_b16 v[98:99], v60 offset:41984
v_mfma_f32_16x16x32_bf16 v[168:171], a[68:71], v[88:91], v[168:171]
ds_read_b64_tr_b16 v[100:101], v61 offset:40960
v_mfma_f32_16x16x32_bf16 v[164:167], a[64:67], v[92:95], v[164:167]
buffer_load_dwordx4 v3, s[28:31], s84 offen offset:1024 lds
v_mfma_f32_16x16x32_bf16 v[172:175], a[68:71], v[92:95], v[172:175]
ds_read_b64_tr_b16 v[102:103], v61 offset:41984
v_mfma_f32_16x16x32_bf16 v[144:147], v[80:83], a[72:75], v[144:147]
ds_read_b128 a[88:91], v19 offset:32768
v_mfma_f32_16x16x32_bf16 v[148:151], v[80:83], a[76:79], v[148:151]
ds_read_b128 a[92:95], v19 offset:34816
v_mfma_f32_16x16x32_bf16 v[152:155], v[84:87], a[72:75], v[152:155]
ds_read_b64_tr_b16 v[104:105], v62 offset:41472
v_mfma_f32_16x16x32_bf16 v[156:159], v[84:87], a[76:79], v[156:159]
ds_read_b64_tr_b16 v[106:107], v62 offset:42496
v_mfma_f32_16x16x32_bf16 v[176:179], a[72:75], v[88:91], v[176:179]
buffer_load_dwordx4 v4, s[28:31], s84 offen offset:2048 lds
v_mfma_f32_16x16x32_bf16 v[184:187], a[76:79], v[88:91], v[184:187]
ds_read_b64_tr_b16 v[108:109], v63 offset:41472
v_mfma_f32_16x16x32_bf16 v[180:183], a[72:75], v[92:95], v[180:183]
buffer_load_dwordx4 v5, s[28:31], s84 offen offset:3072 lds
v_mfma_f32_16x16x32_bf16 v[188:191], a[76:79], v[92:95], v[188:191]
ds_read_b64_tr_b16 v[110:111], v63 offset:42496
s_waitcnt lgkmcnt(0)
v_mfma_f32_16x16x32_bf16 v[128:131], v[96:99], a[80:83], v[128:131]
s_waitcnt vmcnt(12)
s_barrier
ds_read_b128 a[96:99], v16 offset:49152
v_mfma_f32_16x16x32_bf16 v[132:135], v[96:99], a[84:87], v[132:135]
ds_read_b128 a[100:103], v16 offset:51200
s_add_u32 m0, s87, 81920
s_mul_i32 s85, s84, 1536
v_mfma_f32_16x16x32_bf16 v[136:139], v[100:103], a[80:83], v[136:139]
buffer_load_dwordx4 v6, s[32:35], s85 offen lds
v_mfma_f32_16x16x32_bf16 v[140:143], v[100:103], a[84:87], v[140:143]
ds_read_b64_tr_b16 v[80:81], v60 offset:49152
v_mfma_f32_16x16x32_bf16 v[160:163], a[80:83], v[104:107], v[160:163]
ds_read_b64_tr_b16 v[82:83], v60 offset:50176
v_mfma_f32_16x16x32_bf16 v[168:171], a[84:87], v[104:107], v[168:171]
ds_read_b64_tr_b16 v[84:85], v61 offset:49152
v_mfma_f32_16x16x32_bf16 v[164:167], a[80:83], v[108:111], v[164:167]
buffer_load_dwordx4 v7, s[32:35], s85 offen offset:1024 lds
v_mfma_f32_16x16x32_bf16 v[172:175], a[84:87], v[108:111], v[172:175]
ds_read_b64_tr_b16 v[86:87], v61 offset:50176
v_mfma_f32_16x16x32_bf16 v[144:147], v[96:99], a[88:91], v[144:147]
ds_read_b128 a[104:107], v18 offset:49152
v_mfma_f32_16x16x32_bf16 v[148:151], v[96:99], a[92:95], v[148:151]
ds_read_b128 a[108:111], v18 offset:51200
v_mfma_f32_16x16x32_bf16 v[152:155], v[100:103], a[88:91], v[152:155]
buffer_load_dwordx4 v8, s[32:35], s85 offen offset:2048 lds
v_mfma_f32_16x16x32_bf16 v[156:159], v[100:103], a[92:95], v[156:159]
ds_read_b64_tr_b16 v[88:89], v62 offset:49664
v_mfma_f32_16x16x32_bf16 v[176:179], a[88:91], v[104:107], v[176:179]
ds_read_b64_tr_b16 v[90:91], v62 offset:50688
v_mfma_f32_16x16x32_bf16 v[184:187], a[92:95], v[104:107], v[184:187]
ds_read_b64_tr_b16 v[92:93], v63 offset:49664
v_mfma_f32_16x16x32_bf16 v[180:183], a[88:91], v[108:111], v[180:183]
buffer_load_dwordx4 v9, s[32:35], s85 offen offset:3072 lds
v_mfma_f32_16x16x32_bf16 v[188:191], a[92:95], v[108:111], v[188:191]
ds_read_b64_tr_b16 v[94:95], v63 offset:50688
s_waitcnt lgkmcnt(6)
v_mfma_f32_16x16x32_bf16 v[128:131], v[80:83], a[96:99], v[128:131]
ds_read_b128 a[112:115], v17 offset:49152
s_lshl_b32 s85, s73, 1
v_mfma_f32_16x16x32_bf16 v[132:135], v[80:83], a[100:103], v[132:135]
ds_read_b128 a[116:119], v17 offset:51200
s_add_u32 s85, s85, s76
s_lshr_b32 s86, s87, 2
s_add_u32 m0, s86, 147456
s_lshl_b32 s85, s85, 10
v_mfma_f32_16x16x32_bf16 v[136:139], v[84:87], a[96:99], v[136:139]
buffer_load_dwordx4 v38, s[60:63], s85 offen lds
v_mfma_f32_16x16x32_bf16 v[140:143], v[84:87], a[100:103], v[140:143]
ds_read_b64_tr_b16 v[96:97], v60 offset:57344
s_waitcnt lgkmcnt(3)
v_mfma_f32_16x16x32_bf16 v[160:163], a[96:99], v[88:91], v[160:163]
ds_read_b64_tr_b16 v[98:99], v60 offset:58368
s_add_u32 m0, s86, 159744
v_mfma_f32_16x16x32_bf16 v[168:171], a[100:103], v[88:91], v[168:171]
ds_read_b64_tr_b16 v[100:101], v61 offset:57344
s_mov_b32 s85, 0
v_mfma_f32_16x16x32_bf16 v[164:167], a[96:99], v[92:95], v[164:167]
buffer_load_dwordx4 v38, s[64:67], s85 offen lds
v_mfma_f32_16x16x32_bf16 v[172:175], a[100:103], v[92:95], v[172:175]
ds_read_b64_tr_b16 v[102:103], v61 offset:58368
v_mfma_f32_16x16x32_bf16 v[144:147], v[80:83], a[104:107], v[144:147]
ds_read_b128 a[120:123], v19 offset:49152
s_add_u32 m0, s87, 32768
v_mfma_f32_16x16x32_bf16 v[148:151], v[80:83], a[108:111], v[148:151]
ds_read_b128 a[124:127], v19 offset:51200
s_add_u32 s84, s79, 768
v_mfma_f32_16x16x32_bf16 v[152:155], v[84:87], a[104:107], v[152:155]
ds_read_b64_tr_b16 v[104:105], v62 offset:57856
s_and_b32 s84, s84, 0x380
v_mfma_f32_16x16x32_bf16 v[156:159], v[84:87], a[108:111], v[156:159]
ds_read_b64_tr_b16 v[106:107], v62 offset:58880
v_mfma_f32_16x16x32_bf16 v[176:179], a[104:107], v[88:91], v[176:179]
buffer_load_dwordx4 v2, s[28:31], s84 offen lds
v_mfma_f32_16x16x32_bf16 v[184:187], a[108:111], v[88:91], v[184:187]
ds_read_b64_tr_b16 v[108:109], v63 offset:57856
v_mfma_f32_16x16x32_bf16 v[180:183], a[104:107], v[92:95], v[180:183]
buffer_load_dwordx4 v3, s[28:31], s84 offen offset:1024 lds
v_mfma_f32_16x16x32_bf16 v[188:191], a[108:111], v[92:95], v[188:191]
ds_read_b64_tr_b16 v[110:111], v63 offset:58880
s_waitcnt lgkmcnt(0)
v_mfma_f32_16x16x32_bf16 v[128:131], v[96:99], a[112:115], v[128:131]
s_waitcnt vmcnt(12)
s_barrier
ds_read_b128 a[128:131], v16 offset:0
v_mfma_f32_16x16x32_bf16 v[132:135], v[96:99], a[116:119], v[132:135]
ds_read_b128 a[132:135], v16 offset:2048
v_mfma_f32_16x16x32_bf16 v[136:139], v[100:103], a[112:115], v[136:139]
buffer_load_dwordx4 v4, s[28:31], s84 offen offset:2048 lds
v_mfma_f32_16x16x32_bf16 v[140:143], v[100:103], a[116:119], v[140:143]
ds_read_b64_tr_b16 v[80:81], v60 offset:0
v_mfma_f32_16x16x32_bf16 v[160:163], a[112:115], v[104:107], v[160:163]
ds_read_b64_tr_b16 v[82:83], v60 offset:1024
L_pad_KL_1:
s_cbranch_execz L_pad_KL_2
s_nop 0
v_mfma_f32_16x16x32_bf16 v[168:171], a[116:119], v[104:107], v[168:171]
ds_read_b64_tr_b16 v[84:85], v61 offset:0
v_mfma_f32_16x16x32_bf16 v[164:167], a[112:115], v[108:111], v[164:167]
buffer_load_dwordx4 v5, s[28:31], s84 offen offset:3072 lds
v_mfma_f32_16x16x32_bf16 v[172:175], a[116:119], v[108:111], v[172:175]
ds_read_b64_tr_b16 v[86:87], v61 offset:1024
v_mfma_f32_16x16x32_bf16 v[144:147], v[96:99], a[120:123], v[144:147]
ds_read_b128 a[136:139], v18 offset:0
s_add_u32 m0, s87, 98304
v_mfma_f32_16x16x32_bf16 v[148:151], v[96:99], a[124:127], v[148:151]
ds_read_b128 a[140:143], v18 offset:2048
s_mul_i32 s85, s84, 1536
v_mfma_f32_16x16x32_bf16 v[152:155], v[100:103], a[120:123], v[152:155]
buffer_load_dwordx4 v6, s[32:35], s85 offen lds
v_mfma_f32_16x16x32_bf16 v[156:159], v[100:103], a[124:127], v[156:159]
ds_read_b64_tr_b16 v[88:89], v62 offset:512
v_mfma_f32_16x16x32_bf16 v[176:179], a[120:123], v[104:107], v[176:179]
ds_read_b64_tr_b16 v[90:91], v62 offset:1536
v_mfma_f32_16x16x32_bf16 v[184:187], a[124:127], v[104:107], v[184:187]
ds_read_b64_tr_b16 v[92:93], v63 offset:512
v_mfma_f32_16x16x32_bf16 v[180:183], a[120:123], v[108:111], v[180:183]
buffer_load_dwordx4 v7, s[32:35], s85 offen offset:1024 lds
v_mfma_f32_16x16x32_bf16 v[188:191], a[124:127], v[108:111], v[188:191]
ds_read_b64_tr_b16 v[94:95], v63 offset:1536
s_waitcnt lgkmcnt(6)
v_mfma_f32_16x16x32_bf16 v[128:131], v[80:83], a[128:131], v[128:131]
ds_read_b128 a[144:147], v17 offset:0
v_mfma_f32_16x16x32_bf16 v[132:135], v[80:83], a[132:135], v[132:135]
ds_read_b128 a[148:151], v17 offset:2048
v_mfma_f32_16x16x32_bf16 v[136:139], v[84:87], a[128:131], v[136:139]
buffer_load_dwordx4 v8, s[32:35], s85 offen offset:2048 lds
v_mfma_f32_16x16x32_bf16 v[140:143], v[84:87], a[132:135], v[140:143]
ds_read_b64_tr_b16 v[96:97], v60 offset:8192
s_waitcnt lgkmcnt(3)
v_mfma_f32_16x16x32_bf16 v[160:163], a[128:131], v[88:91], v[160:163]
ds_read_b64_tr_b16 v[98:99], v60 offset:9216
v_mfma_f32_16x16x32_bf16 v[168:171], a[132:135], v[88:91], v[168:171]
ds_read_b64_tr_b16 v[100:101], v61 offset:8192
v_mfma_f32_16x16x32_bf16 v[164:167], a[128:131], v[92:95], v[164:167]
buffer_load_dwordx4 v9, s[32:35], s85 offen offset:3072 lds
v_mfma_f32_16x16x32_bf16 v[172:175], a[132:135], v[92:95], v[172:175]
ds_read_b64_tr_b16 v[102:103], v61 offset:9216
v_mfma_f32_16x16x32_bf16 v[144:147], v[80:83], a[136:139], v[144:147]
ds_read_b128 a[152:155], v19 offset:0
s_add_u32 m0, s87, 49152
v_mfma_f32_16x16x32_bf16 v[148:151], v[80:83], a[140:143], v[148:151]
ds_read_b128 a[156:159], v19 offset:2048
s_add_u32 s84, s79, 896
v_mfma_f32_16x16x32_bf16 v[152:155], v[84:87], a[136:139], v[152:155]
ds_read_b64_tr_b16 v[104:105], v62 offset:8704
s_and_b32 s84, s84, 0x380
v_mfma_f32_16x16x32_bf16 v[156:159], v[84:87], a[140:143], v[156:159]
ds_read_b64_tr_b16 v[106:107], v62 offset:9728
v_mfma_f32_16x16x32_bf16 v[176:179], a[136:139], v[88:91], v[176:179]
buffer_load_dwordx4 v2, s[28:31], s84 offen lds
v_mfma_f32_16x16x32_bf16 v[184:187], a[140:143], v[88:91], v[184:187]
ds_read_b64_tr_b16 v[108:109], v63 offset:8704
v_mfma_f32_16x16x32_bf16 v[180:183], a[136:139], v[92:95], v[180:183]
buffer_load_dwordx4 v3, s[28:31], s84 offen offset:1024 lds
v_mfma_f32_16x16x32_bf16 v[188:191], a[140:143], v[92:95], v[188:191]
ds_read_b64_tr_b16 v[110:111], v63 offset:9728
s_waitcnt lgkmcnt(0)
v_mfma_f32_16x16x32_bf16 v[128:131], v[96:99], a[144:147], v[128:131]
s_waitcnt vmcnt(12)
s_barrier
ds_read_b128 a[160:163], v16 offset:16384
v_mfma_f32_16x16x32_bf16 v[132:135], v[96:99], a[148:151], v[132:135]
ds_read_b128 a[164:167], v16 offset:18432
v_mfma_f32_16x16x32_bf16 v[136:139], v[100:103], a[144:147], v[136:139]
buffer_load_dwordx4 v4, s[28:31], s84 offen offset:2048 lds
v_mfma_f32_16x16x32_bf16 v[140:143], v[100:103], a[148:151], v[140:143]
ds_read_b64_tr_b16 v[80:81], v60 offset:16384
v_mfma_f32_16x16x32_bf16 v[160:163], a[144:147], v[104:107], v[160:163]
ds_read_b64_tr_b16 v[82:83], v60 offset:17408
v_mfma_f32_16x16x32_bf16 v[168:171], a[148:151], v[104:107], v[168:171]
ds_read_b64_tr_b16 v[84:85], v61 offset:16384
v_mfma_f32_16x16x32_bf16 v[164:167], a[144:147], v[108:111], v[164:167]
buffer_load_dwordx4 v5, s[28:31], s84 offen offset:3072 lds
v_mfma_f32_16x16x32_bf16 v[172:175], a[148:151], v[108:111], v[172:175]
ds_read_b64_tr_b16 v[86:87], v61 offset:17408
v_mfma_f32_16x16x32_bf16 v[144:147], v[96:99], a[152:155], v[144:147]
ds_read_b128 a[168:171], v18 offset:16384
s_add_u32 m0, s87, 114688
v_mfma_f32_16x16x32_bf16 v[148:151], v[96:99], a[156:159], v[148:151]
ds_read_b128 a[172:175], v18 offset:18432
s_mul_i32 s85, s84, 1536
v_mfma_f32_16x16x32_bf16 v[152:155], v[100:103], a[152:155], v[152:155]
buffer_load_dwordx4 v6, s[32:35], s85 offen lds
v_mfma_f32_16x16x32_bf16 v[156:159], v[100:103], a[156:159], v[156:159]
ds_read_b64_tr_b16 v[88:89], v62 offset:16896
v_mfma_f32_16x16x32_bf16 v[176:179], a[152:155], v[104:107], v[176:179]
ds_read_b64_tr_b16 v[90:91], v62 offset:17920
v_mfma_f32_16x16x32_bf16 v[184:187], a[156:159], v[104:107], v[184:187]
ds_read_b64_tr_b16 v[92:93], v63 offset:16896
v_mfma_f32_16x16x32_bf16 v[180:183], a[152:155], v[108:111], v[180:183]
buffer_load_dwordx4 v7, s[32:35], s85 offen offset:1024 lds
v_mfma_f32_16x16x32_bf16 v[188:191], a[156:159], v[108:111], v[188:191]
ds_read_b64_tr_b16 v[94:95], v63 offset:17920
s_waitcnt lgkmcnt(6)
v_mfma_f32_16x16x32_bf16 v[128:131], v[80:83], a[160:163], v[128:131]
ds_read_b128 a[176:179], v17 offset:16384
v_mfma_f32_16x16x32_bf16 v[132:135], v[80:83], a[164:167], v[132:135]
ds_read_b128 a[180:183], v17 offset:18432
v_mfma_f32_16x16x32_bf16 v[136:139], v[84:87], a[160:163], v[136:139]
buffer_load_dwordx4 v8, s[32:35], s85 offen offset:2048 lds
v_mfma_f32_16x16x32_bf16 v[140:143], v[84:87], a[164:167], v[140:143]
ds_read_b64_tr_b16 v[96:97], v60 offset:24576
s_waitcnt lgkmcnt(3)
v_mfma_f32_16x16x32_bf16 v[160:163], a[160:163], v[88:91], v[160:163]
ds_read_b64_tr_b16 v[98:99], v60 offset:25600
v_mfma_f32_16x16x32_bf16 v[168:171], a[164:167], v[88:91], v[168:171]
ds_read_b64_tr_b16 v[100:101], v61 offset:24576
v_mfma_f32_16x16x32_bf16 v[164:167], a[160:163], v[92:95], v[164:167]
buffer_load_dwordx4 v9, s[32:35], s85 offen offset:3072 lds
v_mfma_f32_16x16x32_bf16 v[172:175], a[164:167], v[92:95], v[172:175]
ds_read_b64_tr_b16 v[102:103], v61 offset:25600
v_mfma_f32_16x16x32_bf16 v[144:147], v[80:83], a[168:171], v[144:147]
ds_read_b128 a[184:187], v19 offset:16384
v_mfma_f32_16x16x32_bf16 v[148:151], v[80:83], a[172:175], v[148:151]
ds_read_b128 a[188:191], v19 offset:18432
v_mfma_f32_16x16x32_bf16 v[152:155], v[84:87], a[168:171], v[152:155]
ds_read_b64_tr_b16 v[104:105], v62 offset:25088
v_mfma_f32_16x16x32_bf16 v[156:159], v[84:87], a[172:175], v[156:159]
ds_read_b64_tr_b16 v[106:107], v62 offset:26112
v_mfma_f32_16x16x32_bf16 v[176:179], a[168:171], v[88:91], v[176:179]
buffer_load_dword v46, v46, s[44:47], 0 offen
v_mfma_f32_16x16x32_bf16 v[184:187], a[172:175], v[88:91], v[184:187]
ds_read_b64_tr_b16 v[108:109], v63 offset:25088
v_mfma_f32_16x16x32_bf16 v[180:183], a[168:171], v[92:95], v[180:183]
buffer_load_dword v44, v44, s[48:51], 0 offen
v_mfma_f32_16x16x32_bf16 v[188:191], a[172:175], v[92:95], v[188:191]
ds_read_b64_tr_b16 v[110:111], v63 offset:26112
s_waitcnt lgkmcnt(0)
v_mfma_f32_16x16x32_bf16 v[128:131], v[96:99], a[176:179], v[128:131]
s_waitcnt vmcnt(10)
s_barrier
ds_read_b128 a[192:195], v16 offset:32768
v_mfma_f32_16x16x32_bf16 v[132:135], v[96:99], a[180:183], v[132:135]
ds_read_b128 a[196:199], v16 offset:34816
s_add_u32 s83, s79, 0
s_and_b32 s83, s83, 0x380
s_add_u32 m0, s89, 131072
s_mul_i32 s86, s83, 1376
v_mfma_f32_16x16x32_bf16 v[136:139], v[100:103], a[176:179], v[136:139]
buffer_load_dwordx4 v10, s[36:39], s86 offen lds
v_mfma_f32_16x16x32_bf16 v[140:143], v[100:103], a[180:183], v[140:143]
ds_read_b64_tr_b16 v[80:81], v60 offset:32768
v_mfma_f32_16x16x32_bf16 v[160:163], a[176:179], v[104:107], v[160:163]
ds_read_b64_tr_b16 v[82:83], v60 offset:33792
v_mfma_f32_16x16x32_bf16 v[168:171], a[180:183], v[104:107], v[168:171]
ds_read_b64_tr_b16 v[84:85], v61 offset:32768
v_mfma_f32_16x16x32_bf16 v[164:167], a[176:179], v[108:111], v[164:167]
buffer_load_dwordx4 v11, s[36:39], s86 offen offset:1024 lds
v_mfma_f32_16x16x32_bf16 v[172:175], a[180:183], v[108:111], v[172:175]
ds_read_b64_tr_b16 v[86:87], v61 offset:33792
v_lshrrev_b32_e64 v68, 5, v1
v_bfe_u32 v69, v1, 2, 2
v_lshl_add_u32 v68, v68, 2, v69
v_lshlrev_b32 v68, 5, v68
v_and_b32 v69, 3, v1
v_mfma_f32_16x16x32_bf16 v[144:147], v[96:99], a[184:187], v[144:147]
ds_read_b128 a[200:203], v18 offset:32768
s_add_u32 m0, s89, 133120
v_mfma_f32_16x16x32_bf16 v[148:151], v[96:99], a[188:191], v[148:151]
ds_read_b128 a[204:207], v18 offset:34816
v_mfma_f32_16x16x32_bf16 v[152:155], v[100:103], a[184:187], v[152:155]
buffer_load_dwordx4 v10, s[40:43], s86 offen lds
v_mfma_f32_16x16x32_bf16 v[156:159], v[100:103], a[188:191], v[156:159]
ds_read_b64_tr_b16 v[88:89], v62 offset:33280
v_mfma_f32_16x16x32_bf16 v[176:179], a[184:187], v[104:107], v[176:179]
ds_read_b64_tr_b16 v[90:91], v62 offset:34304
v_mfma_f32_16x16x32_bf16 v[184:187], a[188:191], v[104:107], v[184:187]
ds_read_b64_tr_b16 v[92:93], v63 offset:33280
v_mfma_f32_16x16x32_bf16 v[180:183], a[184:187], v[108:111], v[180:183]
buffer_load_dwordx4 v11, s[40:43], s86 offen offset:1024 lds
v_mfma_f32_16x16x32_bf16 v[188:191], a[188:191], v[108:111], v[188:191]
ds_read_b64_tr_b16 v[94:95], v63 offset:34304
v_lshl_add_u32 v68, v69, 3, v68
v_bfe_u32 v69, v1, 4, 1
v_lshl_add_u32 v68, v69, 9, v68
s_lshr_b32 s91, s87, 2
s_add_u32 s91, s91, 147456
s_waitcnt lgkmcnt(6)
v_mfma_f32_16x16x32_bf16 v[128:131], v[80:83], a[192:195], v[128:131]
ds_read_b128 a[208:211], v17 offset:32768
s_add_u32 s83, s79, 128
v_mfma_f32_16x16x32_bf16 v[132:135], v[80:83], a[196:199], v[132:135]
ds_read_b128 a[212:215], v17 offset:34816
s_and_b32 s83, s83, 0x380
v_mfma_f32_16x16x32_bf16 v[136:139], v[84:87], a[192:195], v[136:139]
ds_read_b64_tr_b16 v[96:97], v60 offset:40960
s_add_u32 m0, s89, 0
v_mfma_f32_16x16x32_bf16 v[140:143], v[84:87], a[196:199], v[140:143]
ds_read_b64_tr_b16 v[98:99], v60 offset:41984
s_waitcnt lgkmcnt(4)
v_mfma_f32_16x16x32_bf16 v[160:163], a[192:195], v[88:91], v[160:163]
ds_read_b64_tr_b16 v[100:101], v61 offset:40960
s_mul_i32 s86, s83, 1376
v_mfma_f32_16x16x32_bf16 v[168:171], a[196:199], v[88:91], v[168:171]
ds_read_b64_tr_b16 v[102:103], v61 offset:41984
v_mfma_f32_16x16x32_bf16 v[164:167], a[192:195], v[92:95], v[164:167]
buffer_load_dwordx4 v10, s[36:39], s86 offen lds
v_mfma_f32_16x16x32_bf16 v[172:175], a[196:199], v[92:95], v[172:175]
v_add_u32_e64 v68, s91, v68
ds_read_b64_tr_b16 v[64:65], v68
ds_read_b64_tr_b16 v[66:67], v68 offset:256
s_lshl_b32 s93, s73, 2
v_mfma_f32_16x16x32_bf16 v[144:147], v[80:83], a[200:203], v[144:147]
ds_read_b128 a[216:219], v19 offset:32768
s_add_u32 s93, s93, s74
v_mfma_f32_16x16x32_bf16 v[148:151], v[80:83], a[204:207], v[148:151]
ds_read_b128 a[220:223], v19 offset:34816
s_lshl_b32 s84, s93, 4
v_mfma_f32_16x16x32_bf16 v[152:155], v[84:87], a[200:203], v[152:155]
ds_read_b64_tr_b16 v[104:105], v62 offset:41472
s_add_u32 s84, s84, s72
v_mfma_f32_16x16x32_bf16 v[156:159], v[84:87], a[204:207], v[156:159]
ds_read_b64_tr_b16 v[106:107], v62 offset:42496
s_lshr_b32 s80, s93, 1
v_mfma_f32_16x16x32_bf16 v[176:179], a[200:203], v[88:91], v[176:179]
ds_read_b64_tr_b16 v[108:109], v63 offset:41472
s_lshl_b32 s80, s80, 4
v_mfma_f32_16x16x32_bf16 v[184:187], a[204:207], v[88:91], v[184:187]
ds_read_b64_tr_b16 v[110:111], v63 offset:42496
v_mfma_f32_16x16x32_bf16 v[180:183], a[200:203], v[92:95], v[180:183]
v_mfma_f32_16x16x32_bf16 v[188:191], a[204:207], v[92:95], v[188:191]
s_waitcnt lgkmcnt(0)
v_mfma_f32_16x16x32_bf16 v[128:131], v[96:99], a[208:211], v[128:131]
s_waitcnt vmcnt(7)
s_barrier
ds_read_b128 a[224:227], v16 offset:49152
v_mfma_f32_16x16x32_bf16 v[132:135], v[96:99], a[212:215], v[132:135]
ds_read_b128 a[228:231], v16 offset:51200
s_add_u32 s80, s80, s72
v_mfma_f32_16x16x32_bf16 v[136:139], v[100:103], a[208:211], v[136:139]
ds_read_b64_tr_b16 v[80:81], v60 offset:49152
s_lshl_b32 s80, s80, 10
v_mfma_f32_16x16x32_bf16 v[140:143], v[100:103], a[212:215], v[140:143]
ds_read_b64_tr_b16 v[82:83], v60 offset:50176
s_add_u32 s80, s80, 8781824
v_mfma_f32_16x16x32_bf16 v[160:163], a[208:211], v[104:107], v[160:163]
ds_read_b64_tr_b16 v[84:85], v61 offset:49152
s_lshl_b32 s84, s84, 10
v_mfma_f32_16x16x32_bf16 v[168:171], a[212:215], v[104:107], v[168:171]
ds_read_b64_tr_b16 v[86:87], v61 offset:50176
s_add_u32 s84, s84, 7864320
v_mfma_f32_16x16x32_bf16 v[164:167], a[208:211], v[108:111], v[164:167]
v_mfma_f32_16x16x32_bf16 v[172:175], a[212:215], v[108:111], v[172:175]
v_mfma_f32_16x16x32_bf16 v[144:147], v[96:99], a[216:219], v[144:147]
ds_read_b128 a[232:235], v18 offset:49152
s_sub_u32 s100, 0, s75
v_mfma_f32_16x16x32_bf16 v[148:151], v[96:99], a[220:223], v[148:151]
ds_read_b128 a[236:239], v18 offset:51200
s_mov_b32 s101, s100
v_mfma_f32_16x16x32_bf16 v[152:155], v[100:103], a[216:219], v[152:155]
ds_read_b64_tr_b16 v[88:89], v62 offset:49664
s_lshr_b32 s90, s87, 1
v_mfma_f32_16x16x32_bf16 v[156:159], v[100:103], a[220:223], v[156:159]
ds_read_b64_tr_b16 v[90:91], v62 offset:50688
s_add_u32 s90, s90, 151552
v_mfma_f32_16x16x32_bf16 v[176:179], a[216:219], v[104:107], v[176:179]
ds_read_b64_tr_b16 v[92:93], v63 offset:49664
v_add_u32 v2, s90, v38
v_mfma_f32_16x16x32_bf16 v[184:187], a[220:223], v[104:107], v[184:187]
ds_read_b64_tr_b16 v[94:95], v63 offset:50688
v_mfma_f32_16x16x32_bf16 v[180:183], a[216:219], v[108:111], v[180:183]
v_mfma_f32_16x16x32_bf16 v[188:191], a[220:223], v[108:111], v[188:191]
s_waitcnt lgkmcnt(6)
v_mfma_f32_16x16x32_bf16 v[128:131], v[80:83], a[224:227], v[128:131]
ds_read_b128 a[240:243], v17 offset:49152
v_xor_b32 v3, 0x800, v2
v_mfma_f32_16x16x32_bf16 v[132:135], v[80:83], a[228:231], v[132:135]
ds_read_b128 a[244:247], v17 offset:51200
s_lshl_b32 s91, s74, 8
v_mfma_f32_16x16x32_bf16 v[136:139], v[84:87], a[224:227], v[136:139]
ds_read_b64_tr_b16 v[96:97], v60 offset:57344
s_add_u32 s91, s91, 147456
v_mfma_f32_16x16x32_bf16 v[140:143], v[84:87], a[228:231], v[140:143]
ds_read_b64_tr_b16 v[98:99], v60 offset:58368
s_waitcnt lgkmcnt(4)
v_mfma_f32_16x16x32_bf16 v[160:163], a[224:227], v[88:91], v[160:163]
ds_read_b64_tr_b16 v[100:101], v61 offset:57344
v_lshl_add_u32 v4, v1, 2, s91
v_mfma_f32_16x16x32_bf16 v[168:171], a[228:231], v[88:91], v[168:171]
ds_read_b64_tr_b16 v[102:103], v61 offset:58368
s_and_b32 s91, s91, 0xfffffeff
v_mfma_f32_16x16x32_bf16 v[164:167], a[224:227], v[92:95], v[164:167]
v_mfma_f32_16x16x32_bf16 v[172:175], a[228:231], v[92:95], v[172:175]
v_mfma_f32_16x16x32_bf16 v[144:147], v[80:83], a[232:235], v[144:147]
ds_read_b128 a[248:251], v19 offset:49152
v_and_b32 v5, 31, v1
v_mfma_f32_16x16x32_bf16 v[148:151], v[80:83], a[236:239], v[148:151]
ds_read_b128 a[252:255], v19 offset:51200
v_lshl_add_u32 v5, v5, 3, s91
v_mfma_f32_16x16x32_bf16 v[152:155], v[84:87], a[232:235], v[152:155]
ds_read_b64_tr_b16 v[104:105], v62 offset:57856
v_lshrrev_b32_e64 v6, 5, v1
v_mfma_f32_16x16x32_bf16 v[156:159], v[84:87], a[236:239], v[156:159]
ds_read_b64_tr_b16 v[106:107], v62 offset:58880
v_or_b32_e64 v6, s75, v6
v_mfma_f32_16x16x32_bf16 v[176:179], a[232:235], v[88:91], v[176:179]
ds_read_b64_tr_b16 v[108:109], v63 offset:57856
v_lshlrev_b32_e64 v6, 30, v6
v_mfma_f32_16x16x32_bf16 v[184:187], a[236:239], v[88:91], v[184:187]
ds_read_b64_tr_b16 v[110:111], v63 offset:58880
v_mfma_f32_16x16x32_bf16 v[180:183], a[232:235], v[92:95], v[180:183]
v_mfma_f32_16x16x32_bf16 v[188:191], a[236:239], v[92:95], v[188:191]
s_waitcnt lgkmcnt(0)
v_mfma_f32_16x16x32_bf16 v[128:131], v[96:99], a[240:243], v[128:131]
s_barrier
v_lshl_add_u32 v6, v1, 2, v6
v_mfma_f32_16x16x32_bf16 v[132:135], v[96:99], a[244:247], v[132:135]
v_lshrrev_b32 v7, 1, v1
v_xor_b32 v7, v7, v1
v_mfma_f32_16x16x32_bf16 v[136:139], v[100:103], a[240:243], v[136:139]
v_and_b32 v7, 2, v7
v_mul_u32_u24 v7, 12, v7
v_mfma_f32_16x16x32_bf16 v[140:143], v[100:103], a[244:247], v[140:143]
v_mfma_f32_16x16x32_bf16 v[160:163], a[240:243], v[104:107], v[160:163]
v_mfma_f32_16x16x32_bf16 v[168:171], a[244:247], v[104:107], v[168:171]
v_mfma_f32_16x16x32_bf16 v[164:167], a[240:243], v[108:111], v[164:167]
v_mfma_f32_16x16x32_bf16 v[172:175], a[244:247], v[108:111], v[172:175]
v_mfma_f32_16x16x32_bf16 v[144:147], v[96:99], a[248:251], v[144:147]
v_xor_b32_e64 v6, v6, v7
v_mfma_f32_16x16x32_bf16 v[148:151], v[96:99], a[252:255], v[148:151]
v_mfma_f32_16x16x32_bf16 v[152:155], v[100:103], a[248:251], v[152:155]
v_mfma_f32_16x16x32_bf16 v[156:159], v[100:103], a[252:255], v[156:159]
v_mfma_f32_16x16x32_bf16 v[176:179], a[248:251], v[104:107], v[176:179]
v_mfma_f32_16x16x32_bf16 v[184:187], a[252:255], v[104:107], v[184:187]
v_mfma_f32_16x16x32_bf16 v[180:183], a[248:251], v[108:111], v[180:183]
v_mfma_f32_16x16x32_bf16 v[188:191], a[252:255], v[108:111], v[188:191]
v_cvt_pk_bf16_f32 v80, v128, v129
v_cvt_pk_bf16_f32 v83, v134, v135
v_cvt_pk_bf16_f32 v86, v140, v141
v_cvt_pk_bf16_f32 v87, v142, v143
v_cvt_pk_bf16_f32 v82, v132, v133
v_cvt_pk_bf16_f32 v84, v136, v137
v_cvt_pk_bf16_f32 v85, v138, v139
v_cvt_pk_bf16_f32 v81, v130, v131
v_permlane16_swap_b32 v84, v86
v_permlane16_swap_b32 v85, v87
v_permlane16_swap_b32 v81, v83
v_permlane16_swap_b32 v80, v82
v_mfma_f32_32x32x16_bf16 v[208:223], v[64:67], v[84:87], 0
v_cvt_pk_bf16_f32 v92, v152, v153
v_cvt_pk_bf16_f32 v91, v150, v151
v_cvt_pk_bf16_f32 v95, v158, v159
v_cvt_pk_bf16_f32 v94, v156, v157
v_cvt_pk_bf16_f32 v89, v146, v147
v_cvt_pk_bf16_f32 v93, v154, v155
v_mfma_f32_32x32x16_bf16 v[192:207], v[64:67], v[80:83], 0
v_cvt_pk_bf16_f32 v88, v144, v145
v_permlane16_swap_b32_e64 v93, v95
v_cvt_pk_bf16_f32 v90, v148, v149
v_permlane16_swap_b32 v89, v91
v_permlane16_swap_b32 v92, v94
v_max3_f32 v71, -v216, -v217, -v218
v_max3_f32 v71, v71, -v219, -v220
v_mfma_f32_32x32x16_bf16 v[240:255], v[64:67], v[92:95], 0
v_max3_f32 v70, v216, v217, v218
v_max3_f32 v71, v71, -v221, -v222
v_max3_f32 v70, v70, v219, v220
v_max3_f32 v70, v70, v221, v222
v_max3_f32 v69, -v192, -v193, -v194
v_max3_f32 v69, v69, -v195, -v196
v_max3_f32 v69, v69, -v197, -v198
v_max_f32 v69, v69, -v199
v_max_f32 v71, v71, -v223
v_max_f32_e64 v70, v70, v223
v_max3_f32 v68, v192, v193, v194
v_max3_f32 v68, v68, v195, v196
v_max3_f32 v68, v68, v197, v198
v_max_f32 v68, v68, v199
v_permlane32_swap_b32 v70, v71
v_max_f32 v70, v70, v71
v_permlane32_swap_b32 v68, v69
v_max_f32_e64 v68, v68, v69
v_mul_f32 v71, -v70, v50
v_mul_f32 v70, -v70, v50
v_permlane16_swap_b32_e64 v88, v90
v_mul_f32 v69, -v68, v50
v_mul_f32 v68, -v68, v50
v_mfma_f32_32x32x16_bf16 v[224:239], v[64:67], v[88:91], 0
v_permlane32_swap_b32 v70, v71
v_permlane32_swap_b32 v68, v69
v_cvt_pk_bf16_f32 v104, v176, v177
v_cvt_pk_bf16_f32 v105, v178, v179
v_cvt_pk_bf16_f32 v103, v174, v175
v_cvt_pk_bf16_f32 v109, v186, v187
v_cvt_pk_bf16_f32 v97, v162, v163
v_pk_fma_f32 v[134:135], v[198:199], v[50:51], v[68:69] op_sel_hi:[1,0,0]
v_pk_fma_f32 v[156:157], v[220:221], v[50:51], v[70:71] op_sel:[0,0,1] op_sel_hi:[1,0,1] neg_lo:[1,0,0] neg_hi:[1,0,0]
v_pk_fma_f32 v[148:149], v[220:221], v[50:51], v[70:71] op_sel_hi:[1,0,0]
v_pk_fma_f32 v[132:133], v[196:197], v[50:51], v[68:69] op_sel_hi:[1,0,0]
v_pk_fma_f32 v[144:145], v[216:217], v[50:51], v[70:71] op_sel_hi:[1,0,0]
v_pk_fma_f32 v[146:147], v[218:219], v[50:51], v[70:71] op_sel_hi:[1,0,0]
v_pk_fma_f32 v[136:137], v[192:193], v[50:51], v[68:69] op_sel:[0,0,1] op_sel_hi:[1,0,1] neg_lo:[1,0,0] neg_hi:[1,0,0]
v_exp_f32 v136, v136
v_exp_f32 v157, v157
v_exp_f32 v156, v156
v_exp_f32 v145, v145
v_exp_f32_e64 v135, v135
v_pk_fma_f32 v[158:159], v[222:223], v[50:51], v[70:71] op_sel:[0,0,1] op_sel_hi:[1,0,1] neg_lo:[1,0,0] neg_hi:[1,0,0]
v_exp_f32 v158, v158
v_exp_f32 v147, v147
v_exp_f32_e64 v159, v159
v_pk_fma_f32 v[130:131], v[194:195], v[50:51], v[68:69] op_sel_hi:[1,0,0]
v_exp_f32 v131, v131
v_exp_f32 v130, v130
v_exp_f32_e64 v149, v149
v_pk_fma_f32 v[152:153], v[216:217], v[50:51], v[70:71] op_sel:[0,0,1] op_sel_hi:[1,0,1] neg_lo:[1,0,0] neg_hi:[1,0,0]
s_load_dword s68, s[24:25], 0
v_exp_f32 v153, v153
v_exp_f32 v152, v152
v_exp_f32 v144, v144
v_exp_f32 v146, v146
v_pk_fma_f32 v[140:141], v[196:197], v[50:51], v[68:69] op_sel:[0,0,1] op_sel_hi:[1,0,1] neg_lo:[1,0,0] neg_hi:[1,0,0]
v_pk_add_f32 v[216:217], v[144:145], v[146:147]
v_exp_f32 v141, v141
v_exp_f32 v132, v132
v_pk_fma_f32 v[154:155], v[218:219], v[50:51], v[70:71] op_sel:[0,0,1] op_sel_hi:[1,0,1] neg_lo:[1,0,0] neg_hi:[1,0,0]
v_exp_f32 v155, v155
v_exp_f32 v154, v154
buffer_load_dwordx4 v11, s[36:39], s86 offen offset:1024 lds
v_pk_fma_f32 v[138:139], v[194:195], v[50:51], v[68:69] op_sel:[0,0,1] op_sel_hi:[1,0,1] neg_lo:[1,0,0] neg_hi:[1,0,0]
v_exp_f32 v139, v139
v_exp_f32 v138, v138
v_pk_add_f32 v[220:221], v[152:153], v[154:155]
v_pk_fma_f32 v[128:129], v[192:193], v[50:51], v[68:69] op_sel_hi:[1,0,0]
v_exp_f32_e64 v128, v128
v_pk_fma_f32 v[150:151], v[222:223], v[50:51], v[70:71] op_sel_hi:[1,0,0]
v_exp_f32_e64 v150, v150
v_pk_add_f32 v[222:223], v[156:157], v[158:159]
v_pk_add_f32 v[220:221], v[220:221], v[222:223]
v_add_f32 v71, v220, v221
v_exp_f32 v151, v151
v_exp_f32 v137, v137
v_exp_f32 v134, v134
s_add_u32 m0, s89, 2048
s_nop 0
buffer_load_dwordx4 v10, s[40:43], s86 offen lds
v_pk_fma_f32 v[142:143], v[198:199], v[50:51], v[68:69] op_sel:[0,0,1] op_sel_hi:[1,0,1] neg_lo:[1,0,0] neg_hi:[1,0,0]
v_exp_f32 v142, v142
v_exp_f32 v143, v143
v_exp_f32 v140, v140
v_exp_f32_e64 v148, v148
v_pk_add_f32 v[198:199], v[140:141], v[142:143]
v_pk_add_f32 v[218:219], v[148:149], v[150:151]
v_exp_f32 v129, v129
v_exp_f32 v133, v133
v_pk_add_f32 v[196:197], v[136:137], v[138:139]
v_pk_add_f32 v[194:195], v[132:133], v[134:135]
v_pk_add_f32 v[196:197], v[196:197], v[198:199]
v_add_f32_e64 v69, v196, v197
v_pk_add_f32 v[192:193], v[128:129], v[130:131]
buffer_load_dwordx4 v11, s[40:43], s86 offen offset:1024 lds
v_pk_add_f32 v[192:193], v[192:193], v[194:195]
v_pk_add_f32 v[216:217], v[216:217], v[218:219]
v_add_f32 v70, v216, v217
v_add_f32 v68, v192, v193
v_cvt_pk_bf16_f32 v106, v180, v181
v_permlane32_swap_b32 v70, v71
v_permlane32_swap_b32 v68, v69
v_add_f32 v70, v70, v71
v_rcp_f32 v70, v70
v_add_f32 v68, v68, v69
v_rcp_f32 v68, v68
v_mov_b32 v71, v70
v_mov_b32 v69, v68
v_cvt_pk_bf16_f32 v99, v166, v167
v_permlane32_swap_b32_e64 v70, v71
s_add_u32 s83, s79, 256
s_and_b32 s83, s83, 0x380
s_add_u32 m0, s89, 65536
s_mul_i32 s86, s83, 1376
buffer_load_dwordx4 v10, s[36:39], s86 offen lds
v_permlane32_swap_b32_e64 v68, v69
v_pk_mul_f32 v[132:133], v[132:133], v[68:69] op_sel_hi:[1,0]
v_pk_mul_f32 v[146:147], v[146:147], v[70:71] op_sel_hi:[1,0]
v_pk_mul_f32 v[140:141], v[140:141], v[68:69] op_sel:[0,1] op_sel_hi:[1,1]
v_pk_mul_f32 v[154:155], v[154:155], v[70:71] op_sel:[0,1] op_sel_hi:[1,1]
v_pk_mul_f32 v[144:145], v[144:145], v[70:71] op_sel_hi:[1,0]
v_pk_mul_f32 v[158:159], v[158:159], v[70:71] op_sel:[0,1] op_sel_hi:[1,1]
v_pk_mul_f32 v[134:135], v[134:135], v[68:69] op_sel_hi:[1,0]
v_pk_mul_f32 v[150:151], v[150:151], v[70:71] op_sel_hi:[1,0]
v_pk_mul_f32 v[130:131], v[130:131], v[68:69] op_sel_hi:[1,0]
v_cvt_pk_bf16_f32 v113, v130, v131
v_pk_mul_f32 v[148:149], v[148:149], v[70:71] op_sel_hi:[1,0]
v_cvt_pk_bf16_f32 v122, v148, v149
v_pk_mul_f32 v[138:139], v[138:139], v[68:69] op_sel:[0,1] op_sel_hi:[1,1]
v_pk_mul_f32 v[136:137], v[136:137], v[68:69] op_sel:[0,1] op_sel_hi:[1,1]
v_pk_mul_f32 v[152:153], v[152:153], v[70:71] op_sel:[0,1] op_sel_hi:[1,1]
v_cvt_pk_bf16_f32 v115, v134, v135
v_cvt_pk_bf16_f32 v121, v146, v147
v_pk_mul_f32 v[128:129], v[128:129], v[68:69] op_sel_hi:[1,0]
buffer_load_dwordx4 v11, s[36:39], s86 offen offset:1024 lds
v_cvt_pk_bf16_f32 v120, v144, v145
v_cvt_pk_bf16_f32 v114, v132, v133
v_cvt_pk_bf16_f32 v111, v190, v191
v_pk_mul_f32 v[142:143], v[142:143], v[68:69] op_sel:[0,1] op_sel_hi:[1,1]
v_max3_f32 v68, v224, v225, v226
v_max3_f32 v69, -v224, -v225, -v226
v_pk_mul_f32 v[156:157], v[156:157], v[70:71] op_sel:[0,1] op_sel_hi:[1,1]
v_max3_f32 v71, -v248, -v249, -v250
v_cvt_pk_bf16_f32 v124, v152, v153
v_cvt_pk_bf16_f32 v116, v136, v137
v_cvt_pk_bf16_f32 v112, v128, v129
v_cvt_pk_bf16_f32 v98, v164, v165
v_cvt_pk_bf16_f32 v100, v168, v169
v_cvt_pk_bf16_f32 v123, v150, v151
v_cvt_pk_bf16_f32 v126, v156, v157
v_cvt_pk_bf16_f32 v118, v140, v141
v_cvt_pk_bf16_f32 v127, v158, v159
v_cvt_pk_bf16_f32 v102, v172, v173
v_max3_f32 v71, v71, -v251, -v252
v_cvt_pk_bf16_f32 v125, v154, v155
s_add_u32 m0, s89, 67584
s_nop 0
buffer_load_dwordx4 v10, s[40:43], s86 offen lds
v_cvt_pk_bf16_f32 v101, v170, v171
v_cvt_pk_bf16_f32 v110, v188, v189
v_cvt_pk_bf16_f32 v107, v182, v183
v_cvt_pk_bf16_f32 v96, v160, v161
v_mfma_f32_32x32x16_bf16 v[160:175], v[112:115], v[52:55], 0
v_cvt_pk_bf16_f32 v117, v138, v139
v_cvt_pk_bf16_f32 v108, v184, v185
v_max3_f32 v69, v69, -v227, -v228
v_max3_f32 v69, v69, -v229, -v230
v_cvt_pk_bf16_f32 v119, v142, v143
v_max3_f32 v70, v248, v249, v250
v_mfma_f32_32x32x16_bf16 v[176:191], v[120:123], v[52:55], 0
v_max3_f32 v70, v70, v251, v252
v_max3_f32 v71, v71, -v253, -v254
v_max_f32 v71, v71, -v255
v_max_f32 v69, v69, -v231
v_max3_f32 v68, v68, v227, v228
v_max3_f32 v68, v68, v229, v230
buffer_load_dwordx4 v11, s[40:43], s86 offen offset:1024 lds
v_mfma_f32_32x32x16_bf16 v[160:175], v[116:119], v[56:59], v[160:175]
v_max3_f32 v70, v70, v253, v254
v_max_f32 v70, v70, v255
v_max_f32 v68, v68, v231
v_permlane16_swap_b32 v96, v98
v_permlane32_swap_b32_e64 v70, v71
v_mfma_f32_32x32x16_bf16 v[176:191], v[124:127], v[56:59], v[176:191]
v_permlane32_swap_b32 v68, v69
v_max_f32 v70, v70, v71
v_mul_f32 v71, -v70, v50
v_mul_f32 v70, -v70, v50
v_max_f32_e64 v68, v68, v69
v_mul_f32 v69, -v68, v50
v_mul_f32 v68, -v68, v50
v_permlane32_swap_b32_e64 v70, v71
s_add_u32 s83, s79, 384
s_and_b32 s83, s83, 0x380
s_add_u32 m0, s89, 16384
s_mul_i32 s86, s83, 1376
buffer_load_dwordx4 v10, s[36:39], s86 offen lds
v_pk_fma_f32 v[150:151], v[254:255], v[50:51], v[70:71] op_sel_hi:[1,0,0]
v_pk_fma_f32 v[154:155], v[250:251], v[50:51], v[70:71] op_sel:[0,0,1] op_sel_hi:[1,0,1] neg_lo:[1,0,0] neg_hi:[1,0,0]
L_pad_KL_2:
s_cbranch_execz L_pad_KL_3
s_nop 0
v_permlane32_swap_b32_e64 v68, v69
v_pk_fma_f32 v[136:137], v[224:225], v[50:51], v[68:69] op_sel:[0,0,1] op_sel_hi:[1,0,1] neg_lo:[1,0,0] neg_hi:[1,0,0]
v_exp_f32_e64 v136, v136
v_pk_fma_f32 v[142:143], v[230:231], v[50:51], v[68:69] op_sel:[0,0,1] op_sel_hi:[1,0,1] neg_lo:[1,0,0] neg_hi:[1,0,0]
v_exp_f32 v143, v143
v_exp_f32 v142, v142
v_pk_fma_f32 v[148:149], v[252:253], v[50:51], v[70:71] op_sel_hi:[1,0,0]
v_exp_f32 v148, v148
v_exp_f32 v149, v149
v_exp_f32_e64 v155, v155
v_pk_fma_f32 v[132:133], v[228:229], v[50:51], v[68:69] op_sel_hi:[1,0,0]
buffer_load_dwordx4 v11, s[36:39], s86 offen offset:1024 lds
v_exp_f32_e64 v132, v132
v_pk_fma_f32 v[140:141], v[228:229], v[50:51], v[68:69] op_sel:[0,0,1] op_sel_hi:[1,0,1] neg_lo:[1,0,0] neg_hi:[1,0,0]
v_exp_f32 v140, v140
v_exp_f32 v141, v141
v_pk_fma_f32 v[128:129], v[224:225], v[50:51], v[68:69] op_sel_hi:[1,0,0]
v_exp_f32 v129, v129
s_waitcnt lgkmcnt(0)
s_bfe_u32 s97, s68, 524288
s_cmp_lt_u32 s97, 16
s_cbranch_scc1 L_slow_KL0
L_back_KL0:
v_exp_f32_e64 v128, v128
v_pk_fma_f32 v[134:135], v[230:231], v[50:51], v[68:69] op_sel_hi:[1,0,0]
v_exp_f32 v134, v134
v_exp_f32 v135, v135
s_add_u32 m0, s89, 18432
s_nop 0
buffer_load_dwordx4 v10, s[40:43], s86 offen lds
v_pk_fma_f32 v[146:147], v[250:251], v[50:51], v[70:71] op_sel_hi:[1,0,0]
v_exp_f32 v137, v137
v_pk_fma_f32 v[152:153], v[248:249], v[50:51], v[70:71] op_sel:[0,0,1] op_sel_hi:[1,0,1] neg_lo:[1,0,0] neg_hi:[1,0,0]
v_exp_f32_e64 v153, v153
v_pk_fma_f32 v[156:157], v[252:253], v[50:51], v[70:71] op_sel:[0,0,1] op_sel_hi:[1,0,1] neg_lo:[1,0,0] neg_hi:[1,0,0]
v_exp_f32 v157, v157
v_exp_f32 v152, v152
v_exp_f32 v150, v150
v_exp_f32 v151, v151
v_exp_f32_e64 v147, v147
v_pk_fma_f32 v[144:145], v[248:249], v[50:51], v[70:71] op_sel_hi:[1,0,0]
v_exp_f32_e64 v145, v145
buffer_load_dwordx4 v11, s[40:43], s86 offen offset:1024 lds
v_pk_fma_f32 v[130:131], v[226:227], v[50:51], v[68:69] op_sel_hi:[1,0,0]
v_exp_f32_e64 v131, v131
v_pk_fma_f32 v[138:139], v[226:227], v[50:51], v[68:69] op_sel:[0,0,1] op_sel_hi:[1,0,1] neg_lo:[1,0,0] neg_hi:[1,0,0]
v_exp_f32 v138, v138
v_exp_f32 v139, v139
v_exp_f32_e64 v154, v154
v_pk_add_f32 v[228:229], v[136:137], v[138:139]
v_pk_add_f32 v[252:253], v[152:153], v[154:155]
v_pk_fma_f32 v[158:159], v[254:255], v[50:51], v[70:71] op_sel:[0,0,1] op_sel_hi:[1,0,1] neg_lo:[1,0,0] neg_hi:[1,0,0]
v_exp_f32 v158, v158
v_exp_f32 v159, v159
v_pk_add_f32 v[250:251], v[148:149], v[150:151]
v_exp_f32_e64 v144, v144
s_add_u32 s83, s79, 512
s_and_b32 s83, s83, 0x380
s_add_u32 m0, s89, 81920
s_mul_i32 s86, s83, 1376
buffer_load_dwordx4 v10, s[36:39], s86 offen lds
v_exp_f32 v130, v130
v_exp_f32 v133, v133
v_pk_add_f32 v[224:225], v[128:129], v[130:131]
v_exp_f32 v146, v146
v_exp_f32 v156, v156
v_pk_add_f32 v[248:249], v[144:145], v[146:147]
v_pk_add_f32 v[254:255], v[156:157], v[158:159]
v_pk_add_f32 v[248:249], v[248:249], v[250:251]
v_add_f32_e64 v70, v248, v249
v_pk_add_f32 v[230:231], v[140:141], v[142:143]
v_pk_add_f32 v[228:229], v[228:229], v[230:231]
v_add_f32_e64 v69, v228, v229
v_pk_add_f32 v[226:227], v[132:133], v[134:135]
v_pk_add_f32 v[224:225], v[224:225], v[226:227]
v_add_f32_e64 v68, v224, v225
v_pk_add_f32 v[252:253], v[252:253], v[254:255]
buffer_load_dwordx4 v11, s[36:39], s86 offen offset:1024 lds
v_add_f32 v71, v252, v253
v_permlane32_swap_b32 v68, v69
v_cvt_pk_bf16_f32 v83, v166, v167
v_permlane32_swap_b32 v70, v71
v_add_f32 v70, v70, v71
v_rcp_f32 v70, v70
v_add_f32 v68, v68, v69
v_mov_b32 v71, v70
v_rcp_f32 v68, v68
v_cvt_pk_bf16_f32 v90, v180, v181
v_permlane32_swap_b32_e64 v70, v71
v_pk_mul_f32 v[148:149], v[148:149], v[70:71] op_sel_hi:[1,0]
v_cvt_pk_bf16_f32 v122, v148, v149
v_cvt_pk_bf16_f32 v88, v176, v177
v_cvt_pk_bf16_f32 v95, v190, v191
s_add_u32 m0, s89, 83968
s_nop 0
buffer_load_dwordx4 v10, s[40:43], s86 offen lds
v_cvt_pk_bf16_f32 v81, v162, v163
v_pk_add_f32 v[74:75], v[176:177], v[178:179]
v_mov_b32 v69, v68
v_cvt_pk_bf16_f32 v89, v178, v179
v_pk_add_f32 v[72:73], v[160:161], v[162:163]
v_pk_add_f32 v[72:73], v[72:73], v[164:165]
v_cvt_pk_bf16_f32 v91, v182, v183
v_cvt_pk_bf16_f32 v82, v164, v165
v_cvt_pk_bf16_f32 v93, v186, v187
v_cvt_pk_bf16_f32 v92, v184, v185
v_pk_add_f32 v[74:75], v[74:75], v[180:181]
v_pk_add_f32 v[74:75], v[74:75], v[182:183]
v_pk_add_f32 v[74:75], v[74:75], v[184:185]
v_pk_add_f32 v[74:75], v[74:75], v[186:187]
v_pk_add_f32 v[74:75], v[74:75], v[188:189]
v_pk_add_f32 v[74:75], v[74:75], v[190:191]
v_cvt_pk_bf16_f32 v87, v174, v175
v_pk_add_f32 v[72:73], v[72:73], v[166:167]
v_pk_add_f32 v[72:73], v[72:73], v[168:169]
v_pk_add_f32 v[72:73], v[72:73], v[170:171]
buffer_load_dwordx4 v11, s[40:43], s86 offen offset:1024 lds
v_pk_add_f32 v[72:73], v[72:73], v[172:173]
v_permlane32_swap_b32_e64 v68, v69
v_pk_mul_f32 v[132:133], v[132:133], v[68:69] op_sel_hi:[1,0]
v_pk_mul_f32 v[130:131], v[130:131], v[68:69] op_sel_hi:[1,0]
v_pk_mul_f32 v[128:129], v[128:129], v[68:69] op_sel_hi:[1,0]
v_cvt_pk_bf16_f32 v112, v128, v129
v_cvt_pk_bf16_f32 v114, v132, v133
v_cvt_pk_bf16_f32 v113, v130, v131
v_cvt_pk_bf16_f32 v86, v172, v173
v_pk_mul_f32 v[146:147], v[146:147], v[70:71] op_sel_hi:[1,0]
v_cvt_pk_bf16_f32 v121, v146, v147
v_pk_mul_f32 v[144:145], v[144:145], v[70:71] op_sel_hi:[1,0]
v_pk_mul_f32 v[138:139], v[138:139], v[68:69] op_sel:[0,1] op_sel_hi:[1,1]
v_cvt_pk_bf16_f32 v80, v160, v161
v_pk_add_f32 v[72:73], v[72:73], v[174:175]
v_cvt_pk_bf16_f32 v94, v188, v189
v_cvt_pk_bf16_f32 v120, v144, v145
v_pk_mul_f32 v[140:141], v[140:141], v[68:69] op_sel:[0,1] op_sel_hi:[1,1]
v_cvt_pk_bf16_f32 v118, v140, v141
s_add_u32 s83, s79, 640
s_and_b32 s83, s83, 0x380
s_add_u32 m0, s89, 32768
s_mul_i32 s86, s83, 1376
buffer_load_dwordx4 v10, s[36:39], s86 offen lds
v_pk_mul_f32 v[150:151], v[150:151], v[70:71] op_sel_hi:[1,0]
v_cvt_pk_bf16_f32 v123, v150, v151
v_pk_mul_f32 v[142:143], v[142:143], v[68:69] op_sel:[0,1] op_sel_hi:[1,1]
v_pk_mul_f32 v[134:135], v[134:135], v[68:69] op_sel_hi:[1,0]
v_pk_mul_f32 v[158:159], v[158:159], v[70:71] op_sel:[0,1] op_sel_hi:[1,1]
v_pk_mul_f32 v[156:157], v[156:157], v[70:71] op_sel:[0,1] op_sel_hi:[1,1]
v_pk_mul_f32 v[154:155], v[154:155], v[70:71] op_sel:[0,1] op_sel_hi:[1,1]
v_pk_mul_f32 v[136:137], v[136:137], v[68:69] op_sel:[0,1] op_sel_hi:[1,1]
v_pk_mul_f32 v[152:153], v[152:153], v[70:71] op_sel:[0,1] op_sel_hi:[1,1]
v_cvt_pk_bf16_f32 v115, v134, v135
v_mfma_f32_32x32x16_bf16 v[176:191], v[120:123], v[52:55], 0
v_cvt_pk_bf16_f32 v119, v142, v143
v_cvt_pk_bf16_f32 v84, v168, v169
v_cvt_pk_bf16_f32 v85, v170, v171
v_cvt_pk_bf16_f32 v116, v136, v137
v_cvt_pk_bf16_f32 v117, v138, v139
v_cvt_pk_bf16_f32 v124, v152, v153
v_mfma_f32_32x32x16_bf16 v[160:175], v[112:115], v[52:55], 0
buffer_load_dwordx4 v11, s[36:39], s86 offen offset:1024 lds
v_cvt_pk_bf16_f32 v126, v156, v157
v_permlane32_swap_b32 v96, v98
v_permlane16_swap_b32 v97, v99
v_cvt_pk_bf16_f32 v125, v154, v155
v_mfma_f32_32x32x16_bf16 v[160:175], v[116:119], v[56:59], v[160:175]
v_permlane16_swap_b32_e64 v100, v102
v_cvt_pk_bf16_f32 v127, v158, v159
v_permlane16_swap_b32 v101, v103
v_permlane32_swap_b32 v100, v102
v_mfma_f32_32x32x16_bf16 v[176:191], v[124:127], v[56:59], v[176:191]
v_permlane32_swap_b32 v97, v99
v_permlane16_swap_b32 v105, v107
s_add_u32 m0, s89, 34816
s_nop 0
buffer_load_dwordx4 v10, s[40:43], s86 offen lds
v_permlane32_swap_b32 v101, v103
v_mfma_f32_32x32x16_bf16 v[192:207], v[80:83], v[96:99], 0
v_permlane16_swap_b32 v104, v106
v_permlane16_swap_b32 v109, v111
v_permlane16_swap_b32_e64 v108, v110
v_mfma_f32_32x32x16_bf16 v[208:223], v[88:91], v[96:99], 0
v_cvt_pk_bf16_f32 v82, v164, v165
v_cvt_pk_bf16_f32 v81, v162, v163
v_permlane32_swap_b32_e64 v109, v111
v_cvt_pk_bf16_f32 v80, v160, v161
v_cvt_pk_bf16_f32 v91, v182, v183
v_mfma_f32_32x32x16_bf16 v[192:207], v[84:87], v[100:103], v[192:207]
buffer_load_dwordx4 v11, s[40:43], s86 offen offset:1024 lds
v_cvt_pk_bf16_f32 v89, v178, v179
v_cvt_pk_bf16_f32 v88, v176, v177
v_cvt_pk_bf16_f32 v90, v180, v181
v_permlane32_swap_b32_e64 v108, v110
v_cvt_pk_bf16_f32 v83, v166, v167
v_mfma_f32_32x32x16_bf16 v[208:223], v[92:95], v[100:103], v[208:223]
v_cvt_pk_bf16_f32 v92, v184, v185
v_cvt_pk_bf16_f32 v85, v170, v171
v_cvt_pk_bf16_f32 v87, v174, v175
v_permlane32_swap_b32_e64 v105, v107
v_cvt_pk_bf16_f32 v93, v186, v187
v_permlane32_swap_b32_e64 v104, v106
v_cvt_pk_bf16_f32 v84, v168, v169
v_pk_add_f32 v[74:75], v[74:75], v[176:177]
v_pk_add_f32 v[74:75], v[74:75], v[178:179]
v_pk_add_f32 v[74:75], v[74:75], v[180:181]
s_add_u32 s83, s79, 768
s_and_b32 s83, s83, 0x380
s_add_u32 m0, s89, 98304
s_mul_i32 s86, s83, 1376
buffer_load_dwordx4 v10, s[36:39], s86 offen lds
v_pk_add_f32 v[74:75], v[74:75], v[182:183]
v_pk_add_f32 v[72:73], v[72:73], v[160:161]
v_pk_add_f32 v[72:73], v[72:73], v[162:163]
v_pk_add_f32 v[72:73], v[72:73], v[164:165]
v_pk_add_f32 v[72:73], v[72:73], v[166:167]
v_pk_add_f32 v[72:73], v[72:73], v[168:169]
v_pk_add_f32 v[72:73], v[72:73], v[170:171]
v_pk_add_f32 v[72:73], v[72:73], v[172:173]
v_pk_add_f32 v[74:75], v[74:75], v[184:185]
v_pk_add_f32 v[74:75], v[74:75], v[186:187]
v_pk_add_f32 v[74:75], v[74:75], v[188:189]
v_pk_add_f32 v[74:75], v[74:75], v[190:191]
v_pk_add_f32 v[72:73], v[72:73], v[174:175]
v_cvt_pk_bf16_f32 v94, v188, v189
v_mfma_f32_32x32x16_bf16 v[192:207], v[80:83], v[104:107], v[192:207]
v_cvt_pk_bf16_f32 v86, v172, v173
v_cvt_pk_bf16_f32 v95, v190, v191
v_add_f32 v72, v72, v73
v_add_f32 v74, v74, v75
buffer_load_dwordx4 v11, s[36:39], s86 offen offset:1024 lds
v_mfma_f32_32x32x16_bf16 v[192:207], v[84:87], v[108:111], v[192:207]
v_permlane32_swap_b32 v72, v74
v_add_f32 v72, v72, v74
ds_write_b32 v4, v72
v_mfma_f32_32x32x16_bf16 v[208:223], v[88:91], v[104:107], v[208:223]
v_mfma_f32_32x32x16_bf16 v[208:223], v[92:95], v[108:111], v[208:223]
s_nop 11
v_cndmask_b32 v195, v195, v211, s[98:99]
v_cndmask_b32 v205, v205, v221, s[98:99]
v_cndmask_b32 v194, v194, v210, s[98:99]
v_cndmask_b32 v202, v202, v218, s[98:99]
v_cndmask_b32 v193, v193, v209, s[98:99]
v_cndmask_b32 v200, v200, v216, s[98:99]
v_cndmask_b32 v203, v203, v219, s[98:99]
v_cndmask_b32 v131, v203, v195, s[100:101]
v_cndmask_b32 v192, v192, v208, s[98:99]
s_add_u32 m0, s89, 100352
s_nop 0
buffer_load_dwordx4 v10, s[40:43], s86 offen lds
v_cndmask_b32 v128, v200, v192, s[100:101]
v_cndmask_b32 v198, v198, v214, s[98:99]
v_cndmask_b32 v197, v197, v213, s[98:99]
v_cndmask_b32 v237, v197, v205, s[100:101]
v_cndmask_b32 v204, v204, v220, s[98:99]
v_cndmask_b32 v133, v205, v197, s[100:101]
v_cndmask_b32 v206, v206, v222, s[98:99]
v_cndmask_b32 v134, v206, v198, s[100:101]
v_cndmask_b32 v238, v198, v206, s[100:101]
v_cndmask_b32 v232, v192, v200, s[100:101]
v_cndmask_b32 v235, v195, v203, s[100:101]
v_cndmask_b32 v201, v201, v217, s[98:99]
v_cndmask_b32 v233, v193, v201, s[100:101]
v_cndmask_b32 v129, v201, v193, s[100:101]
v_cndmask_b32 v207, v207, v223, s[98:99]
v_cndmask_b32 v130, v202, v194, s[100:101]
ds_write_b128 v2, v[128:131]
v_cndmask_b32 v196, v196, v212, s[98:99]
v_cndmask_b32 v236, v196, v204, s[100:101]
buffer_load_dwordx4 v11, s[40:43], s86 offen offset:1024 lds
v_cndmask_b32 v132, v204, v196, s[100:101]
v_cndmask_b32 v199, v199, v215, s[98:99]
v_cndmask_b32 v239, v199, v207, s[100:101]
v_cndmask_b32 v135, v207, v199, s[100:101]
ds_write_b128 v2, v[132:135] offset:1024
v_cndmask_b32 v234, v194, v202, s[100:101]
s_waitcnt vmcnt(24) lgkmcnt(0)
s_barrier
s_add_u32 s90, s79, 0
s_and_b32 s90, s90, 0x380
v_add_u32 v31, s90, v30
ds_read_b64_tr_b16 v[80:81], v26 offset:0
ds_read_b64_tr_b16 v[82:83], v26 offset:512
ds_read_b64_tr_b16 v[84:85], v26 offset:2048
ds_read_b64_tr_b16 v[86:87], v26 offset:2560
ds_read_b128 v[96:99], v31 offset:0
ds_read_b64_tr_b16 v[88:89], v27 offset:0
ds_read_b64_tr_b16 v[90:91], v27 offset:512
ds_read_b64_tr_b16 v[92:93], v27 offset:2048
ds_read_b64_tr_b16 v[94:95], v27 offset:2560
ds_read_b128 v[240:243], v3
ds_read_b128 v[244:247], v3 offset:1024
ds_read_b64 v[72:73], v5
ds_read_b64 v[74:75], v5 offset:256
s_waitcnt lgkmcnt(11)
v_mfma_f32_16x16x32_bf16 v[128:131], v[80:83], a[0:3], 0
ds_read_b64_tr_b16 v[104:105], v26 offset:8192
s_waitcnt lgkmcnt(4)
v_add_f32_e64 v232, v232, v240
v_mfma_f32_16x16x32_bf16 v[132:135], v[80:83], a[4:7], 0
ds_read_b64_tr_b16 v[106:107], v26 offset:8704
v_add_f32_e64 v233, v233, v241
v_mfma_f32_16x16x32_bf16 v[136:139], v[84:87], a[0:3], 0
ds_read_b64_tr_b16 v[108:109], v26 offset:10240
v_add_f32_e64 v234, v234, v242
v_mfma_f32_16x16x32_bf16 v[140:143], v[84:87], a[4:7], 0
ds_read_b64_tr_b16 v[110:111], v26 offset:10752
s_waitcnt lgkmcnt(4)
v_mfma_f32_16x16x32_bf16 v[160:163], v[88:91], a[0:3], 0
ds_read_b128 v[120:123], v31 offset:64
v_add_f32 v235, v235, v243
v_mfma_f32_16x16x32_bf16 v[164:167], v[88:91], a[4:7], 0
v_add_f32 v236, v236, v244
v_add_f32 v237, v237, v245
v_mfma_f32_16x16x32_bf16 v[168:171], v[92:95], a[0:3], 0
v_add_f32 v238, v238, v246
v_add_f32 v239, v239, v247
v_mfma_f32_16x16x32_bf16 v[172:175], v[92:95], a[4:7], 0
v_add_f32_e64 v72, v72, v74
v_mfma_f32_16x16x32_bf16 v[192:195], v[96:99], a[0:3], 0
v_mfma_f32_16x16x32_bf16 v[144:147], v[80:83], a[8:11], 0
ds_read_b64_tr_b16 v[112:113], v27 offset:8192
v_add_f32_e64 v73, v73, v75
v_mfma_f32_16x16x32_bf16 v[148:151], v[80:83], a[12:15], 0
ds_read_b64_tr_b16 v[114:115], v27 offset:8704
v_cvt_pk_bf16_f32 v248, v232, v233
v_mfma_f32_16x16x32_bf16 v[152:155], v[84:87], a[8:11], 0
ds_read_b64_tr_b16 v[116:117], v27 offset:10240
v_cvt_pk_bf16_f32 v249, v234, v235
v_mfma_f32_16x16x32_bf16 v[156:159], v[84:87], a[12:15], 0
ds_read_b64_tr_b16 v[118:119], v27 offset:10752
v_cvt_pk_bf16_f32 v250, v236, v237
v_mfma_f32_16x16x32_bf16 v[176:179], v[88:91], a[8:11], 0
v_cvt_pk_bf16_f32 v251, v238, v239
v_cvt_pk_bf16_f32 v252, v72, v73
v_mfma_f32_16x16x32_bf16 v[180:183], v[88:91], a[12:15], 0
buffer_store_dwordx4 v[248:251], v38, s[52:55], s84 offen sc1
v_mfma_f32_16x16x32_bf16 v[184:187], v[92:95], a[8:11], 0
v_mfma_f32_16x16x32_bf16 v[188:191], v[92:95], a[12:15], 0
buffer_store_dword v252, v6, s[52:55], s80 offen sc1
v_mfma_f32_16x16x32_bf16 v[196:199], v[96:99], a[4:7], 0
s_add_u32 s90, s79, 128
s_and_b32 s90, s90, 0x380
v_add_u32 v31, s90, v30
s_waitcnt lgkmcnt(0)
v_mfma_f32_16x16x32_bf16 v[128:131], v[104:107], a[16:19], v[128:131]
s_waitcnt vmcnt(22)
s_barrier
ds_read_b64_tr_b16 v[80:81], v20 offset:0
v_mfma_f32_16x16x32_bf16 v[132:135], v[104:107], a[20:23], v[132:135]
ds_read_b64_tr_b16 v[82:83], v20 offset:512
s_add_u32 s83, s79, 896
s_and_b32 s83, s83, 0x380
s_add_u32 m0, s89, 49152
s_mul_i32 s86, s83, 1376
v_mfma_f32_16x16x32_bf16 v[136:139], v[108:111], a[16:19], v[136:139]
buffer_load_dwordx4 v10, s[36:39], s86 offen lds
v_mfma_f32_16x16x32_bf16 v[140:143], v[108:111], a[20:23], v[140:143]
ds_read_b64_tr_b16 v[84:85], v20 offset:2048
v_mfma_f32_16x16x32_bf16 v[160:163], v[112:115], a[16:19], v[160:163]
ds_read_b64_tr_b16 v[86:87], v20 offset:2560
v_mfma_f32_16x16x32_bf16 v[164:167], v[112:115], a[20:23], v[164:167]
ds_read_b128 v[96:99], v31 offset:0
v_mfma_f32_16x16x32_bf16 v[168:171], v[116:119], a[16:19], v[168:171]
v_mfma_f32_16x16x32_bf16 v[172:175], v[116:119], a[20:23], v[172:175]
buffer_load_dwordx4 v11, s[36:39], s86 offen offset:1024 lds
v_mfma_f32_16x16x32_bf16 v[192:195], v[120:123], a[16:19], v[192:195]
s_lshl_b32 s92, s72, 2
s_add_u32 s92, s92, s74
s_lshr_b32 s64, s92, 1
s_lshl_b32 s65, s64, 14
s_and_b32 s66, s92, 1
s_lshl_b32 s66, s66, 9
s_add_u32 s65, s65, s66
v_mfma_f32_16x16x32_bf16 v[144:147], v[104:107], a[24:27], v[144:147]
ds_read_b64_tr_b16 v[88:89], v21 offset:0
s_add_u32 m0, s89, 51200
v_mfma_f32_16x16x32_bf16 v[148:151], v[104:107], a[28:31], v[148:151]
ds_read_b64_tr_b16 v[90:91], v21 offset:512
v_mfma_f32_16x16x32_bf16 v[152:155], v[108:111], a[24:27], v[152:155]
buffer_load_dwordx4 v10, s[40:43], s86 offen lds
v_mfma_f32_16x16x32_bf16 v[156:159], v[108:111], a[28:31], v[156:159]
ds_read_b64_tr_b16 v[92:93], v21 offset:2048
v_mfma_f32_16x16x32_bf16 v[176:179], v[112:115], a[24:27], v[176:179]
ds_read_b64_tr_b16 v[94:95], v21 offset:2560
v_mfma_f32_16x16x32_bf16 v[180:183], v[112:115], a[28:31], v[180:183]
v_mfma_f32_16x16x32_bf16 v[184:187], v[116:119], a[24:27], v[184:187]
v_mfma_f32_16x16x32_bf16 v[188:191], v[116:119], a[28:31], v[188:191]
buffer_load_dwordx4 v11, s[40:43], s86 offen offset:1024 lds
v_mfma_f32_16x16x32_bf16 v[196:199], v[120:123], a[20:23], v[196:199]
s_add_u32 s65, s65, 7864320
s_lshl_b32 s66, s92, 9
s_add_u32 s66, s66, 9043968
s_and_b32 s93, s92, 15
s_lshl_b32 s67, s93, 14
s_add_u32 s67, s67, 8781824
s_lshl_b32 s88, s93, 7
s_waitcnt lgkmcnt(4)
v_mfma_f32_16x16x32_bf16 v[128:131], v[80:83], a[32:35], v[128:131]
ds_read_b64_tr_b16 v[104:105], v20 offset:8192
s_add_u32 m0, s87, 114688
s_add_u32 s85, s13, 0
v_mfma_f32_16x16x32_bf16 v[132:135], v[80:83], a[36:39], v[132:135]
buffer_load_dwordx4 v32, s[44:47], s85 offen lds
v_mfma_f32_16x16x32_bf16 v[136:139], v[84:87], a[32:35], v[136:139]
ds_read_b64_tr_b16 v[106:107], v20 offset:8704
v_mfma_f32_16x16x32_bf16 v[140:143], v[84:87], a[36:39], v[140:143]
ds_read_b64_tr_b16 v[108:109], v20 offset:10240
s_waitcnt lgkmcnt(3)
v_mfma_f32_16x16x32_bf16 v[160:163], v[88:91], a[32:35], v[160:163]
buffer_load_dwordx4 v33, s[44:47], s85 offen offset:1024 lds
v_mfma_f32_16x16x32_bf16 v[164:167], v[88:91], a[36:39], v[164:167]
ds_read_b64_tr_b16 v[110:111], v20 offset:10752
v_mfma_f32_16x16x32_bf16 v[168:171], v[92:95], a[32:35], v[168:171]
ds_read_b128 v[120:123], v31 offset:64
v_mfma_f32_16x16x32_bf16 v[172:175], v[92:95], a[36:39], v[172:175]
buffer_load_dwordx4 v34, s[44:47], s85 offen offset:2048 lds
v_mfma_f32_16x16x32_bf16 v[192:195], v[96:99], a[32:35], v[192:195]
s_add_u32 s88, s88, 9076736
s_lshl_b32 s93, s93, 1
s_cmp_lt_u32 s92, 16
s_cselect_b32 s92, 8, 0
s_bitcmp1_b32 s73, 0
s_cselect_b32 s64, s93, s64
s_cselect_b32 s65, s67, s65
s_cselect_b32 s66, s88, s66
s_cselect_b32 s92, s92, 32
v_mfma_f32_16x16x32_bf16 v[144:147], v[80:83], a[40:43], v[144:147]
ds_read_b64_tr_b16 v[112:113], v21 offset:8192
v_mfma_f32_16x16x32_bf16 v[148:151], v[80:83], a[44:47], v[148:151]
ds_read_b64_tr_b16 v[114:115], v21 offset:8704
v_mfma_f32_16x16x32_bf16 v[152:155], v[84:87], a[40:43], v[152:155]
ds_read_b64_tr_b16 v[116:117], v21 offset:10240
v_mfma_f32_16x16x32_bf16 v[156:159], v[84:87], a[44:47], v[156:159]
ds_read_b64_tr_b16 v[118:119], v21 offset:10752
v_mfma_f32_16x16x32_bf16 v[176:179], v[88:91], a[40:43], v[176:179]
v_mfma_f32_16x16x32_bf16 v[180:183], v[88:91], a[44:47], v[180:183]
buffer_load_dwordx4 v35, s[44:47], s85 offen offset:3072 lds
v_mfma_f32_16x16x32_bf16 v[184:187], v[92:95], a[40:43], v[184:187]
s_add_u32 m0, s87, 131072
s_add_u32 s85, s13, 32768
v_mfma_f32_16x16x32_bf16 v[188:191], v[92:95], a[44:47], v[188:191]
buffer_load_dwordx4 v32, s[44:47], s85 offen lds
v_mfma_f32_16x16x32_bf16 v[196:199], v[96:99], a[36:39], v[196:199]
s_and_b32 s67, s64, 30
s_lshl_b32 s67, s67, 8
s_lshl_b32 s64, s64, 8
s_cmp_lg_u32 s92, 0
s_cselect_b32 s88, 0x100, 0
v_and_b32 v228, 31, v1
v_cmp_gt_u32 vcc, s92, v228
s_add_u32 s90, s79, 256
s_and_b32 s90, s90, 0x380
v_add_u32 v31, s90, v30
s_waitcnt lgkmcnt(0)
v_mfma_f32_16x16x32_bf16 v[128:131], v[104:107], a[48:51], v[128:131]
s_waitcnt vmcnt(27)
s_barrier
ds_read_b64_tr_b16 v[80:81], v23 offset:0
v_mfma_f32_16x16x32_bf16 v[132:135], v[104:107], a[52:55], v[132:135]
buffer_load_dwordx4 v33, s[44:47], s85 offen offset:1024 lds
v_mfma_f32_16x16x32_bf16 v[136:139], v[108:111], a[48:51], v[136:139]
ds_read_b64_tr_b16 v[82:83], v23 offset:512
v_mfma_f32_16x16x32_bf16 v[140:143], v[108:111], a[52:55], v[140:143]
ds_read_b64_tr_b16 v[84:85], v23 offset:2048
v_mfma_f32_16x16x32_bf16 v[160:163], v[112:115], a[48:51], v[160:163]
buffer_load_dwordx4 v34, s[44:47], s85 offen offset:2048 lds
v_mfma_f32_16x16x32_bf16 v[164:167], v[112:115], a[52:55], v[164:167]
ds_read_b64_tr_b16 v[86:87], v23 offset:2560
v_mfma_f32_16x16x32_bf16 v[168:171], v[116:119], a[48:51], v[168:171]
ds_read_b128 v[96:99], v31 offset:0
v_mfma_f32_16x16x32_bf16 v[172:175], v[116:119], a[52:55], v[172:175]
buffer_load_dwordx4 v35, s[44:47], s85 offen offset:3072 lds
v_mfma_f32_16x16x32_bf16 v[192:195], v[120:123], a[48:51], v[192:195]
v_lshrrev_b32 v229, 5, v1
v_lshlrev_b32 v230, 4, v228
v_mov_b32 v231, 2146435072
v_cndmask_b32_e64 v230, v231, v230, vcc
v_lshl_add_u32 v228, v229, 10, v230
v_lshl_or_b32 v229, v229, 30, v230
v_mov_b32_e64 v224, v52
v_mfma_f32_16x16x32_bf16 v[144:147], v[104:107], a[56:59], v[144:147]
ds_read_b64_tr_b16 v[88:89], v24 offset:0
s_waitcnt vmcnt(12)
v_mfma_f32_16x16x32_bf16 v[148:151], v[104:107], a[60:63], v[148:151]
ds_read_b64_tr_b16 v[90:91], v24 offset:512
s_atomic_add s69, s[26:27], s15
s_add_u32 m0, s87, 0
s_add_u32 s85, s23, 0
v_mfma_f32_16x16x32_bf16 v[152:155], v[108:111], a[56:59], v[152:155]
buffer_load_dwordx4 v32, s[44:47], s85 offen lds
v_mfma_f32_16x16x32_bf16 v[156:159], v[108:111], a[60:63], v[156:159]
ds_read_b64_tr_b16 v[92:93], v24 offset:2048
v_mfma_f32_16x16x32_bf16 v[176:179], v[112:115], a[56:59], v[176:179]
ds_read_b64_tr_b16 v[94:95], v24 offset:2560
v_mfma_f32_16x16x32_bf16 v[180:183], v[112:115], a[60:63], v[180:183]
v_mfma_f32_16x16x32_bf16 v[184:187], v[116:119], a[56:59], v[184:187]
v_mfma_f32_16x16x32_bf16 v[188:191], v[116:119], a[60:63], v[188:191]
buffer_load_dwordx4 v33, s[44:47], s85 offen offset:1024 lds
v_mfma_f32_16x16x32_bf16 v[196:199], v[120:123], a[52:55], v[196:199]
s_waitcnt lgkmcnt(4)
v_mfma_f32_16x16x32_bf16 v[128:131], v[80:83], a[64:67], v[128:131]
ds_read_b64_tr_b16 v[104:105], v23 offset:8192
v_mfma_f32_16x16x32_bf16 v[132:135], v[80:83], a[68:71], v[132:135]
ds_read_b64_tr_b16 v[106:107], v23 offset:8704
v_mfma_f32_16x16x32_bf16 v[136:139], v[84:87], a[64:67], v[136:139]
buffer_load_dwordx4 v34, s[44:47], s85 offen offset:2048 lds
v_mfma_f32_16x16x32_bf16 v[140:143], v[84:87], a[68:71], v[140:143]
ds_read_b64_tr_b16 v[108:109], v23 offset:10240
s_waitcnt lgkmcnt(3)
v_mfma_f32_16x16x32_bf16 v[160:163], v[88:91], a[64:67], v[160:163]
ds_read_b64_tr_b16 v[110:111], v23 offset:10752
v_mfma_f32_16x16x32_bf16 v[164:167], v[88:91], a[68:71], v[164:167]
ds_read_b128 v[120:123], v31 offset:64
v_mfma_f32_16x16x32_bf16 v[168:171], v[92:95], a[64:67], v[168:171]
v_mfma_f32_16x16x32_bf16 v[172:175], v[92:95], a[68:71], v[172:175]
buffer_load_dwordx4 v35, s[44:47], s85 offen offset:3072 lds
v_mfma_f32_16x16x32_bf16 v[192:195], v[96:99], a[64:67], v[192:195]
v_mov_b32 v225, v53
v_mov_b32 v226, v54
v_mov_b32 v227, v55
v_permlane32_swap_b32 v224, v52
v_permlane32_swap_b32 v225, v53
v_permlane32_swap_b32 v226, v54
v_permlane32_swap_b32 v227, v55
v_mfma_f32_16x16x32_bf16 v[144:147], v[80:83], a[72:75], v[144:147]
ds_read_b64_tr_b16 v[112:113], v24 offset:8192
v_mfma_f32_16x16x32_bf16 v[148:151], v[80:83], a[76:79], v[148:151]
ds_read_b64_tr_b16 v[114:115], v24 offset:8704
v_mfma_f32_16x16x32_bf16 v[152:155], v[84:87], a[72:75], v[152:155]
ds_read_b64_tr_b16 v[116:117], v24 offset:10240
v_mfma_f32_16x16x32_bf16 v[156:159], v[84:87], a[76:79], v[156:159]
ds_read_b64_tr_b16 v[118:119], v24 offset:10752
v_mfma_f32_16x16x32_bf16 v[176:179], v[88:91], a[72:75], v[176:179]
ds_read_b32 v47, v43
v_mfma_f32_16x16x32_bf16 v[180:183], v[88:91], a[76:79], v[180:183]
v_mfma_f32_16x16x32_bf16 v[184:187], v[92:95], a[72:75], v[184:187]
v_mfma_f32_16x16x32_bf16 v[188:191], v[92:95], a[76:79], v[188:191]
v_mfma_f32_16x16x32_bf16 v[196:199], v[96:99], a[68:71], v[196:199]
s_add_u32 s90, s79, 384
s_and_b32 s90, s90, 0x380
v_add_u32 v31, s90, v30
s_waitcnt lgkmcnt(1)
v_mfma_f32_16x16x32_bf16 v[128:131], v[104:107], a[80:83], v[128:131]
s_barrier
ds_read_b64_tr_b16 v[80:81], v20 offset:16384
s_add_u32 m0, s87, 65536
s_add_u32 s85, s23, 32768
v_mfma_f32_16x16x32_bf16 v[132:135], v[104:107], a[84:87], v[132:135]
buffer_load_dwordx4 v32, s[44:47], s85 offen lds
v_mfma_f32_16x16x32_bf16 v[136:139], v[108:111], a[80:83], v[136:139]
ds_read_b64_tr_b16 v[82:83], v20 offset:16896
v_mfma_f32_16x16x32_bf16 v[140:143], v[108:111], a[84:87], v[140:143]
ds_read_b64_tr_b16 v[84:85], v20 offset:18432
v_mfma_f32_16x16x32_bf16 v[160:163], v[112:115], a[80:83], v[160:163]
buffer_load_dwordx4 v33, s[44:47], s85 offen offset:1024 lds
v_mfma_f32_16x16x32_bf16 v[164:167], v[112:115], a[84:87], v[164:167]
ds_read_b64_tr_b16 v[86:87], v20 offset:18944
v_mfma_f32_16x16x32_bf16 v[168:171], v[116:119], a[80:83], v[168:171]
ds_read_b128 v[96:99], v31 offset:0
v_mfma_f32_16x16x32_bf16 v[172:175], v[116:119], a[84:87], v[172:175]
buffer_load_dwordx4 v34, s[44:47], s85 offen offset:2048 lds
v_mfma_f32_16x16x32_bf16 v[192:195], v[120:123], a[80:83], v[192:195]
v_mfma_f32_16x16x32_bf16 v[144:147], v[104:107], a[88:91], v[144:147]
ds_read_b64_tr_b16 v[88:89], v21 offset:16384
v_mfma_f32_16x16x32_bf16 v[148:151], v[104:107], a[92:95], v[148:151]
ds_read_b64_tr_b16 v[90:91], v21 offset:16896
v_mfma_f32_16x16x32_bf16 v[152:155], v[108:111], a[88:91], v[152:155]
ds_read_b64_tr_b16 v[92:93], v21 offset:18432
v_mfma_f32_16x16x32_bf16 v[156:159], v[108:111], a[92:95], v[156:159]
ds_read_b64_tr_b16 v[94:95], v21 offset:18944
v_mfma_f32_16x16x32_bf16 v[176:179], v[112:115], a[88:91], v[176:179]
v_mfma_f32_16x16x32_bf16 v[180:183], v[112:115], a[92:95], v[180:183]
L_pad_KL_3:
s_cbranch_execz L_pad_KL_4
s_nop 0
v_mfma_f32_16x16x32_bf16 v[184:187], v[116:119], a[88:91], v[184:187]
v_mfma_f32_16x16x32_bf16 v[188:191], v[116:119], a[92:95], v[188:191]
buffer_load_dwordx4 v35, s[44:47], s85 offen offset:3072 lds
v_mfma_f32_16x16x32_bf16 v[196:199], v[120:123], a[84:87], v[196:199]
s_waitcnt lgkmcnt(4)
v_mfma_f32_16x16x32_bf16 v[128:131], v[80:83], a[96:99], v[128:131]
ds_read_b64_tr_b16 v[104:105], v20 offset:24576
s_load_dword s68, s[26:27], s64 glc
v_mfma_f32_16x16x32_bf16 v[132:135], v[80:83], a[100:103], v[132:135]
ds_read_b64_tr_b16 v[106:107], v20 offset:25088
v_mfma_f32_16x16x32_bf16 v[136:139], v[84:87], a[96:99], v[136:139]
ds_read_b64_tr_b16 v[108:109], v20 offset:26624
v_mfma_f32_16x16x32_bf16 v[140:143], v[84:87], a[100:103], v[140:143]
ds_read_b64_tr_b16 v[110:111], v20 offset:27136
s_waitcnt lgkmcnt(4)
v_mfma_f32_16x16x32_bf16 v[160:163], v[88:91], a[96:99], v[160:163]
ds_read_b128 v[120:123], v31 offset:64
v_mfma_f32_16x16x32_bf16 v[164:167], v[88:91], a[100:103], v[164:167]
v_mfma_f32_16x16x32_bf16 v[168:171], v[92:95], a[96:99], v[168:171]
v_mfma_f32_16x16x32_bf16 v[172:175], v[92:95], a[100:103], v[172:175]
v_mfma_f32_16x16x32_bf16 v[192:195], v[96:99], a[96:99], v[192:195]
v_mfma_f32_16x16x32_bf16 v[144:147], v[80:83], a[104:107], v[144:147]
s_waitcnt vmcnt(12)
ds_read_b64_tr_b16 v[112:113], v21 offset:24576
v_mfma_f32_16x16x32_bf16 v[148:151], v[80:83], a[108:111], v[148:151]
ds_read_b64_tr_b16 v[114:115], v21 offset:25088
v_mfma_f32_16x16x32_bf16 v[152:155], v[84:87], a[104:107], v[152:155]
ds_read_b64_tr_b16 v[116:117], v21 offset:26624
v_mfma_f32_16x16x32_bf16 v[156:159], v[84:87], a[108:111], v[156:159]
ds_read_b64_tr_b16 v[118:119], v21 offset:27136
v_mfma_f32_16x16x32_bf16 v[176:179], v[88:91], a[104:107], v[176:179]
ds_read_b64_tr_b16 a[0:1], v41 offset:49152
v_mfma_f32_16x16x32_bf16 v[180:183], v[88:91], a[108:111], v[180:183]
ds_read_b64_tr_b16 a[2:3], v41 offset:50176
v_mfma_f32_16x16x32_bf16 v[184:187], v[92:95], a[104:107], v[184:187]
ds_read_b64_tr_b16 a[4:5], v14 offset:49152
v_mfma_f32_16x16x32_bf16 v[188:191], v[92:95], a[108:111], v[188:191]
ds_read_b64_tr_b16 a[6:7], v14 offset:50176
v_mfma_f32_16x16x32_bf16 v[196:199], v[96:99], a[100:103], v[196:199]
ds_read_b32 v47, v43
s_add_u32 s90, s79, 512
s_and_b32 s90, s90, 0x380
v_add_u32 v31, s90, v30
s_waitcnt lgkmcnt(1)
v_mfma_f32_16x16x32_bf16 v[128:131], v[104:107], a[112:115], v[128:131]
s_barrier
ds_read_b64_tr_b16 v[80:81], v23 offset:16384
ds_read_b64_tr_b16 v[82:83], v23 offset:16896
s_add_u32 m0, s87, 16384
s_add_u32 s85, s4, 0
v_mfma_f32_16x16x32_bf16 v[132:135], v[104:107], a[116:119], v[132:135]
buffer_load_dwordx4 v32, s[48:51], s85 offen lds
v_mfma_f32_16x16x32_bf16 v[136:139], v[108:111], a[112:115], v[136:139]
ds_read_b64_tr_b16 v[84:85], v23 offset:18432
ds_read_b64_tr_b16 v[86:87], v23 offset:18944
v_mfma_f32_16x16x32_bf16 v[140:143], v[108:111], a[116:119], v[140:143]
ds_read_b128 v[96:99], v31 offset:0
ds_read_b64_tr_b16 a[8:9], v41 offset:49408
v_mfma_f32_16x16x32_bf16 v[160:163], v[112:115], a[112:115], v[160:163]
buffer_load_dwordx4 v33, s[48:51], s85 offen offset:1024 lds
v_mfma_f32_16x16x32_bf16 v[164:167], v[112:115], a[116:119], v[164:167]
ds_read_b64_tr_b16 a[10:11], v41 offset:50432
v_mfma_f32_16x16x32_bf16 v[168:171], v[116:119], a[112:115], v[168:171]
ds_read_b64_tr_b16 a[12:13], v14 offset:49408
v_mfma_f32_16x16x32_bf16 v[172:175], v[116:119], a[116:119], v[172:175]
buffer_load_dwordx4 v34, s[48:51], s85 offen offset:2048 lds
v_mfma_f32_16x16x32_bf16 v[192:195], v[120:123], a[112:115], v[192:195]
ds_read_b64_tr_b16 a[14:15], v14 offset:50432
v_mfma_f32_16x16x32_bf16 v[144:147], v[104:107], a[120:123], v[144:147]
s_waitcnt vmcnt(11)
ds_read_b64_tr_b16 v[88:89], v24 offset:16384
v_mfma_f32_16x16x32_bf16 v[148:151], v[104:107], a[124:127], v[148:151]
ds_read_b64_tr_b16 v[90:91], v24 offset:16896
v_mfma_f32_16x16x32_bf16 v[152:155], v[108:111], a[120:123], v[152:155]
ds_read_b64_tr_b16 v[92:93], v24 offset:18432
v_mfma_f32_16x16x32_bf16 v[156:159], v[108:111], a[124:127], v[156:159]
ds_read_b64_tr_b16 v[94:95], v24 offset:18944
v_mfma_f32_16x16x32_bf16 v[176:179], v[112:115], a[120:123], v[176:179]
ds_read_b64_tr_b16 a[16:17], v42 offset:0
v_mfma_f32_16x16x32_bf16 v[180:183], v[112:115], a[124:127], v[180:183]
ds_read_b64_tr_b16 a[18:19], v42 offset:1024
v_mfma_f32_16x16x32_bf16 v[184:187], v[116:119], a[120:123], v[184:187]
ds_read_b64_tr_b16 a[20:21], v15 offset:0
v_mfma_f32_16x16x32_bf16 v[188:191], v[116:119], a[124:127], v[188:191]
buffer_load_dwordx4 v35, s[48:51], s85 offen offset:3072 lds
v_mfma_f32_16x16x32_bf16 v[196:199], v[120:123], a[116:119], v[196:199]
ds_read_b64_tr_b16 a[22:23], v15 offset:1024
s_waitcnt lgkmcnt(0)
s_bfe_u32 s97, s68, 524288
s_cmp_lt_u32 s97, 16
s_cbranch_scc1 L_slow_KL1
L_back_KL1:
buffer_load_dwordx4 a[96:99], v228, s[52:55], s65 offen offset:0 sc1
buffer_load_dwordx4 a[100:103], v228, s[52:55], s65 offen offset:2048 sc1
s_add_u32 s65, s65, 4096
buffer_load_dwordx4 a[104:107], v228, s[52:55], s65 offen offset:0 sc1
buffer_load_dwordx4 a[108:111], v228, s[52:55], s65 offen offset:2048 sc1
v_mfma_f32_16x16x32_bf16 v[128:131], v[80:83], a[128:131], v[128:131]
ds_read_b64_tr_b16 v[104:105], v23 offset:24576
ds_read_b64_tr_b16 v[106:107], v23 offset:25088
s_add_u32 s65, s65, 4096
v_mfma_f32_16x16x32_bf16 v[132:135], v[80:83], a[132:135], v[132:135]
buffer_load_dwordx4 a[112:115], v228, s[52:55], s65 offen offset:0 sc1
v_mfma_f32_16x16x32_bf16 v[136:139], v[84:87], a[128:131], v[136:139]
ds_read_b64_tr_b16 v[108:109], v23 offset:26624
ds_read_b64_tr_b16 v[110:111], v23 offset:27136
v_mfma_f32_16x16x32_bf16 v[140:143], v[84:87], a[132:135], v[140:143]
ds_read_b128 v[120:123], v31 offset:64
ds_read_b64_tr_b16 a[24:25], v42 offset:256
v_mfma_f32_16x16x32_bf16 v[160:163], v[88:91], a[128:131], v[160:163]
buffer_load_dwordx4 a[116:119], v228, s[52:55], s65 offen offset:2048 sc1
v_mfma_f32_16x16x32_bf16 v[164:167], v[88:91], a[132:135], v[164:167]
ds_read_b64_tr_b16 a[26:27], v42 offset:1280
s_add_u32 s65, s65, 4096
v_mfma_f32_16x16x32_bf16 v[168:171], v[92:95], a[128:131], v[168:171]
ds_read_b64_tr_b16 a[28:29], v15 offset:256
v_mfma_f32_16x16x32_bf16 v[172:175], v[92:95], a[132:135], v[172:175]
buffer_load_dwordx4 a[120:123], v228, s[52:55], s65 offen offset:0 sc1
v_mfma_f32_16x16x32_bf16 v[192:195], v[96:99], a[128:131], v[192:195]
ds_read_b64_tr_b16 a[30:31], v15 offset:1280
v_mfma_f32_16x16x32_bf16 v[144:147], v[80:83], a[136:139], v[144:147]
s_waitcnt vmcnt(15)
ds_read_b64_tr_b16 v[112:113], v24 offset:24576
ds_read_b64_tr_b16 v[114:115], v24 offset:25088
v_mfma_f32_16x16x32_bf16 v[148:151], v[80:83], a[140:143], v[148:151]
ds_read_b64_tr_b16 v[116:117], v24 offset:26624
v_mfma_f32_16x16x32_bf16 v[152:155], v[84:87], a[136:139], v[152:155]
ds_read_b64_tr_b16 v[118:119], v24 offset:27136
v_mfma_f32_16x16x32_bf16 v[156:159], v[84:87], a[140:143], v[156:159]
ds_read_b64_tr_b16 a[32:33], v40 offset:0
v_mfma_f32_16x16x32_bf16 v[176:179], v[88:91], a[136:139], v[176:179]
ds_read_b64_tr_b16 a[34:35], v40 offset:1024
v_mfma_f32_16x16x32_bf16 v[180:183], v[88:91], a[140:143], v[180:183]
buffer_load_dwordx4 a[124:127], v228, s[52:55], s65 offen offset:2048 sc1
v_mfma_f32_16x16x32_bf16 v[184:187], v[92:95], a[136:139], v[184:187]
ds_read_b64_tr_b16 a[36:37], v13 offset:0
s_add_u32 m0, s87, 114688
s_add_u32 s85, s4, 32768
v_mfma_f32_16x16x32_bf16 v[188:191], v[92:95], a[140:143], v[188:191]
buffer_load_dwordx4 v32, s[48:51], s85 offen lds
v_mfma_f32_16x16x32_bf16 v[196:199], v[96:99], a[132:135], v[196:199]
ds_read_b64_tr_b16 a[38:39], v13 offset:1024
s_add_u32 s90, s79, 640
s_and_b32 s90, s90, 0x380
v_add_u32_e64 v31, s90, v30
s_waitcnt lgkmcnt(0)
v_mfma_f32_16x16x32_bf16 v[128:131], v[104:107], a[144:147], v[128:131]
s_barrier
ds_read_b64_tr_b16 v[80:81], v20 offset:32768
ds_read_b64_tr_b16 v[82:83], v20 offset:33280
v_mfma_f32_16x16x32_bf16 v[132:135], v[104:107], a[148:151], v[132:135]
buffer_load_dwordx4 v33, s[48:51], s85 offen offset:1024 lds
v_mfma_f32_16x16x32_bf16 v[136:139], v[108:111], a[144:147], v[136:139]
ds_read_b64_tr_b16 v[84:85], v20 offset:34816
ds_read_b64_tr_b16 v[86:87], v20 offset:35328
v_mfma_f32_16x16x32_bf16 v[140:143], v[108:111], a[148:151], v[140:143]
ds_read_b128 v[96:99], v31 offset:0
ds_read_b64_tr_b16 a[40:41], v40 offset:256
v_mfma_f32_16x16x32_bf16 v[160:163], v[112:115], a[144:147], v[160:163]
buffer_load_dwordx4 v34, s[48:51], s85 offen offset:2048 lds
v_mfma_f32_16x16x32_bf16 v[164:167], v[112:115], a[148:151], v[164:167]
ds_read_b64_tr_b16 a[42:43], v40 offset:1280
v_mfma_f32_16x16x32_bf16 v[168:171], v[116:119], a[144:147], v[168:171]
ds_read_b64_tr_b16 a[44:45], v13 offset:256
v_mfma_f32_16x16x32_bf16 v[172:175], v[116:119], a[148:151], v[172:175]
buffer_load_dwordx4 v35, s[48:51], s85 offen offset:3072 lds
v_mfma_f32_16x16x32_bf16 v[192:195], v[120:123], a[144:147], v[192:195]
ds_read_b64_tr_b16 a[46:47], v13 offset:1280
v_mfma_f32_16x16x32_bf16 v[144:147], v[104:107], a[152:155], v[144:147]
s_waitcnt vmcnt(16)
ds_read_b64_tr_b16 v[88:89], v21 offset:32768
ds_read_b64_tr_b16 v[90:91], v21 offset:33280
v_mfma_f32_16x16x32_bf16 v[148:151], v[104:107], a[156:159], v[148:151]
ds_read_b64_tr_b16 v[92:93], v21 offset:34816
s_add_u32 m0, s87, 81920
s_add_u32 s85, s4, 65536
v_mfma_f32_16x16x32_bf16 v[152:155], v[108:111], a[152:155], v[152:155]
buffer_load_dwordx4 v32, s[48:51], s85 offen lds
v_mfma_f32_16x16x32_bf16 v[156:159], v[108:111], a[156:159], v[156:159]
ds_read_b64_tr_b16 v[94:95], v21 offset:35328
v_mfma_f32_16x16x32_bf16 v[176:179], v[112:115], a[152:155], v[176:179]
ds_read_b64_tr_b16 a[48:49], v41 offset:0
v_mfma_f32_16x16x32_bf16 v[180:183], v[112:115], a[156:159], v[180:183]
ds_read_b64_tr_b16 a[50:51], v41 offset:1024
v_mfma_f32_16x16x32_bf16 v[184:187], v[116:119], a[152:155], v[184:187]
ds_read_b64_tr_b16 a[52:53], v14 offset:0
v_mfma_f32_16x16x32_bf16 v[188:191], v[116:119], a[156:159], v[188:191]
buffer_load_dwordx4 v33, s[48:51], s85 offen offset:1024 lds
v_mfma_f32_16x16x32_bf16 v[196:199], v[120:123], a[148:151], v[196:199]
ds_read_b64_tr_b16 a[54:55], v14 offset:1024
s_waitcnt lgkmcnt(8)
v_mfma_f32_16x16x32_bf16 v[128:131], v[80:83], a[160:163], v[128:131]
ds_read_b64_tr_b16 v[104:105], v20 offset:40960
v_mfma_f32_16x16x32_bf16 v[132:135], v[80:83], a[164:167], v[132:135]
ds_read_b64_tr_b16 v[106:107], v20 offset:41472
v_mfma_f32_16x16x32_bf16 v[136:139], v[84:87], a[160:163], v[136:139]
buffer_load_dwordx4 v34, s[48:51], s85 offen offset:2048 lds
v_mfma_f32_16x16x32_bf16 v[140:143], v[84:87], a[164:167], v[140:143]
ds_read_b64_tr_b16 v[108:109], v20 offset:43008
s_waitcnt lgkmcnt(3)
v_mfma_f32_16x16x32_bf16 v[160:163], v[88:91], a[160:163], v[160:163]
ds_read_b64_tr_b16 v[110:111], v20 offset:43520
v_mfma_f32_16x16x32_bf16 v[164:167], v[88:91], a[164:167], v[164:167]
ds_read_b128 v[120:123], v31 offset:64
v_mfma_f32_16x16x32_bf16 v[168:171], v[92:95], a[160:163], v[168:171]
buffer_load_dwordx4 v35, s[48:51], s85 offen offset:3072 lds
v_mfma_f32_16x16x32_bf16 v[172:175], v[92:95], a[164:167], v[172:175]
ds_read_b64_tr_b16 a[56:57], v41 offset:256
s_add_u32 m0, s87, 0
v_mfma_f32_16x16x32_bf16 v[192:195], v[96:99], a[160:163], v[192:195]
ds_read_b64_tr_b16 a[58:59], v41 offset:1280
s_add_u32 s85, s5, 0
s_waitcnt vmcnt(15)
v_mfma_f32_32x32x16_bf16 v[208:223], v[224:227], a[96:99], 0
ds_read_b64_tr_b16 a[60:61], v14 offset:256
ds_read_b64_tr_b16 a[62:63], v14 offset:1280
s_waitcnt vmcnt(14)
v_mfma_f32_32x32x16_bf16 v[208:223], v[224:227], a[100:103], v[208:223]
s_waitcnt vmcnt(13)
v_mfma_f32_32x32x16_bf16 v[208:223], v[224:227], a[104:107], v[208:223]
buffer_load_dwordx4 v32, s[48:51], s85 offen lds
s_waitcnt vmcnt(13)
v_mfma_f32_32x32x16_bf16 v[208:223], v[224:227], a[108:111], v[208:223]
v_mfma_f32_16x16x32_bf16 v[144:147], v[80:83], a[168:171], v[144:147]
ds_read_b64_tr_b16 v[112:113], v21 offset:40960
v_mfma_f32_16x16x32_bf16 v[148:151], v[80:83], a[172:175], v[148:151]
ds_read_b64_tr_b16 v[114:115], v21 offset:41472
v_mfma_f32_16x16x32_bf16 v[152:155], v[84:87], a[168:171], v[152:155]
ds_read_b64_tr_b16 v[116:117], v21 offset:43008
v_mfma_f32_16x16x32_bf16 v[156:159], v[84:87], a[172:175], v[156:159]
ds_read_b64_tr_b16 v[118:119], v21 offset:43520
v_mfma_f32_16x16x32_bf16 v[176:179], v[88:91], a[168:171], v[176:179]
v_mfma_f32_16x16x32_bf16 v[180:183], v[88:91], a[172:175], v[180:183]
v_mfma_f32_16x16x32_bf16 v[184:187], v[92:95], a[168:171], v[184:187]
v_mfma_f32_16x16x32_bf16 v[188:191], v[92:95], a[172:175], v[188:191]
v_mfma_f32_16x16x32_bf16 v[196:199], v[96:99], a[164:167], v[196:199]
s_waitcnt vmcnt(12)
v_mfma_f32_32x32x16_bf16 v[208:223], v[224:227], a[112:115], v[208:223]
buffer_load_dwordx4 v33, s[48:51], s85 offen offset:1024 lds
s_waitcnt vmcnt(12)
v_mfma_f32_32x32x16_bf16 v[208:223], v[224:227], a[116:119], v[208:223]
s_waitcnt vmcnt(11)
v_mfma_f32_32x32x16_bf16 v[208:223], v[224:227], a[120:123], v[208:223]
buffer_load_dwordx4 v34, s[48:51], s85 offen offset:2048 lds
s_waitcnt vmcnt(11)
v_mfma_f32_32x32x16_bf16 v[208:223], v[224:227], a[124:127], v[208:223]
s_add_u32 s90, s79, 768
s_and_b32 s90, s90, 0x380
v_add_u32 v31, s90, v30
s_waitcnt lgkmcnt(0)
v_mfma_f32_16x16x32_bf16 v[128:131], v[104:107], a[176:179], v[128:131]
s_barrier
buffer_load_dwordx4 v35, s[48:51], s85 offen offset:3072 lds
v_mfma_f32_16x16x32_bf16 v[132:135], v[104:107], a[180:183], v[132:135]
ds_read_b64_tr_b16 v[80:81], v23 offset:32768
s_add_u32 m0, s87, 32768
s_add_u32 s85, s5, 32768
v_mfma_f32_16x16x32_bf16 v[136:139], v[108:111], a[176:179], v[136:139]
buffer_load_dwordx4 v32, s[48:51], s85 offen lds
v_mfma_f32_16x16x32_bf16 v[140:143], v[108:111], a[180:183], v[140:143]
ds_read_b64_tr_b16 v[82:83], v23 offset:33280
v_mfma_f32_16x16x32_bf16 v[160:163], v[112:115], a[176:179], v[160:163]
buffer_load_dwordx4 v33, s[48:51], s85 offen offset:1024 lds
v_mfma_f32_16x16x32_bf16 v[164:167], v[112:115], a[180:183], v[164:167]
ds_read_b64_tr_b16 v[84:85], v23 offset:34816
v_cvt_pk_bf16_f32 v216, v208, v209
v_mfma_f32_16x16x32_bf16 v[168:171], v[116:119], a[176:179], v[168:171]
ds_read_b64_tr_b16 v[86:87], v23 offset:35328
v_cvt_pk_bf16_f32 v217, v210, v211
v_cvt_pk_bf16_f32 v218, v212, v213
v_cvt_pk_bf16_f32 v219, v214, v215
v_mfma_f32_16x16x32_bf16 v[172:175], v[116:119], a[180:183], v[172:175]
buffer_store_dwordx4 v[216:219], v229, s[52:55], s66 offen sc1
v_mfma_f32_16x16x32_bf16 v[192:195], v[120:123], a[176:179], v[192:195]
ds_read_b128 v[96:99], v31 offset:0
v_mfma_f32_16x16x32_bf16 v[144:147], v[104:107], a[184:187], v[144:147]
ds_read_b64_tr_b16 v[88:89], v24 offset:32768
ds_read_b64_tr_b16 v[90:91], v24 offset:33280
v_mfma_f32_16x16x32_bf16 v[148:151], v[104:107], a[188:191], v[148:151]
ds_read_b64_tr_b16 v[92:93], v24 offset:34816
v_mfma_f32_16x16x32_bf16 v[152:155], v[108:111], a[184:187], v[152:155]
buffer_load_dwordx4 v34, s[48:51], s85 offen offset:2048 lds
v_mfma_f32_16x16x32_bf16 v[156:159], v[108:111], a[188:191], v[156:159]
ds_read_b64_tr_b16 v[94:95], v24 offset:35328
v_mfma_f32_16x16x32_bf16 v[176:179], v[112:115], a[184:187], v[176:179]
ds_read_b64_tr_b16 a[64:65], v40 offset:16384
v_mfma_f32_16x16x32_bf16 v[180:183], v[112:115], a[188:191], v[180:183]
ds_read_b64_tr_b16 a[66:67], v40 offset:17408
v_mfma_f32_16x16x32_bf16 v[184:187], v[116:119], a[184:187], v[184:187]
ds_read_b64_tr_b16 a[68:69], v13 offset:16384
v_mfma_f32_16x16x32_bf16 v[188:191], v[116:119], a[188:191], v[188:191]
buffer_load_dwordx4 v35, s[48:51], s85 offen offset:3072 lds
v_mfma_f32_16x16x32_bf16 v[196:199], v[120:123], a[180:183], v[196:199]
ds_read_b64_tr_b16 a[70:71], v13 offset:17408
s_waitcnt lgkmcnt(8)
v_mfma_f32_16x16x32_bf16 v[128:131], v[80:83], a[192:195], v[128:131]
ds_read_b64_tr_b16 v[104:105], v23 offset:40960
ds_read_b64_tr_b16 v[106:107], v23 offset:41472
s_add_u32 m0, s87, 65536
s_add_u32 s85, s5, 65536
v_mfma_f32_16x16x32_bf16 v[132:135], v[80:83], a[196:199], v[132:135]
buffer_load_dwordx4 v32, s[48:51], s85 offen lds
v_mfma_f32_16x16x32_bf16 v[136:139], v[84:87], a[192:195], v[136:139]
ds_read_b64_tr_b16 v[108:109], v23 offset:43008
ds_read_b64_tr_b16 v[110:111], v23 offset:43520
v_mfma_f32_16x16x32_bf16 v[140:143], v[84:87], a[196:199], v[140:143]
ds_read_b128 v[120:123], v31 offset:64
ds_read_b64_tr_b16 a[72:73], v40 offset:16640
s_waitcnt lgkmcnt(6)
v_mfma_f32_16x16x32_bf16 v[160:163], v[88:91], a[192:195], v[160:163]
buffer_load_dwordx4 v33, s[48:51], s85 offen offset:1024 lds
v_mfma_f32_16x16x32_bf16 v[164:167], v[88:91], a[196:199], v[164:167]
ds_read_b64_tr_b16 a[74:75], v40 offset:17664
v_mfma_f32_16x16x32_bf16 v[168:171], v[92:95], a[192:195], v[168:171]
ds_read_b64_tr_b16 a[76:77], v13 offset:16640
v_mfma_f32_16x16x32_bf16 v[172:175], v[92:95], a[196:199], v[172:175]
buffer_load_dwordx4 v34, s[48:51], s85 offen offset:2048 lds
v_mfma_f32_16x16x32_bf16 v[192:195], v[96:99], a[192:195], v[192:195]
ds_read_b64_tr_b16 a[78:79], v13 offset:17664
v_mfma_f32_16x16x32_bf16 v[144:147], v[80:83], a[200:203], v[144:147]
ds_read_b64_tr_b16 v[112:113], v24 offset:40960
v_mfma_f32_16x16x32_bf16 v[148:151], v[80:83], a[204:207], v[148:151]
ds_read_b64_tr_b16 v[114:115], v24 offset:41472
v_mfma_f32_16x16x32_bf16 v[152:155], v[84:87], a[200:203], v[152:155]
ds_read_b64_tr_b16 v[116:117], v24 offset:43008
v_mfma_f32_16x16x32_bf16 v[156:159], v[84:87], a[204:207], v[156:159]
ds_read_b64_tr_b16 v[118:119], v24 offset:43520
v_mfma_f32_16x16x32_bf16 v[176:179], v[88:91], a[200:203], v[176:179]
v_mfma_f32_16x16x32_bf16 v[180:183], v[88:91], a[204:207], v[180:183]
buffer_load_dwordx4 v35, s[48:51], s85 offen offset:3072 lds
v_mfma_f32_16x16x32_bf16 v[184:187], v[92:95], a[200:203], v[184:187]
s_add_u32 m0, s87, 131072
s_add_u32 s85, s6, 0
v_mfma_f32_16x16x32_bf16 v[188:191], v[92:95], a[204:207], v[188:191]
buffer_load_dwordx4 v32, s[48:51], s85 offen lds
v_mfma_f32_16x16x32_bf16 v[196:199], v[96:99], a[196:199], v[196:199]
s_add_u32 s90, s79, 896
s_and_b32 s90, s90, 0x380
v_add_u32 v31, s90, v30
s_waitcnt lgkmcnt(0)
v_mfma_f32_16x16x32_bf16 v[128:131], v[104:107], a[208:211], v[128:131]
s_barrier
s_waitcnt vmcnt(18)
ds_read_b64_tr_b16 v[80:81], v20 offset:49152
ds_read_b64_tr_b16 v[82:83], v20 offset:49664
s_waitcnt vmcnt(7)
s_atomic_add s88, s[26:27], s67
v_mfma_f32_16x16x32_bf16 v[132:135], v[104:107], a[212:215], v[132:135]
buffer_load_dwordx4 v33, s[48:51], s85 offen offset:1024 lds
v_mfma_f32_16x16x32_bf16 v[136:139], v[108:111], a[208:211], v[136:139]
ds_read_b64_tr_b16 v[84:85], v20 offset:51200
ds_read_b64_tr_b16 v[86:87], v20 offset:51712
v_mfma_f32_16x16x32_bf16 v[140:143], v[108:111], a[212:215], v[140:143]
ds_read_b128 v[96:99], v31 offset:0
ds_read_b64_tr_b16 a[80:81], v41 offset:49152
v_mfma_f32_16x16x32_bf16 v[160:163], v[112:115], a[208:211], v[160:163]
buffer_load_dwordx4 v34, s[48:51], s85 offen offset:2048 lds
v_mfma_f32_16x16x32_bf16 v[164:167], v[112:115], a[212:215], v[164:167]
ds_read_b64_tr_b16 a[82:83], v41 offset:50176
v_mfma_f32_16x16x32_bf16 v[168:171], v[116:119], a[208:211], v[168:171]
ds_read_b64_tr_b16 a[84:85], v14 offset:49152
v_mfma_f32_16x16x32_bf16 v[172:175], v[116:119], a[212:215], v[172:175]
buffer_load_dwordx4 v35, s[48:51], s85 offen offset:3072 lds
v_mfma_f32_16x16x32_bf16 v[192:195], v[120:123], a[208:211], v[192:195]
ds_read_b64_tr_b16 a[86:87], v14 offset:50176
v_mfma_f32_16x16x32_bf16 v[144:147], v[104:107], a[216:219], v[144:147]
ds_read_b64_tr_b16 v[88:89], v21 offset:49152
ds_read_b64_tr_b16 v[90:91], v21 offset:49664
v_mfma_f32_16x16x32_bf16 v[148:151], v[104:107], a[220:223], v[148:151]
ds_read_b64_tr_b16 v[92:93], v21 offset:51200
s_add_u32 m0, s87, 16384
s_add_u32 s85, s6, 32768
v_mfma_f32_16x16x32_bf16 v[152:155], v[108:111], a[216:219], v[152:155]
buffer_load_dwordx4 v32, s[48:51], s85 offen lds
v_mfma_f32_16x16x32_bf16 v[156:159], v[108:111], a[220:223], v[156:159]
ds_read_b64_tr_b16 v[94:95], v21 offset:51712
v_mfma_f32_16x16x32_bf16 v[176:179], v[112:115], a[216:219], v[176:179]
ds_read_b64_tr_b16 a[88:89], v41 offset:49408
v_mfma_f32_16x16x32_bf16 v[180:183], v[112:115], a[220:223], v[180:183]
ds_read_b64_tr_b16 a[90:91], v41 offset:50432
v_mfma_f32_16x16x32_bf16 v[184:187], v[116:119], a[216:219], v[184:187]
ds_read_b64_tr_b16 a[92:93], v14 offset:49408
v_mfma_f32_16x16x32_bf16 v[188:191], v[116:119], a[220:223], v[188:191]
buffer_load_dwordx4 v33, s[48:51], s85 offen offset:1024 lds
v_mfma_f32_16x16x32_bf16 v[196:199], v[120:123], a[212:215], v[196:199]
ds_read_b64_tr_b16 a[94:95], v14 offset:50432
s_waitcnt lgkmcnt(8)
v_mfma_f32_16x16x32_bf16 v[128:131], v[80:83], a[224:227], v[128:131]
ds_read_b64_tr_b16 v[104:105], v20 offset:57344
s_load_dword s68, s[26:27], s14 glc
v_mfma_f32_16x16x32_bf16 v[132:135], v[80:83], a[228:231], v[132:135]
buffer_load_dwordx4 v34, s[48:51], s85 offen offset:2048 lds
v_mfma_f32_16x16x32_bf16 v[136:139], v[84:87], a[224:227], v[136:139]
ds_read_b64_tr_b16 v[106:107], v20 offset:57856
v_mfma_f32_16x16x32_bf16 v[140:143], v[84:87], a[228:231], v[140:143]
ds_read_b64_tr_b16 v[108:109], v20 offset:59392
s_waitcnt lgkmcnt(3)
v_mfma_f32_16x16x32_bf16 v[160:163], v[88:91], a[224:227], v[160:163]
buffer_load_dwordx4 v35, s[48:51], s85 offen offset:3072 lds
v_mfma_f32_16x16x32_bf16 v[164:167], v[88:91], a[228:231], v[164:167]
ds_read_b64_tr_b16 v[110:111], v20 offset:59904
s_add_u32 m0, s87, 98304
v_mfma_f32_16x16x32_bf16 v[168:171], v[92:95], a[224:227], v[168:171]
ds_read_b128 v[120:123], v31 offset:64
s_add_u32 s85, s18, 65536
v_mfma_f32_16x16x32_bf16 v[172:175], v[92:95], a[228:231], v[172:175]
buffer_load_dwordx4 v32, s[48:51], s85 offen lds
v_mfma_f32_16x16x32_bf16 v[192:195], v[96:99], a[224:227], v[192:195]
v_mfma_f32_16x16x32_bf16 v[144:147], v[80:83], a[232:235], v[144:147]
ds_read_b64_tr_b16 v[112:113], v21 offset:57344
v_mfma_f32_16x16x32_bf16 v[148:151], v[80:83], a[236:239], v[148:151]
ds_read_b64_tr_b16 v[114:115], v21 offset:57856
v_mfma_f32_16x16x32_bf16 v[152:155], v[84:87], a[232:235], v[152:155]
ds_read_b64_tr_b16 v[116:117], v21 offset:59392
v_mfma_f32_16x16x32_bf16 v[156:159], v[84:87], a[236:239], v[156:159]
ds_read_b64_tr_b16 v[118:119], v21 offset:59904
v_mfma_f32_16x16x32_bf16 v[176:179], v[88:91], a[232:235], v[176:179]
ds_read_b32 v47, v43
v_mfma_f32_16x16x32_bf16 v[180:183], v[88:91], a[236:239], v[180:183]
buffer_load_dwordx4 v33, s[48:51], s85 offen offset:1024 lds
v_mfma_f32_16x16x32_bf16 v[184:187], v[92:95], a[232:235], v[184:187]
ds_read_b32 v47, v43
s_add_u32 s85, s19, 49152
v_mfma_f32_16x16x32_bf16 v[188:191], v[92:95], a[236:239], v[188:191]
buffer_load_dwordx4 v36, s[48:51], s85 offen offset:2048 lds
v_mfma_f32_16x16x32_bf16 v[196:199], v[96:99], a[228:231], v[196:199]
s_waitcnt lgkmcnt(2)
v_mfma_f32_16x16x32_bf16 v[128:131], v[104:107], a[240:243], v[128:131]
s_barrier
v_mfma_f32_16x16x32_bf16 v[132:135], v[104:107], a[244:247], v[132:135]
buffer_load_dwordx4 v37, s[48:51], s85 offen offset:3072 lds
v_mfma_f32_16x16x32_bf16 v[136:139], v[108:111], a[240:243], v[136:139]
s_add_u32 m0, s87, 49152
s_add_u32 s85, s7, 0
v_mfma_f32_16x16x32_bf16 v[140:143], v[108:111], a[244:247], v[140:143]
v_mfma_f32_16x16x32_bf16 v[160:163], v[112:115], a[240:243], v[160:163]
buffer_load_dwordx4 v32, s[48:51], s85 offen lds
v_mfma_f32_16x16x32_bf16 v[164:167], v[112:115], a[244:247], v[164:167]
v_mfma_f32_16x16x32_bf16 v[168:171], v[116:119], a[240:243], v[168:171]
v_mfma_f32_16x16x32_bf16 v[172:175], v[116:119], a[244:247], v[172:175]
buffer_load_dwordx4 v33, s[48:51], s85 offen offset:1024 lds
v_mfma_f32_16x16x32_bf16 v[192:195], v[120:123], a[240:243], v[192:195]
v_mfma_f32_16x16x32_bf16 v[144:147], v[104:107], a[248:251], v[144:147]
v_mfma_f32_16x16x32_bf16 v[148:151], v[104:107], a[252:255], v[148:151]
v_mfma_f32_16x16x32_bf16 v[152:155], v[108:111], a[248:251], v[152:155]
buffer_load_dwordx4 v34, s[48:51], s85 offen offset:2048 lds
v_mfma_f32_16x16x32_bf16 v[156:159], v[108:111], a[252:255], v[156:159]
v_mfma_f32_16x16x32_bf16 v[176:179], v[112:115], a[248:251], v[176:179]
v_mfma_f32_16x16x32_bf16 v[180:183], v[112:115], a[252:255], v[180:183]
v_mfma_f32_16x16x32_bf16 v[184:187], v[116:119], a[248:251], v[184:187]
v_mfma_f32_16x16x32_bf16 v[188:191], v[116:119], a[252:255], v[188:191]
buffer_load_dwordx4 v35, s[48:51], s85 offen offset:3072 lds
v_mfma_f32_16x16x32_bf16 v[196:199], v[120:123], a[244:247], v[196:199]
s_lshl_b32 s90, s76, 1
s_add_u32 s90, s90, s95
s_lshl_b32 s90, s90, 11
s_add_u32 s90, s90, s94
s_lshl_b32 s91, s76, 10
s_add_u32 s84, s90, s91
s_xor_b32 s83, s84, 1024
s_lshl_b32 s90, s72, 1
s_add_u32 s90, s90, s75
s_lshl_b32 s91, s90, 1
s_add_u32 s91, s91, s76
s_lshl_b32 s91, s91, 7
s_add_u32 s82, s91, 8454144
s_add_u32 s100, s26, s16
s_addc_u32 s101, s27, 0
s_xor_b32 s91, s73, s75
s_and_b32 s91, s91, 1
s_cselect_b32 s71, 0, s70
v_lshrrev_b32 v68, 5, v1
v_or_b32 v68, s91, v68
v_lshlrev_b32_e64 v68, 30, v68
v_lshl_add_u32 v68, v1, 2, v68
v_cndmask_b32 v192, v192, v196, s[98:99]
buffer_store_dword v192, v68, s[52:55], s82 offen sc1
s_waitcnt lgkmcnt(0)
s_bfe_u32 s97, s68, 524288
s_cmp_lt_u32 s97, 4
s_cbranch_scc1 L_slow_KL2
L_back_KL2:
v_pk_mul_f32 v[80:81], v[128:129], v[128:129]
v_pk_mul_f32 v[82:83], v[130:131], v[130:131]
v_pk_mul_f32 v[84:85], v[132:133], v[132:133]
v_pk_mul_f32 v[86:87], v[134:135], v[134:135]
v_pk_fma_f32 v[80:81], v[80:81], v[48:49], v[48:49] op_sel:[0,0,1] op_sel_hi:[1,0,1]
v_pk_fma_f32 v[82:83], v[82:83], v[48:49], v[48:49] op_sel:[0,0,1] op_sel_hi:[1,0,1]
v_pk_fma_f32 v[84:85], v[84:85], v[48:49], v[48:49] op_sel:[0,0,1] op_sel_hi:[1,0,1]
v_pk_fma_f32 v[86:87], v[86:87], v[48:49], v[48:49] op_sel:[0,0,1] op_sel_hi:[1,0,1]
v_pk_mul_f32 v[80:81], v[80:81], v[128:129]
v_pk_mul_f32 v[82:83], v[82:83], v[130:131]
v_pk_mul_f32 v[84:85], v[84:85], v[132:133]
v_pk_mul_f32 v[86:87], v[86:87], v[134:135]
v_exp_f32_e64 v80, v80
s_add_u32 s86, s8, 0
buffer_load_dwordx4 a[96:99], v77, s[52:55], s86 offen offset:0 sc1
v_exp_f32_e64 v81, v81
v_pk_mul_f32 v[88:89], v[128:129], v[136:137]
v_exp_f32 v82, v82
v_exp_f32 v83, v83
v_pk_mul_f32 v[90:91], v[130:131], v[138:139]
v_exp_f32 v84, v84
v_exp_f32 v85, v85
v_pk_mul_f32 v[92:93], v[132:133], v[140:141]
v_exp_f32 v86, v86
v_exp_f32 v87, v87
buffer_load_dwordx4 a[100:103], v77, s[52:55], s86 offen offset:256 sc1
v_pk_mul_f32 v[94:95], v[134:135], v[142:143]
v_pk_add_f32 v[80:81], v[80:81], 1.0 op_sel_hi:[1,0]
v_pk_add_f32 v[82:83], v[82:83], 1.0 op_sel_hi:[1,0]
v_pk_add_f32 v[84:85], v[84:85], 1.0 op_sel_hi:[1,0]
v_pk_add_f32 v[86:87], v[86:87], 1.0 op_sel_hi:[1,0]
v_rcp_f32 v80, v80
v_rcp_f32 v81, v81
v_rcp_f32 v82, v82
v_rcp_f32 v83, v83
v_rcp_f32 v84, v84
v_rcp_f32 v85, v85
buffer_load_dwordx4 a[104:107], v77, s[52:55], s86 offen offset:1024 sc1
v_rcp_f32 v86, v86
v_rcp_f32 v87, v87
v_pk_mul_f32 v[88:89], v[88:89], v[80:81]
v_pk_mul_f32 v[90:91], v[90:91], v[82:83]
v_pk_mul_f32 v[92:93], v[92:93], v[84:85]
v_pk_mul_f32 v[94:95], v[94:95], v[86:87]
v_cvt_pk_bf16_f32 v128, v88, v89
v_cvt_pk_bf16_f32 v129, v90, v91
v_cvt_pk_bf16_f32 v130, v92, v93
v_cvt_pk_bf16_f32 v131, v94, v95
v_pk_mul_f32 v[80:81], v[144:145], v[144:145]
v_pk_mul_f32 v[82:83], v[146:147], v[146:147]
v_pk_mul_f32 v[84:85], v[148:149], v[148:149]
v_pk_mul_f32 v[86:87], v[150:151], v[150:151]
buffer_load_dwordx4 a[108:111], v77, s[52:55], s86 offen offset:1280 sc1
v_pk_fma_f32 v[80:81], v[80:81], v[48:49], v[48:49] op_sel:[0,0,1] op_sel_hi:[1,0,1]
v_pk_fma_f32 v[82:83], v[82:83], v[48:49], v[48:49] op_sel:[0,0,1] op_sel_hi:[1,0,1]
v_pk_fma_f32 v[84:85], v[84:85], v[48:49], v[48:49] op_sel:[0,0,1] op_sel_hi:[1,0,1]
v_pk_fma_f32 v[86:87], v[86:87], v[48:49], v[48:49] op_sel:[0,0,1] op_sel_hi:[1,0,1]
v_pk_mul_f32 v[80:81], v[80:81], v[144:145]
v_pk_mul_f32 v[82:83], v[82:83], v[146:147]
v_pk_mul_f32 v[84:85], v[84:85], v[148:149]
v_pk_mul_f32 v[86:87], v[86:87], v[150:151]
v_exp_f32 v80, v80
v_exp_f32 v81, v81
v_pk_mul_f32 v[88:89], v[144:145], v[152:153]
v_exp_f32 v82, v82
v_exp_f32 v83, v83
s_add_u32 s86, s8, 4096
buffer_load_dwordx4 a[112:115], v77, s[52:55], s86 offen offset:0 sc1
v_pk_mul_f32 v[90:91], v[146:147], v[154:155]
v_exp_f32 v84, v84
v_exp_f32 v85, v85
v_pk_mul_f32 v[92:93], v[148:149], v[156:157]
v_exp_f32 v86, v86
v_exp_f32 v87, v87
L_pad_KL_4:
s_cbranch_execz L_pad_KL_5
s_nop 0
v_pk_mul_f32 v[94:95], v[150:151], v[158:159]
v_pk_add_f32 v[80:81], v[80:81], 1.0 op_sel_hi:[1,0]
v_pk_add_f32 v[82:83], v[82:83], 1.0 op_sel_hi:[1,0]
v_pk_add_f32 v[84:85], v[84:85], 1.0 op_sel_hi:[1,0]
v_pk_add_f32 v[86:87], v[86:87], 1.0 op_sel_hi:[1,0]
v_rcp_f32_e64 v80, v80
buffer_load_dwordx4 a[116:119], v77, s[52:55], s86 offen offset:256 sc1
v_rcp_f32 v81, v81
v_rcp_f32 v82, v82
v_rcp_f32 v83, v83
v_rcp_f32 v84, v84
v_rcp_f32 v85, v85
v_rcp_f32 v86, v86
v_rcp_f32_e64 v87, v87
v_pk_mul_f32 v[88:89], v[88:89], v[80:81]
v_pk_mul_f32 v[90:91], v[90:91], v[82:83]
buffer_load_dwordx4 a[120:123], v77, s[52:55], s86 offen offset:1024 sc1
v_pk_mul_f32 v[92:93], v[92:93], v[84:85]
v_pk_mul_f32 v[94:95], v[94:95], v[86:87]
v_cvt_pk_bf16_f32 v144, v88, v89
v_cvt_pk_bf16_f32 v145, v90, v91
v_cvt_pk_bf16_f32 v146, v92, v93
v_cvt_pk_bf16_f32 v147, v94, v95
v_pk_mul_f32 v[80:81], v[160:161], v[160:161]
v_pk_mul_f32 v[82:83], v[162:163], v[162:163]
v_pk_mul_f32 v[84:85], v[164:165], v[164:165]
v_pk_mul_f32 v[86:87], v[166:167], v[166:167]
v_pk_fma_f32 v[80:81], v[80:81], v[48:49], v[48:49] op_sel:[0,0,1] op_sel_hi:[1,0,1]
v_pk_fma_f32 v[82:83], v[82:83], v[48:49], v[48:49] op_sel:[0,0,1] op_sel_hi:[1,0,1]
v_pk_fma_f32 v[84:85], v[84:85], v[48:49], v[48:49] op_sel:[0,0,1] op_sel_hi:[1,0,1]
v_pk_fma_f32 v[86:87], v[86:87], v[48:49], v[48:49] op_sel:[0,0,1] op_sel_hi:[1,0,1]
v_pk_mul_f32 v[80:81], v[80:81], v[160:161]
v_pk_mul_f32 v[82:83], v[82:83], v[162:163]
buffer_load_dwordx4 a[124:127], v77, s[52:55], s86 offen offset:1280 sc1
v_pk_mul_f32 v[84:85], v[84:85], v[164:165]
v_pk_mul_f32 v[86:87], v[86:87], v[166:167]
v_exp_f32 v80, v80
v_exp_f32 v81, v81
v_pk_mul_f32 v[88:89], v[160:161], v[168:169]
v_exp_f32 v82, v82
v_exp_f32 v83, v83
v_pk_mul_f32 v[90:91], v[162:163], v[170:171]
v_exp_f32 v84, v84
v_exp_f32 v85, v85
s_add_u32 s86, s8, 8192
buffer_load_dwordx4 a[128:131], v77, s[52:55], s86 offen offset:0 sc1
v_pk_mul_f32 v[92:93], v[164:165], v[172:173]
v_exp_f32 v86, v86
v_exp_f32 v87, v87
v_pk_mul_f32 v[94:95], v[166:167], v[174:175]
v_pk_add_f32 v[80:81], v[80:81], 1.0 op_sel_hi:[1,0]
v_pk_add_f32 v[82:83], v[82:83], 1.0 op_sel_hi:[1,0]
v_pk_add_f32 v[84:85], v[84:85], 1.0 op_sel_hi:[1,0]
v_pk_add_f32 v[86:87], v[86:87], 1.0 op_sel_hi:[1,0]
v_rcp_f32 v80, v80
v_rcp_f32 v81, v81
v_rcp_f32_e64 v82, v82
buffer_load_dwordx4 a[132:135], v77, s[52:55], s86 offen offset:256 sc1
v_rcp_f32 v83, v83
v_rcp_f32 v84, v84
v_rcp_f32 v85, v85
v_rcp_f32 v86, v86
v_rcp_f32_e64 v87, v87
v_pk_mul_f32 v[88:89], v[88:89], v[80:81]
v_pk_mul_f32 v[90:91], v[90:91], v[82:83]
v_pk_mul_f32 v[92:93], v[92:93], v[84:85]
v_pk_mul_f32 v[94:95], v[94:95], v[86:87]
v_cvt_pk_bf16_f32 v160, v88, v89
v_cvt_pk_bf16_f32 v161, v90, v91
buffer_load_dwordx4 a[136:139], v77, s[52:55], s86 offen offset:1024 sc1
v_cvt_pk_bf16_f32 v162, v92, v93
v_cvt_pk_bf16_f32 v163, v94, v95
s_waitcnt vmcnt(11)
s_atomic_add s71, s[100:101], 0
s_atomic_add s71, s[100:101], 256
s_atomic_add s71, s[100:101], 512
s_atomic_add s71, s[100:101], 768
v_pk_mul_f32 v[80:81], v[176:177], v[176:177]
v_pk_mul_f32 v[82:83], v[178:179], v[178:179]
v_pk_mul_f32 v[84:85], v[180:181], v[180:181]
v_pk_mul_f32 v[86:87], v[182:183], v[182:183]
v_pk_fma_f32 v[80:81], v[80:81], v[48:49], v[48:49] op_sel:[0,0,1] op_sel_hi:[1,0,1]
v_pk_fma_f32 v[82:83], v[82:83], v[48:49], v[48:49] op_sel:[0,0,1] op_sel_hi:[1,0,1]
v_pk_fma_f32 v[84:85], v[84:85], v[48:49], v[48:49] op_sel:[0,0,1] op_sel_hi:[1,0,1]
v_pk_fma_f32 v[86:87], v[86:87], v[48:49], v[48:49] op_sel:[0,0,1] op_sel_hi:[1,0,1]
v_pk_mul_f32 v[80:81], v[80:81], v[176:177]
buffer_load_dwordx4 a[140:143], v77, s[52:55], s86 offen offset:1280 sc1
v_pk_mul_f32 v[82:83], v[82:83], v[178:179]
v_pk_mul_f32 v[84:85], v[84:85], v[180:181]
v_pk_mul_f32 v[86:87], v[86:87], v[182:183]
v_exp_f32 v80, v80
v_exp_f32_e64 v81, v81
v_pk_mul_f32 v[88:89], v[176:177], v[184:185]
v_exp_f32 v82, v82
v_exp_f32 v83, v83
v_pk_mul_f32 v[90:91], v[178:179], v[186:187]
v_exp_f32_e64 v84, v84
v_exp_f32 v85, v85
s_add_u32 s86, s9, 0
buffer_load_dwordx4 a[144:147], v77, s[52:55], s86 offen offset:0 sc1
v_pk_mul_f32 v[92:93], v[180:181], v[188:189]
v_exp_f32 v86, v86
v_exp_f32 v87, v87
v_pk_mul_f32 v[94:95], v[182:183], v[190:191]
v_pk_add_f32 v[80:81], v[80:81], 1.0 op_sel_hi:[1,0]
v_pk_add_f32 v[82:83], v[82:83], 1.0 op_sel_hi:[1,0]
v_pk_add_f32 v[84:85], v[84:85], 1.0 op_sel_hi:[1,0]
v_pk_add_f32 v[86:87], v[86:87], 1.0 op_sel_hi:[1,0]
v_rcp_f32 v80, v80
v_rcp_f32 v81, v81
v_rcp_f32 v82, v82
v_rcp_f32 v83, v83
v_rcp_f32 v84, v84
v_rcp_f32 v85, v85
v_rcp_f32 v86, v86
v_rcp_f32 v87, v87
v_pk_mul_f32 v[88:89], v[88:89], v[80:81]
v_pk_mul_f32 v[90:91], v[90:91], v[82:83]
v_pk_mul_f32 v[92:93], v[92:93], v[84:85]
v_pk_mul_f32 v[94:95], v[94:95], v[86:87]
v_cvt_pk_bf16_f32 v176, v88, v89
v_cvt_pk_bf16_f32 v177, v90, v91
v_cvt_pk_bf16_f32 v178, v92, v93
v_cvt_pk_bf16_f32 v179, v94, v95
v_permlane16_swap_b32 v128, v130
v_permlane16_swap_b32 v129, v131
buffer_store_dwordx4 v[128:131], v38, s[52:55], s84 offen offset:0 sc1
v_permlane16_swap_b32 v144, v146
v_permlane16_swap_b32 v145, v147
buffer_store_dwordx4 v[144:147], v38, s[52:55], s83 offen offset:0 sc1
v_permlane16_swap_b32 v160, v162
v_permlane16_swap_b32 v161, v163
buffer_store_dwordx4 v[160:163], v38, s[52:55], s84 offen offset:2048 sc1
v_permlane16_swap_b32 v176, v178
v_permlane16_swap_b32 v177, v179
buffer_store_dwordx4 v[176:179], v38, s[52:55], s83 offen offset:2048 sc1
s_waitcnt vmcnt(16)
v_mfma_f32_16x16x32_bf16 v[128:131], a[64:67], a[96:99], 0
s_waitcnt vmcnt(15)
v_mfma_f32_16x16x32_bf16 v[144:147], a[64:67], a[100:103], 0
v_mfma_f32_16x16x32_bf16 v[132:135], a[68:71], a[96:99], 0
buffer_load_dwordx4 a[148:151], v77, s[52:55], s86 offen offset:256 sc1
v_mfma_f32_16x16x32_bf16 v[148:151], a[68:71], a[100:103], 0
v_mfma_f32_16x16x32_bf16 v[136:139], a[72:75], a[96:99], 0
v_mfma_f32_16x16x32_bf16 v[152:155], a[72:75], a[100:103], 0
v_mfma_f32_16x16x32_bf16 v[140:143], a[76:79], a[96:99], 0
buffer_load_dwordx4 a[152:155], v77, s[52:55], s86 offen offset:1024 sc1
v_mfma_f32_16x16x32_bf16 v[156:159], a[76:79], a[100:103], 0
v_and_b32 v72, 15, v1
v_lshrrev_b32 v73, 4, v1
v_xor_b32_e64 v73, v73, v1
v_and_b32 v73, 7, v73
s_waitcnt vmcnt(16)
v_mfma_f32_16x16x32_bf16 v[160:163], a[64:67], a[104:107], 0
s_waitcnt vmcnt(15)
v_mfma_f32_16x16x32_bf16 v[176:179], a[64:67], a[108:111], 0
v_mfma_f32_16x16x32_bf16 v[164:167], a[68:71], a[104:107], 0
buffer_load_dwordx4 a[156:159], v77, s[52:55], s86 offen offset:1280 sc1
v_mfma_f32_16x16x32_bf16 v[180:183], a[68:71], a[108:111], 0
s_add_u32 s86, s9, 4096
v_mfma_f32_16x16x32_bf16 v[168:171], a[72:75], a[104:107], 0
v_mfma_f32_16x16x32_bf16 v[184:187], a[72:75], a[108:111], 0
v_mfma_f32_16x16x32_bf16 v[172:175], a[76:79], a[104:107], 0
buffer_load_dwordx4 a[160:163], v77, s[52:55], s86 offen offset:0 sc1
v_mfma_f32_16x16x32_bf16 v[188:191], a[76:79], a[108:111], 0
v_lshlrev_b32 v73, 4, v73
v_lshl_add_u32 v72, v72, 8, v73
v_add_u32_e64 v112, s87, v72
v_xor_b32 v113, 64, v112
s_waitcnt vmcnt(16)
v_mfma_f32_16x16x32_bf16 v[128:131], a[80:83], a[112:115], v[128:131]
ds_read_b64_tr_b16 v[80:81], v41 offset:16384
s_waitcnt vmcnt(15)
v_mfma_f32_16x16x32_bf16 v[144:147], a[80:83], a[116:119], v[144:147]
ds_read_b64_tr_b16 v[82:83], v41 offset:17408
v_mfma_f32_16x16x32_bf16 v[132:135], a[84:87], a[112:115], v[132:135]
buffer_load_dwordx4 a[164:167], v77, s[52:55], s86 offen offset:256 sc1
v_mfma_f32_16x16x32_bf16 v[148:151], a[84:87], a[116:119], v[148:151]
ds_read_b64_tr_b16 v[84:85], v14 offset:16384
v_mfma_f32_16x16x32_bf16 v[136:139], a[88:91], a[112:115], v[136:139]
ds_read_b64_tr_b16 v[86:87], v14 offset:17408
v_mfma_f32_16x16x32_bf16 v[152:155], a[88:91], a[116:119], v[152:155]
v_mfma_f32_16x16x32_bf16 v[140:143], a[92:95], a[112:115], v[140:143]
buffer_load_dwordx4 a[168:171], v77, s[52:55], s86 offen offset:1024 sc1
v_mfma_f32_16x16x32_bf16 v[156:159], a[92:95], a[116:119], v[156:159]
v_lshlrev_b32 v75, 2, v1
v_lshrrev_b32 v72, 3, v0
v_and_b32 v73, 7, v0
v_lshlrev_b32 v74, 10, v72
s_waitcnt vmcnt(16)
v_mfma_f32_16x16x32_bf16 v[160:163], a[80:83], a[120:123], v[160:163]
ds_read_b64_tr_b16 v[88:89], v41 offset:16640
v_lshl_add_u32 v118, v73, 4, v74
s_waitcnt vmcnt(15)
v_mfma_f32_16x16x32_bf16 v[176:179], a[80:83], a[124:127], v[176:179]
ds_read_b64_tr_b16 v[90:91], v41 offset:17664
v_lshlrev_b32 v73, 1, v73
v_mfma_f32_16x16x32_bf16 v[164:167], a[84:87], a[120:123], v[164:167]
ds_read_b64_tr_b16 v[92:93], v14 offset:16640
v_and_b32_e64 v74, 7, v72
v_mfma_f32_16x16x32_bf16 v[180:183], a[84:87], a[124:127], v[180:183]
ds_read_b64_tr_b16 v[94:95], v14 offset:17664
v_xor_b32_e64 v73, v73, v74
v_mfma_f32_16x16x32_bf16 v[168:171], a[88:91], a[120:123], v[168:171]
v_mfma_f32_16x16x32_bf16 v[184:187], a[88:91], a[124:127], v[184:187]
v_mfma_f32_16x16x32_bf16 v[172:175], a[92:95], a[120:123], v[172:175]
v_mfma_f32_16x16x32_bf16 v[188:191], a[92:95], a[124:127], v[188:191]
s_waitcnt lgkmcnt(4)
s_waitcnt vmcnt(14)
v_mfma_f32_16x16x32_bf16 v[128:131], v[80:83], a[128:131], v[128:131]
ds_read_b64_tr_b16 v[96:97], v40 offset:0
s_waitcnt vmcnt(13)
v_mfma_f32_16x16x32_bf16 v[144:147], v[80:83], a[132:135], v[144:147]
ds_read_b64_tr_b16 v[98:99], v40 offset:1024
v_and_b32 v74, 15, v72
v_mfma_f32_16x16x32_bf16 v[132:135], v[84:87], a[128:131], v[132:135]
ds_read_b64_tr_b16 v[100:101], v13 offset:0
v_lshlrev_b32_e64 v74, 8, v74
v_mfma_f32_16x16x32_bf16 v[148:151], v[84:87], a[132:135], v[148:151]
ds_read_b64_tr_b16 v[102:103], v13 offset:1024
s_waitcnt lgkmcnt(4)
v_mfma_f32_16x16x32_bf16 v[136:139], v[88:91], a[128:131], v[136:139]
v_lshl_add_u32 v73, v73, 4, v74
v_lshrrev_b32 v72, 4, v72
v_mfma_f32_16x16x32_bf16 v[152:155], v[88:91], a[132:135], v[152:155]
v_mfma_f32_16x16x32_bf16 v[140:143], v[92:95], a[128:131], v[140:143]
v_mfma_f32_16x16x32_bf16 v[156:159], v[92:95], a[132:135], v[156:159]
s_waitcnt vmcnt(12)
v_mfma_f32_16x16x32_bf16 v[160:163], v[80:83], a[136:139], v[160:163]
ds_read_b64_tr_b16 v[104:105], v40 offset:256
v_lshl_add_u32 v116, v72, 14, v73
s_waitcnt vmcnt(11)
v_mfma_f32_16x16x32_bf16 v[176:179], v[80:83], a[140:143], v[176:179]
ds_read_b64_tr_b16 v[106:107], v40 offset:1280
v_xor_b32_e64 v117, 16, v116
v_mfma_f32_16x16x32_bf16 v[164:167], v[84:87], a[136:139], v[164:167]
ds_read_b64_tr_b16 v[108:109], v13 offset:256
s_lshl_b32 s90, s77, 16
v_mfma_f32_16x16x32_bf16 v[180:183], v[84:87], a[140:143], v[180:183]
ds_read_b64_tr_b16 v[110:111], v13 offset:1280
s_lshl_b32 s91, s78, 7
v_mfma_f32_16x16x32_bf16 v[168:171], v[88:91], a[136:139], v[168:171]
v_mfma_f32_16x16x32_bf16 v[184:187], v[88:91], a[140:143], v[184:187]
v_mfma_f32_16x16x32_bf16 v[172:175], v[92:95], a[136:139], v[172:175]
v_mfma_f32_16x16x32_bf16 v[188:191], v[92:95], a[140:143], v[188:191]
s_waitcnt lgkmcnt(4)
s_waitcnt vmcnt(10)
v_mfma_f32_16x16x32_bf16 v[128:131], v[96:99], a[144:147], v[128:131]
ds_read_b64_tr_b16 v[80:81], v40 offset:32768
s_waitcnt vmcnt(5)
v_mfma_f32_16x16x32_bf16 v[144:147], v[96:99], a[148:151], v[144:147]
ds_read_b64_tr_b16 v[82:83], v40 offset:33792
s_atomic_add s70, s[26:27], s17
v_mfma_f32_16x16x32_bf16 v[132:135], v[100:103], a[144:147], v[132:135]
buffer_load_dwordx4 a[172:175], v77, s[52:55], s86 offen offset:1280 sc1
v_mfma_f32_16x16x32_bf16 v[148:151], v[100:103], a[148:151], v[148:151]
ds_read_b64_tr_b16 v[84:85], v13 offset:32768
s_waitcnt lgkmcnt(3)
v_mfma_f32_16x16x32_bf16 v[136:139], v[104:107], a[144:147], v[136:139]
ds_read_b64_tr_b16 v[86:87], v13 offset:33792
s_add_u32 s86, s9, 8192
v_mfma_f32_16x16x32_bf16 v[152:155], v[104:107], a[148:151], v[152:155]
ds_read_b32 v47, v43
v_mfma_f32_16x16x32_bf16 v[140:143], v[108:111], a[144:147], v[140:143]
buffer_load_dwordx4 a[176:179], v77, s[52:55], s86 offen offset:0 sc1
v_mfma_f32_16x16x32_bf16 v[156:159], v[108:111], a[148:151], v[156:159]
s_add_u32 s90, s90, s91
s_add_u32 s91, s90, 32768
s_lshl_b32 s93, s77, 8
s_add_u32 s93, s93, 8454144
s_waitcnt vmcnt(6)
v_mfma_f32_16x16x32_bf16 v[160:163], v[96:99], a[152:155], v[160:163]
ds_read_b64_tr_b16 v[88:89], v40 offset:33024
s_waitcnt vmcnt(5)
v_mfma_f32_16x16x32_bf16 v[176:179], v[96:99], a[156:159], v[176:179]
ds_read_b64_tr_b16 v[90:91], v40 offset:34048
v_mfma_f32_16x16x32_bf16 v[164:167], v[100:103], a[152:155], v[164:167]
buffer_load_dwordx4 a[180:183], v77, s[52:55], s86 offen offset:256 sc1
v_mfma_f32_16x16x32_bf16 v[180:183], v[100:103], a[156:159], v[180:183]
ds_read_b64_tr_b16 v[92:93], v13 offset:33024
v_mfma_f32_16x16x32_bf16 v[168:171], v[104:107], a[152:155], v[168:171]
ds_read_b64_tr_b16 v[94:95], v13 offset:34048
v_mfma_f32_16x16x32_bf16 v[184:187], v[104:107], a[156:159], v[184:187]
ds_read_b32 v47, v43
v_mfma_f32_16x16x32_bf16 v[172:175], v[108:111], a[152:155], v[172:175]
buffer_load_dwordx4 a[184:187], v77, s[52:55], s86 offen offset:1024 sc1
v_mfma_f32_16x16x32_bf16 v[188:191], v[108:111], a[156:159], v[188:191]
s_waitcnt lgkmcnt(5)
s_waitcnt vmcnt(6)
v_mfma_f32_16x16x32_bf16 v[128:131], v[80:83], a[160:163], v[128:131]
ds_read_b64_tr_b16 v[96:97], v41 offset:0
s_waitcnt vmcnt(5)
v_mfma_f32_16x16x32_bf16 v[144:147], v[80:83], a[164:167], v[144:147]
ds_read_b64_tr_b16 v[98:99], v41 offset:1024
s_load_dword s68, s[26:27], s14 glc
v_mfma_f32_16x16x32_bf16 v[132:135], v[84:87], a[160:163], v[132:135]
buffer_load_dwordx4 a[188:191], v77, s[52:55], s86 offen offset:1280 sc1
v_mfma_f32_16x16x32_bf16 v[148:151], v[84:87], a[164:167], v[148:151]
ds_read_b64_tr_b16 v[100:101], v14 offset:0
s_waitcnt lgkmcnt(3)
v_mfma_f32_16x16x32_bf16 v[136:139], v[88:91], a[160:163], v[136:139]
ds_read_b64_tr_b16 v[102:103], v14 offset:1024
s_add_u32 m0, s87, 0
v_mfma_f32_16x16x32_bf16 v[152:155], v[88:91], a[164:167], v[152:155]
ds_read_b32 v47, v43
s_add_u32 s85, s7, 32768
v_mfma_f32_16x16x32_bf16 v[140:143], v[92:95], a[160:163], v[140:143]
buffer_load_dwordx4 v32, s[48:51], s85 offen lds
v_mfma_f32_16x16x32_bf16 v[156:159], v[92:95], a[164:167], v[156:159]
ds_read_b32 v47, v43
s_waitcnt vmcnt(6)
v_mfma_f32_16x16x32_bf16 v[160:163], v[80:83], a[168:171], v[160:163]
ds_read_b64_tr_b16 v[104:105], v41 offset:256
s_waitcnt vmcnt(5)
v_mfma_f32_16x16x32_bf16 v[176:179], v[80:83], a[172:175], v[176:179]
ds_read_b64_tr_b16 v[106:107], v41 offset:1280
v_mfma_f32_16x16x32_bf16 v[164:167], v[84:87], a[168:171], v[164:167]
buffer_load_dwordx4 v33, s[48:51], s85 offen offset:1024 lds
v_mfma_f32_16x16x32_bf16 v[180:183], v[84:87], a[172:175], v[180:183]
ds_read_b64_tr_b16 v[108:109], v14 offset:256
v_mfma_f32_16x16x32_bf16 v[168:171], v[88:91], a[168:171], v[168:171]
ds_read_b64_tr_b16 v[110:111], v14 offset:1280
v_mfma_f32_16x16x32_bf16 v[184:187], v[88:91], a[172:175], v[184:187]
ds_read_b32 v47, v43
v_mfma_f32_16x16x32_bf16 v[172:175], v[92:95], a[168:171], v[172:175]
buffer_load_dwordx4 v34, s[48:51], s85 offen offset:2048 lds
v_mfma_f32_16x16x32_bf16 v[188:191], v[92:95], a[172:175], v[188:191]
ds_read_b32 v47, v43
s_waitcnt lgkmcnt(6)
s_waitcnt vmcnt(6)
v_mfma_f32_16x16x32_bf16 v[128:131], v[96:99], a[176:179], v[128:131]
ds_read_b64_tr_b16 v[80:81], v42 offset:0
s_waitcnt vmcnt(5)
v_mfma_f32_16x16x32_bf16 v[144:147], v[96:99], a[180:183], v[144:147]
ds_read_b64_tr_b16 v[82:83], v42 offset:1024
v_mfma_f32_16x16x32_bf16 v[132:135], v[100:103], a[176:179], v[132:135]
ds_read_b64_tr_b16 v[84:85], v15 offset:0
v_mfma_f32_16x16x32_bf16 v[148:151], v[100:103], a[180:183], v[148:151]
ds_read_b64_tr_b16 v[86:87], v15 offset:1024
s_waitcnt lgkmcnt(4)
v_mfma_f32_16x16x32_bf16 v[136:139], v[104:107], a[176:179], v[136:139]
ds_read_b32 v47, v43
v_mfma_f32_16x16x32_bf16 v[152:155], v[104:107], a[180:183], v[152:155]
ds_read_b32 v47, v43
v_mfma_f32_16x16x32_bf16 v[140:143], v[108:111], a[176:179], v[140:143]
buffer_load_dwordx4 v35, s[48:51], s85 offen offset:3072 lds
v_mfma_f32_16x16x32_bf16 v[156:159], v[108:111], a[180:183], v[156:159]
s_waitcnt vmcnt(5)
v_mfma_f32_16x16x32_bf16 v[160:163], v[96:99], a[184:187], v[160:163]
ds_read_b64_tr_b16 v[88:89], v42 offset:256
s_waitcnt vmcnt(4)
v_mfma_f32_16x16x32_bf16 v[176:179], v[96:99], a[188:191], v[176:179]
ds_read_b64_tr_b16 v[90:91], v42 offset:1280
v_mfma_f32_16x16x32_bf16 v[164:167], v[100:103], a[184:187], v[164:167]
ds_read_b64_tr_b16 v[92:93], v15 offset:256
v_mfma_f32_16x16x32_bf16 v[180:183], v[100:103], a[188:191], v[180:183]
ds_read_b64_tr_b16 v[94:95], v15 offset:1280
v_mfma_f32_16x16x32_bf16 v[168:171], v[104:107], a[184:187], v[168:171]
ds_read_b32 v47, v43
v_mfma_f32_16x16x32_bf16 v[184:187], v[104:107], a[188:191], v[184:187]
ds_read_b32 v47, v43
v_mfma_f32_16x16x32_bf16 v[172:175], v[108:111], a[184:187], v[172:175]
v_mfma_f32_16x16x32_bf16 v[188:191], v[108:111], a[188:191], v[188:191]
s_waitcnt lgkmcnt(0)
s_bfe_u32 s97, s68, 524304
s_cmp_lt_u32 s97, 6
s_cbranch_scc1 L_slow_KL3
L_back_KL3:
buffer_load_dword v120, v75, s[52:55], s93 offen sc1
s_add_u32 s86, s10, 0
buffer_load_dwordx4 a[192:195], v77, s[52:55], s86 offen offset:0 sc1
buffer_load_dwordx4 a[196:199], v77, s[52:55], s86 offen offset:256 sc1
buffer_load_dwordx4 a[200:203], v77, s[52:55], s86 offen offset:1024 sc1
buffer_load_dwordx4 a[204:207], v77, s[52:55], s86 offen offset:1280 sc1
s_add_u32 s86, s10, 4096
buffer_load_dwordx4 a[208:211], v77, s[52:55], s86 offen offset:0 sc1
buffer_load_dwordx4 a[212:215], v77, s[52:55], s86 offen offset:256 sc1
buffer_load_dwordx4 a[216:219], v77, s[52:55], s86 offen offset:1024 sc1
s_waitcnt vmcnt(6)
v_mfma_f32_16x16x32_bf16 v[128:131], v[80:83], a[192:195], v[128:131]
ds_read_b64_tr_b16 v[96:97], v40 offset:16384
s_waitcnt vmcnt(5)
v_mfma_f32_16x16x32_bf16 v[144:147], v[80:83], a[196:199], v[144:147]
ds_read_b64_tr_b16 v[98:99], v40 offset:17408
v_mfma_f32_16x16x32_bf16 v[132:135], v[84:87], a[192:195], v[132:135]
buffer_load_dwordx4 a[220:223], v77, s[52:55], s86 offen offset:1280 sc1
v_mfma_f32_16x16x32_bf16 v[148:151], v[84:87], a[196:199], v[148:151]
ds_read_b64_tr_b16 v[100:101], v13 offset:16384
v_mfma_f32_16x16x32_bf16 v[136:139], v[88:91], a[192:195], v[136:139]
ds_read_b64_tr_b16 v[102:103], v13 offset:17408
s_add_u32 s86, s20, 8192
v_mfma_f32_16x16x32_bf16 v[152:155], v[88:91], a[196:199], v[152:155]
v_mfma_f32_16x16x32_bf16 v[140:143], v[92:95], a[192:195], v[140:143]
buffer_load_dwordx4 a[224:227], v39, s[52:55], s86 offen offset:0 sc1
v_mfma_f32_16x16x32_bf16 v[156:159], v[92:95], a[196:199], v[156:159]
s_waitcnt vmcnt(6)
v_mfma_f32_16x16x32_bf16 v[160:163], v[80:83], a[200:203], v[160:163]
ds_read_b64_tr_b16 v[104:105], v40 offset:16640
s_load_dword s68, s[26:27], s14 glc
s_waitcnt vmcnt(5)
v_mfma_f32_16x16x32_bf16 v[176:179], v[80:83], a[204:207], v[176:179]
ds_read_b64_tr_b16 v[106:107], v40 offset:17664
v_mfma_f32_16x16x32_bf16 v[164:167], v[84:87], a[200:203], v[164:167]
buffer_load_dwordx4 a[228:231], v39, s[52:55], s86 offen offset:256 sc1
v_mfma_f32_16x16x32_bf16 v[180:183], v[84:87], a[204:207], v[180:183]
ds_read_b64_tr_b16 v[108:109], v13 offset:16640
v_mfma_f32_16x16x32_bf16 v[168:171], v[88:91], a[200:203], v[168:171]
ds_read_b64_tr_b16 v[110:111], v13 offset:17664
v_mfma_f32_16x16x32_bf16 v[184:187], v[88:91], a[204:207], v[184:187]
ds_read_b32 v47, v43
v_mfma_f32_16x16x32_bf16 v[172:175], v[92:95], a[200:203], v[172:175]
buffer_load_dwordx4 a[232:235], v39, s[52:55], s86 offen offset:1024 sc1
v_mfma_f32_16x16x32_bf16 v[188:191], v[92:95], a[204:207], v[188:191]
s_waitcnt lgkmcnt(5)
s_waitcnt vmcnt(6)
v_mfma_f32_16x16x32_bf16 v[128:131], v[96:99], a[208:211], v[128:131]
ds_read_b64_tr_b16 v[80:81], v41 offset:32768
s_waitcnt vmcnt(5)
v_mfma_f32_16x16x32_bf16 v[144:147], v[96:99], a[212:215], v[144:147]
ds_read_b64_tr_b16 v[82:83], v41 offset:33792
v_mfma_f32_16x16x32_bf16 v[132:135], v[100:103], a[208:211], v[132:135]
buffer_load_dwordx4 a[236:239], v39, s[52:55], s86 offen offset:1280 sc1
v_mfma_f32_16x16x32_bf16 v[148:151], v[100:103], a[212:215], v[148:151]
ds_read_b64_tr_b16 v[84:85], v14 offset:32768
s_waitcnt lgkmcnt(3)
v_mfma_f32_16x16x32_bf16 v[136:139], v[104:107], a[208:211], v[136:139]
ds_read_b64_tr_b16 v[86:87], v14 offset:33792
s_add_u32 s86, s11, 0
v_mfma_f32_16x16x32_bf16 v[152:155], v[104:107], a[212:215], v[152:155]
ds_read_b32 v47, v43
v_mfma_f32_16x16x32_bf16 v[140:143], v[108:111], a[208:211], v[140:143]
buffer_load_dwordx4 a[240:243], v77, s[52:55], s86 offen offset:0 sc1
v_mfma_f32_16x16x32_bf16 v[156:159], v[108:111], a[212:215], v[156:159]
s_waitcnt vmcnt(6)
v_mfma_f32_16x16x32_bf16 v[160:163], v[96:99], a[216:219], v[160:163]
ds_read_b64_tr_b16 v[88:89], v41 offset:33024
s_waitcnt vmcnt(5)
v_mfma_f32_16x16x32_bf16 v[176:179], v[96:99], a[220:223], v[176:179]
ds_read_b64_tr_b16 v[90:91], v41 offset:34048
v_mfma_f32_16x16x32_bf16 v[164:167], v[100:103], a[216:219], v[164:167]
buffer_load_dwordx4 a[244:247], v77, s[52:55], s86 offen offset:256 sc1
v_mfma_f32_16x16x32_bf16 v[180:183], v[100:103], a[220:223], v[180:183]
ds_read_b64_tr_b16 v[92:93], v14 offset:33024
v_mfma_f32_16x16x32_bf16 v[168:171], v[104:107], a[216:219], v[168:171]
ds_read_b64_tr_b16 v[94:95], v14 offset:34048
v_mfma_f32_16x16x32_bf16 v[184:187], v[104:107], a[220:223], v[184:187]
ds_read_b32 v47, v43
v_mfma_f32_16x16x32_bf16 v[172:175], v[108:111], a[216:219], v[172:175]
buffer_load_dwordx4 a[248:251], v77, s[52:55], s86 offen offset:1024 sc1
v_mfma_f32_16x16x32_bf16 v[188:191], v[108:111], a[220:223], v[188:191]
s_waitcnt lgkmcnt(5)
s_waitcnt vmcnt(6)
v_mfma_f32_16x16x32_bf16 v[128:131], v[80:83], a[224:227], v[128:131]
ds_read_b64_tr_b16 v[96:97], v40 offset:49152
s_waitcnt vmcnt(5)
v_mfma_f32_16x16x32_bf16 v[144:147], v[80:83], a[228:231], v[144:147]
ds_read_b64_tr_b16 v[98:99], v40 offset:50176
v_mfma_f32_16x16x32_bf16 v[132:135], v[84:87], a[224:227], v[132:135]
buffer_load_dwordx4 a[252:255], v77, s[52:55], s86 offen offset:1280 sc1
v_mfma_f32_16x16x32_bf16 v[148:151], v[84:87], a[228:231], v[148:151]
ds_read_b64_tr_b16 v[100:101], v13 offset:49152
s_waitcnt lgkmcnt(3)
v_mfma_f32_16x16x32_bf16 v[136:139], v[88:91], a[224:227], v[136:139]
ds_read_b64_tr_b16 v[102:103], v13 offset:50176
s_add_u32 s86, s11, 4096
v_mfma_f32_16x16x32_bf16 v[152:155], v[88:91], a[228:231], v[152:155]
ds_read_b32 v47, v43
v_mfma_f32_16x16x32_bf16 v[140:143], v[92:95], a[224:227], v[140:143]
buffer_load_dwordx4 a[96:99], v77, s[52:55], s86 offen offset:0 sc1
v_mfma_f32_16x16x32_bf16 v[156:159], v[92:95], a[228:231], v[156:159]
s_waitcnt lgkmcnt(0)
s_bfe_u32 s97, s68, 524296
s_cmp_lt_u32 s97, 4
s_cbranch_scc1 L_slow_KL4
L_back_KL4:
buffer_load_dwordx4 a[100:103], v77, s[52:55], s86 offen offset:256 sc1
buffer_load_dwordx4 a[104:107], v77, s[52:55], s86 offen offset:1024 sc1
buffer_load_dwordx4 a[108:111], v77, s[52:55], s86 offen offset:1280 sc1
s_add_u32 s86, s12, 0
buffer_load_dwordx4 a[112:115], v77, s[52:55], s86 offen offset:0 sc1
buffer_load_dwordx4 a[116:119], v77, s[52:55], s86 offen offset:256 sc1
s_add_u32 s86, s12, 4096
buffer_load_dwordx4 a[128:131], v77, s[52:55], s86 offen offset:0 sc1
buffer_load_dwordx4 a[132:135], v77, s[52:55], s86 offen offset:256 sc1
s_add_u32 s86, s22, 0
buffer_load_dwordx4 a[144:147], v77, s[52:55], s86 offen offset:0 sc1
s_waitcnt vmcnt(14)
v_mfma_f32_16x16x32_bf16 v[160:163], v[80:83], a[232:235], v[160:163]
ds_read_b64_tr_b16 v[104:105], v40 offset:49408
s_waitcnt vmcnt(13)
v_mfma_f32_16x16x32_bf16 v[176:179], v[80:83], a[236:239], v[176:179]
ds_read_b64_tr_b16 v[106:107], v40 offset:50432
v_mfma_f32_16x16x32_bf16 v[164:167], v[84:87], a[232:235], v[164:167]
buffer_load_dwordx4 a[148:151], v77, s[52:55], s86 offen offset:256 sc1
v_mfma_f32_16x16x32_bf16 v[180:183], v[84:87], a[236:239], v[180:183]
ds_read_b64_tr_b16 v[108:109], v13 offset:49408
s_add_u32 s86, s22, 4096
v_mfma_f32_16x16x32_bf16 v[168:171], v[88:91], a[232:235], v[168:171]
ds_read_b64_tr_b16 v[110:111], v13 offset:50432
v_mfma_f32_16x16x32_bf16 v[184:187], v[88:91], a[236:239], v[184:187]
v_mfma_f32_16x16x32_bf16 v[172:175], v[92:95], a[232:235], v[172:175]
buffer_load_dwordx4 a[160:163], v77, s[52:55], s86 offen offset:0 sc1
v_mfma_f32_16x16x32_bf16 v[188:191], v[92:95], a[236:239], v[188:191]
s_waitcnt vmcnt(14)
v_mfma_f32_16x16x32_bf16 v[128:131], v[96:99], a[240:243], v[128:131]
ds_read_b64_tr_b16 v[80:81], v40 offset:0
s_waitcnt vmcnt(13)
v_mfma_f32_16x16x32_bf16 v[144:147], v[96:99], a[244:247], v[144:147]
ds_read_b64_tr_b16 v[82:83], v40 offset:1024
v_mfma_f32_16x16x32_bf16 v[132:135], v[100:103], a[240:243], v[132:135]
buffer_load_dwordx4 a[164:167], v77, s[52:55], s86 offen offset:256 sc1
v_mfma_f32_16x16x32_bf16 v[148:151], v[100:103], a[244:247], v[148:151]
ds_read_b64_tr_b16 v[84:85], v13 offset:0
s_waitcnt lgkmcnt(3)
v_mfma_f32_16x16x32_bf16 v[136:139], v[104:107], a[240:243], v[136:139]
ds_read_b64_tr_b16 v[86:87], v13 offset:1024
s_add_u32 s86, s12, 0
v_mfma_f32_16x16x32_bf16 v[152:155], v[104:107], a[244:247], v[152:155]
v_mfma_f32_16x16x32_bf16 v[140:143], v[108:111], a[240:243], v[140:143]
buffer_load_dwordx4 a[120:123], v77, s[52:55], s86 offen offset:1024 sc1
v_mfma_f32_16x16x32_bf16 v[156:159], v[108:111], a[244:247], v[156:159]
v_mul_f32 v120, -v120, v50
v_exp_f32 v120, v120
s_nop 0
v_add_f32 v120, 1.0, v120
v_rcp_f32 v120, v120
s_waitcnt vmcnt(14)
v_mfma_f32_16x16x32_bf16 v[160:163], v[96:99], a[248:251], v[160:163]
ds_read_b64_tr_b16 v[88:89], v40 offset:256
s_waitcnt vmcnt(13)
v_mfma_f32_16x16x32_bf16 v[176:179], v[96:99], a[252:255], v[176:179]
ds_read_b64_tr_b16 v[90:91], v40 offset:1280
v_mfma_f32_16x16x32_bf16 v[164:167], v[100:103], a[248:251], v[164:167]
buffer_load_dwordx4 a[124:127], v77, s[52:55], s86 offen offset:1280 sc1
v_mfma_f32_16x16x32_bf16 v[180:183], v[100:103], a[252:255], v[180:183]
ds_read_b64_tr_b16 v[92:93], v13 offset:256
s_add_u32 s86, s12, 4096
v_mfma_f32_16x16x32_bf16 v[168:171], v[104:107], a[248:251], v[168:171]
ds_read_b64_tr_b16 v[94:95], v13 offset:1280
v_mfma_f32_16x16x32_bf16 v[184:187], v[104:107], a[252:255], v[184:187]
v_mfma_f32_16x16x32_bf16 v[172:175], v[108:111], a[248:251], v[172:175]
buffer_load_dwordx4 a[136:139], v77, s[52:55], s86 offen offset:1024 sc1
v_mfma_f32_16x16x32_bf16 v[188:191], v[108:111], a[252:255], v[188:191]
v_mov_b32 v121, v120
s_nop 1
v_permlane16_swap_b32 v120, v121
v_mov_b32 v122, v120
v_mov_b32 v123, v121
s_waitcnt lgkmcnt(4)
s_waitcnt vmcnt(14)
v_mfma_f32_16x16x32_bf16 v[128:131], v[80:83], a[96:99], v[128:131]
buffer_load_dwordx4 a[140:143], v77, s[52:55], s86 offen offset:1280 sc1
s_waitcnt vmcnt(14)
v_mfma_f32_16x16x32_bf16 v[144:147], v[80:83], a[100:103], v[144:147]
s_add_u32 s86, s22, 0
v_mfma_f32_16x16x32_bf16 v[132:135], v[84:87], a[96:99], v[132:135]
buffer_load_dwordx4 a[152:155], v77, s[52:55], s86 offen offset:1024 sc1
v_mfma_f32_16x16x32_bf16 v[148:151], v[84:87], a[100:103], v[148:151]
s_waitcnt lgkmcnt(0)
v_mfma_f32_16x16x32_bf16 v[136:139], v[88:91], a[96:99], v[136:139]
buffer_load_dwordx4 a[156:159], v77, s[52:55], s86 offen offset:1280 sc1
v_mfma_f32_16x16x32_bf16 v[152:155], v[88:91], a[100:103], v[152:155]
s_add_u32 s86, s22, 4096
v_mfma_f32_16x16x32_bf16 v[140:143], v[92:95], a[96:99], v[140:143]
buffer_load_dwordx4 a[168:171], v77, s[52:55], s86 offen offset:1024 sc1
v_mfma_f32_16x16x32_bf16 v[156:159], v[92:95], a[100:103], v[156:159]
v_permlane32_swap_b32 v120, v122
v_permlane32_swap_b32 v121, v123
v_sub_f32 v124, 1.0, v120
v_sub_f32 v125, 1.0, v121
s_waitcnt vmcnt(16)
v_mfma_f32_16x16x32_bf16 v[160:163], v[80:83], a[104:107], v[160:163]
s_waitcnt vmcnt(15)
v_mfma_f32_16x16x32_bf16 v[176:179], v[80:83], a[108:111], v[176:179]
v_mfma_f32_16x16x32_bf16 v[164:167], v[84:87], a[104:107], v[164:167]
v_mfma_f32_16x16x32_bf16 v[180:183], v[84:87], a[108:111], v[180:183]
v_mfma_f32_16x16x32_bf16 v[168:171], v[88:91], a[104:107], v[168:171]
v_mfma_f32_16x16x32_bf16 v[184:187], v[88:91], a[108:111], v[184:187]
v_mfma_f32_16x16x32_bf16 v[172:175], v[92:95], a[104:107], v[172:175]
buffer_load_dwordx4 a[172:175], v77, s[52:55], s86 offen offset:1280 sc1
v_mfma_f32_16x16x32_bf16 v[188:191], v[92:95], a[108:111], v[188:191]
v_sub_f32 v126, 1.0, v122
v_sub_f32 v127, 1.0, v123
s_waitcnt vmcnt(15)
v_mfma_f32_16x16x32_bf16 v[192:195], a[0:3], a[112:115], 0
v_mul_f32 v128, v128, v124
v_mul_f32 v129, v129, v124
v_mfma_f32_16x16x32_bf16 v[196:199], a[4:7], a[112:115], 0
L_pad_KL_5:
s_cbranch_execz L_padslow_KL
s_nop 0
v_mul_f32 v130, v130, v124
v_mul_f32 v131, v131, v124
v_mfma_f32_16x16x32_bf16 v[200:203], a[8:11], a[112:115], 0
v_mul_f32 v132, v132, v124
v_mul_f32 v133, v133, v124
v_mfma_f32_16x16x32_bf16 v[204:207], a[12:15], a[112:115], 0
v_mul_f32_e64 v134, v134, v124
v_mul_f32 v135, v135, v124
s_waitcnt vmcnt(14)
v_mfma_f32_16x16x32_bf16 v[208:211], a[0:3], a[116:119], 0
v_mul_f32 v136, v136, v124
v_mul_f32 v137, v137, v124
v_mfma_f32_16x16x32_bf16 v[212:215], a[4:7], a[116:119], 0
v_mul_f32 v138, v138, v124
v_mul_f32 v139, v139, v124
v_mfma_f32_16x16x32_bf16 v[216:219], a[8:11], a[116:119], 0
v_mul_f32_e64 v140, v140, v124
v_mfma_f32_16x16x32_bf16 v[220:223], a[12:15], a[116:119], 0
s_waitcnt vmcnt(13)
v_mfma_f32_16x16x32_bf16 v[192:195], a[16:19], a[128:131], v[192:195]
v_mul_f32 v141, v141, v124
v_mul_f32_e64 v142, v142, v124
v_mfma_f32_16x16x32_bf16 v[196:199], a[20:23], a[128:131], v[196:199]
v_mul_f32 v143, v143, v124
v_mul_f32 v144, v144, v125
v_mfma_f32_16x16x32_bf16 v[200:203], a[24:27], a[128:131], v[200:203]
v_mul_f32 v145, v145, v125
v_mul_f32 v146, v146, v125
v_mfma_f32_16x16x32_bf16 v[204:207], a[28:31], a[128:131], v[204:207]
v_mul_f32_e64 v147, v147, v125
v_mul_f32 v148, v148, v125
s_waitcnt vmcnt(12)
v_mfma_f32_16x16x32_bf16 v[208:211], a[16:19], a[132:135], v[208:211]
v_mul_f32 v149, v149, v125
v_mul_f32 v150, v150, v125
v_mfma_f32_16x16x32_bf16 v[212:215], a[20:23], a[132:135], v[212:215]
v_mul_f32 v151, v151, v125
v_mul_f32 v152, v152, v125
v_mfma_f32_16x16x32_bf16 v[216:219], a[24:27], a[132:135], v[216:219]
v_mul_f32_e64 v153, v153, v125
v_mfma_f32_16x16x32_bf16 v[220:223], a[28:31], a[132:135], v[220:223]
s_waitcnt vmcnt(11)
v_mfma_f32_16x16x32_bf16 v[192:195], a[32:35], a[144:147], v[192:195]
v_mul_f32 v154, v154, v125
v_mul_f32_e64 v155, v155, v125
v_mfma_f32_16x16x32_bf16 v[196:199], a[36:39], a[144:147], v[196:199]
v_mul_f32 v156, v156, v125
v_mul_f32 v157, v157, v125
v_mfma_f32_16x16x32_bf16 v[200:203], a[40:43], a[144:147], v[200:203]
v_mul_f32 v158, v158, v125
v_mul_f32 v159, v159, v125
v_mfma_f32_16x16x32_bf16 v[204:207], a[44:47], a[144:147], v[204:207]
v_mul_f32_e64 v160, v160, v126
v_mul_f32 v161, v161, v126
s_waitcnt vmcnt(10)
v_mfma_f32_16x16x32_bf16 v[208:211], a[32:35], a[148:151], v[208:211]
v_mul_f32 v162, v162, v126
v_mul_f32 v163, v163, v126
v_mfma_f32_16x16x32_bf16 v[212:215], a[36:39], a[148:151], v[212:215]
v_mul_f32 v164, v164, v126
v_mul_f32 v165, v165, v126
v_mfma_f32_16x16x32_bf16 v[216:219], a[40:43], a[148:151], v[216:219]
v_mul_f32_e64 v166, v166, v126
v_mfma_f32_16x16x32_bf16 v[220:223], a[44:47], a[148:151], v[220:223]
s_waitcnt vmcnt(9)
v_mfma_f32_16x16x32_bf16 v[192:195], a[48:51], a[160:163], v[192:195]
v_mul_f32 v167, v167, v126
v_mul_f32_e64 v168, v168, v126
v_mfma_f32_16x16x32_bf16 v[196:199], a[52:55], a[160:163], v[196:199]
v_mul_f32 v169, v169, v126
v_mul_f32 v170, v170, v126
v_mfma_f32_16x16x32_bf16 v[200:203], a[56:59], a[160:163], v[200:203]
v_mul_f32 v171, v171, v126
v_mul_f32 v172, v172, v126
v_mfma_f32_16x16x32_bf16 v[204:207], a[60:63], a[160:163], v[204:207]
v_mul_f32_e64 v173, v173, v126
v_mul_f32 v174, v174, v126
s_waitcnt vmcnt(8)
v_mfma_f32_16x16x32_bf16 v[208:211], a[48:51], a[164:167], v[208:211]
v_mul_f32 v175, v175, v126
v_mul_f32 v176, v176, v127
v_mfma_f32_16x16x32_bf16 v[212:215], a[52:55], a[164:167], v[212:215]
v_mul_f32 v177, v177, v127
v_mul_f32 v178, v178, v127
v_mfma_f32_16x16x32_bf16 v[216:219], a[56:59], a[164:167], v[216:219]
v_mul_f32_e64 v179, v179, v127
v_mfma_f32_16x16x32_bf16 v[220:223], a[60:63], a[164:167], v[220:223]
s_waitcnt vmcnt(7)
v_mfma_f32_16x16x32_bf16 v[224:227], a[0:3], a[120:123], 0
v_mul_f32 v180, v180, v127
v_mul_f32_e64 v181, v181, v127
v_mfma_f32_16x16x32_bf16 v[228:231], a[4:7], a[120:123], 0
v_mul_f32 v182, v182, v127
v_mul_f32 v183, v183, v127
v_mfma_f32_16x16x32_bf16 v[232:235], a[8:11], a[120:123], 0
v_mul_f32 v184, v184, v127
v_mul_f32 v185, v185, v127
v_mfma_f32_16x16x32_bf16 v[236:239], a[12:15], a[120:123], 0
v_mul_f32_e64 v186, v186, v127
v_mul_f32 v187, v187, v127
s_waitcnt vmcnt(6)
v_mfma_f32_16x16x32_bf16 v[240:243], a[0:3], a[124:127], 0
v_mul_f32 v188, v188, v127
v_mul_f32 v189, v189, v127
v_mfma_f32_16x16x32_bf16 v[244:247], a[4:7], a[124:127], 0
v_mul_f32 v190, v190, v127
v_mul_f32 v191, v191, v127
v_mfma_f32_16x16x32_bf16 v[248:251], a[8:11], a[124:127], 0
v_mfma_f32_16x16x32_bf16 v[252:255], a[12:15], a[124:127], 0
s_waitcnt vmcnt(5)
v_mfma_f32_16x16x32_bf16 v[224:227], a[16:19], a[136:139], v[224:227]
v_fmac_f32 v128, v192, v120
v_fmac_f32_e64 v129, v193, v120
v_mfma_f32_16x16x32_bf16 v[228:231], a[20:23], a[136:139], v[228:231]
v_fmac_f32 v130, v194, v120
v_fmac_f32 v131, v195, v120
v_mfma_f32_16x16x32_bf16 v[232:235], a[24:27], a[136:139], v[232:235]
ds_write_b128 v112, v[128:131] offset:0
v_fmac_f32_e64 v132, v196, v120
v_mfma_f32_16x16x32_bf16 v[236:239], a[28:31], a[136:139], v[236:239]
v_fmac_f32_e64 v133, v197, v120
v_fmac_f32 v134, v198, v120
s_waitcnt vmcnt(4)
v_mfma_f32_16x16x32_bf16 v[240:243], a[16:19], a[140:143], v[240:243]
v_fmac_f32_e64 v135, v199, v120
v_mfma_f32_16x16x32_bf16 v[244:247], a[20:23], a[140:143], v[244:247]
ds_write_b128 v113, v[132:135] offset:0
v_fmac_f32_e64 v136, v200, v120
v_mfma_f32_16x16x32_bf16 v[248:251], a[24:27], a[140:143], v[248:251]
v_fmac_f32 v137, v201, v120
v_fmac_f32 v138, v202, v120
v_mfma_f32_16x16x32_bf16 v[252:255], a[28:31], a[140:143], v[252:255]
v_fmac_f32_e64 v139, v203, v120
ds_write_b128 v112, v[136:139] offset:128
s_waitcnt vmcnt(3)
v_mfma_f32_16x16x32_bf16 v[224:227], a[32:35], a[152:155], v[224:227]
v_fmac_f32 v140, v204, v120
v_fmac_f32_e64 v141, v205, v120
v_mfma_f32_16x16x32_bf16 v[228:231], a[36:39], a[152:155], v[228:231]
v_fmac_f32 v142, v206, v120
v_fmac_f32 v143, v207, v120
v_mfma_f32_16x16x32_bf16 v[232:235], a[40:43], a[152:155], v[232:235]
ds_write_b128 v113, v[140:143] offset:128
v_fmac_f32_e64 v144, v208, v121
v_mfma_f32_16x16x32_bf16 v[236:239], a[44:47], a[152:155], v[236:239]
v_fmac_f32_e64 v145, v209, v121
v_fmac_f32 v146, v210, v121
s_waitcnt vmcnt(2)
v_mfma_f32_16x16x32_bf16 v[240:243], a[32:35], a[156:159], v[240:243]
v_fmac_f32_e64 v147, v211, v121
v_mfma_f32_16x16x32_bf16 v[244:247], a[36:39], a[156:159], v[244:247]
ds_write_b128 v112, v[144:147] offset:16384
v_fmac_f32_e64 v148, v212, v121
v_mfma_f32_16x16x32_bf16 v[248:251], a[40:43], a[156:159], v[248:251]
v_fmac_f32 v149, v213, v121
v_fmac_f32 v150, v214, v121
v_mfma_f32_16x16x32_bf16 v[252:255], a[44:47], a[156:159], v[252:255]
v_fmac_f32_e64 v151, v215, v121
ds_write_b128 v113, v[148:151] offset:16384
s_waitcnt vmcnt(1)
v_mfma_f32_16x16x32_bf16 v[224:227], a[48:51], a[168:171], v[224:227]
v_fmac_f32 v152, v216, v121
v_fmac_f32_e64 v153, v217, v121
v_mfma_f32_16x16x32_bf16 v[228:231], a[52:55], a[168:171], v[228:231]
v_fmac_f32 v154, v218, v121
v_fmac_f32 v155, v219, v121
v_mfma_f32_16x16x32_bf16 v[232:235], a[56:59], a[168:171], v[232:235]
ds_write_b128 v112, v[152:155] offset:16512
v_fmac_f32_e64 v156, v220, v121
v_mfma_f32_16x16x32_bf16 v[236:239], a[60:63], a[168:171], v[236:239]
v_fmac_f32_e64 v157, v221, v121
v_fmac_f32 v158, v222, v121
s_waitcnt vmcnt(0)
v_mfma_f32_16x16x32_bf16 v[240:243], a[48:51], a[172:175], v[240:243]
v_fmac_f32_e64 v159, v223, v121
v_mfma_f32_16x16x32_bf16 v[244:247], a[52:55], a[172:175], v[244:247]
ds_write_b128 v113, v[156:159] offset:16512
v_mfma_f32_16x16x32_bf16 v[248:251], a[56:59], a[172:175], v[248:251]
v_mfma_f32_16x16x32_bf16 v[252:255], a[60:63], a[172:175], v[252:255]
v_pk_fma_f32 v[160:161], v[224:225], v[122:123], v[160:161] op_sel_hi:[1,0,1]
v_pk_fma_f32 v[162:163], v[226:227], v[122:123], v[162:163] op_sel_hi:[1,0,1]
ds_write_b128 v112, v[160:163] offset:32768
v_pk_fma_f32 v[164:165], v[228:229], v[122:123], v[164:165] op_sel_hi:[1,0,1]
v_pk_fma_f32 v[166:167], v[230:231], v[122:123], v[166:167] op_sel_hi:[1,0,1]
ds_write_b128 v113, v[164:167] offset:32768
v_pk_fma_f32 v[168:169], v[232:233], v[122:123], v[168:169] op_sel_hi:[1,0,1]
v_pk_fma_f32 v[170:171], v[234:235], v[122:123], v[170:171] op_sel_hi:[1,0,1]
ds_write_b128 v112, v[168:171] offset:32896
v_pk_fma_f32 v[172:173], v[236:237], v[122:123], v[172:173] op_sel_hi:[1,0,1]
v_pk_fma_f32 v[174:175], v[238:239], v[122:123], v[174:175] op_sel_hi:[1,0,1]
ds_write_b128 v113, v[172:175] offset:32896
v_pk_fma_f32 v[176:177], v[240:241], v[122:123], v[176:177] op_sel:[0,1,0] op_sel_hi:[1,1,1]
v_pk_fma_f32 v[178:179], v[242:243], v[122:123], v[178:179] op_sel:[0,1,0] op_sel_hi:[1,1,1]
ds_write_b128 v112, v[176:179] offset:49152
v_pk_fma_f32 v[180:181], v[244:245], v[122:123], v[180:181] op_sel:[0,1,0] op_sel_hi:[1,1,1]
v_pk_fma_f32 v[182:183], v[246:247], v[122:123], v[182:183] op_sel:[0,1,0] op_sel_hi:[1,1,1]
ds_write_b128 v113, v[180:183] offset:49152
v_pk_fma_f32 v[184:185], v[248:249], v[122:123], v[184:185] op_sel:[0,1,0] op_sel_hi:[1,1,1]
v_pk_fma_f32 v[186:187], v[250:251], v[122:123], v[186:187] op_sel:[0,1,0] op_sel_hi:[1,1,1]
ds_write_b128 v112, v[184:187] offset:49280
v_pk_fma_f32 v[188:189], v[252:253], v[122:123], v[188:189] op_sel:[0,1,0] op_sel_hi:[1,1,1]
v_pk_fma_f32 v[190:191], v[254:255], v[122:123], v[190:191] op_sel:[0,1,0] op_sel_hi:[1,1,1]
ds_write_b128 v113, v[188:191] offset:49280
s_waitcnt lgkmcnt(0)
s_barrier
ds_read_b128 v[192:195], v116 offset:0
ds_read_b128 v[196:199], v117 offset:0
ds_read_b128 v[200:203], v116 offset:4096
ds_read_b128 v[204:207], v117 offset:4096
ds_read_b128 v[208:211], v116 offset:8192
ds_read_b128 v[212:215], v117 offset:8192
ds_read_b128 v[216:219], v116 offset:12288
ds_read_b128 v[220:223], v117 offset:12288
ds_read_b128 v[128:131], v116 offset:32768
ds_read_b128 v[132:135], v117 offset:32768
ds_read_b128 v[136:139], v116 offset:36864
ds_read_b128 v[140:143], v117 offset:36864
ds_read_b128 v[144:147], v116 offset:40960
ds_read_b128 v[148:151], v117 offset:40960
ds_read_b128 v[152:155], v116 offset:45056
ds_read_b128 v[156:159], v117 offset:45056
s_waitcnt lgkmcnt(13)
v_pk_add_f32 v[192:193], v[192:193], v[200:201]
v_pk_add_f32 v[194:195], v[194:195], v[202:203]
s_waitcnt lgkmcnt(12)
v_pk_add_f32 v[196:197], v[196:197], v[204:205]
v_pk_add_f32 v[198:199], v[198:199], v[206:207]
s_waitcnt lgkmcnt(9)
v_pk_add_f32 v[208:209], v[208:209], v[216:217]
v_pk_add_f32 v[210:211], v[210:211], v[218:219]
s_waitcnt lgkmcnt(8)
v_pk_add_f32 v[212:213], v[212:213], v[220:221]
v_pk_add_f32 v[214:215], v[214:215], v[222:223]
v_pk_add_f32 v[192:193], v[192:193], v[208:209]
v_pk_add_f32 v[194:195], v[194:195], v[210:211]
v_pk_add_f32 v[196:197], v[196:197], v[212:213]
v_pk_add_f32 v[198:199], v[198:199], v[214:215]
v_cvt_pk_bf16_f32 v200, v192, v193
v_cvt_pk_bf16_f32 v201, v194, v195
v_cvt_pk_bf16_f32 v202, v196, v197
v_cvt_pk_bf16_f32 v203, v198, v199
buffer_store_dwordx4 v[200:203], v118, s[56:59], s90 offen
s_waitcnt lgkmcnt(5)
v_pk_add_f32 v[128:129], v[128:129], v[136:137]
v_pk_add_f32 v[130:131], v[130:131], v[138:139]
s_waitcnt lgkmcnt(4)
v_pk_add_f32 v[132:133], v[132:133], v[140:141]
v_pk_add_f32 v[134:135], v[134:135], v[142:143]
s_waitcnt lgkmcnt(1)
v_pk_add_f32 v[144:145], v[144:145], v[152:153]
v_pk_add_f32 v[146:147], v[146:147], v[154:155]
s_waitcnt lgkmcnt(0)
v_pk_add_f32 v[148:149], v[148:149], v[156:157]
v_pk_add_f32 v[150:151], v[150:151], v[158:159]
v_pk_add_f32 v[128:129], v[128:129], v[144:145]
v_pk_add_f32 v[130:131], v[130:131], v[146:147]
v_pk_add_f32 v[132:133], v[132:133], v[148:149]
v_pk_add_f32 v[134:135], v[134:135], v[150:151]
v_cvt_pk_bf16_f32 v136, v128, v129
v_cvt_pk_bf16_f32 v137, v130, v131
v_cvt_pk_bf16_f32 v138, v132, v133
v_cvt_pk_bf16_f32 v139, v134, v135
buffer_store_dwordx4 v[136:139], v118, s[56:59], s91 offen
s_endpgm
L_padslow_KL:
s_branch L_warm_KL
L_slow_KL0:
s_mov_b32 s96, 0
L_spin_KL0:
s_add_u32 s96, s96, 1
v_mov_b32 v47, 0
global_load_dword v47, v47, s[24:25] sc1
s_waitcnt vmcnt(0)
v_readfirstlane_b32 s68, v47
s_nop 3
s_bfe_u32 s97, s68, 524288
s_cmp_lt_u32 s97, 16
s_cbranch_scc0 L_back_KL0
s_cmp_ge_u32 s96, 0x8000
s_cbranch_scc1 L_back_KL0
s_sleep 16
s_branch L_spin_KL0
L_slow_KL1:
s_mov_b32 s96, 0
L_spin_KL1:
s_add_u32 s96, s96, 1
s_load_dword s68, s[26:27], s64 glc
s_waitcnt lgkmcnt(0)
s_bfe_u32 s97, s68, 524288
s_cmp_lt_u32 s97, 16
s_cbranch_scc0 L_back_KL1
s_cmp_ge_u32 s96, 0x8000
s_cbranch_scc1 L_back_KL1
s_sleep 3
s_branch L_spin_KL1
L_slow_KL2:
s_mov_b32 s96, 0
L_spin_KL2:
s_add_u32 s96, s96, 1
s_load_dword s68, s[26:27], s14 glc
s_waitcnt lgkmcnt(0)
s_bfe_u32 s97, s68, 524288
s_cmp_lt_u32 s97, 4
s_cbranch_scc0 L_back_KL2
s_cmp_ge_u32 s96, 0x8000
s_cbranch_scc1 L_back_KL2
s_sleep 3
s_branch L_spin_KL2
L_slow_KL3:
s_mov_b32 s96, 0
L_spin_KL3:
s_add_u32 s96, s96, 1
s_load_dword s68, s[26:27], s14 glc
s_waitcnt lgkmcnt(0)
s_bfe_u32 s97, s68, 524304
s_cmp_lt_u32 s97, 6
s_cbranch_scc0 L_back_KL3
s_cmp_ge_u32 s96, 0x8000
s_cbranch_scc1 L_back_KL3
s_sleep 1
s_branch L_spin_KL3
L_slow_KL4:
s_mov_b32 s96, 0
L_spin_KL4:
s_add_u32 s96, s96, 1
s_load_dword s68, s[26:27], s14 glc
s_waitcnt lgkmcnt(0)
s_bfe_u32 s97, s68, 524296
s_cmp_lt_u32 s97, 4
s_cbranch_scc0 L_back_KL4
s_cmp_ge_u32 s96, 0x8000
s_cbranch_scc1 L_back_KL4
s_sleep 1
s_branch L_spin_KL4
.p2align 12
L_Q:
s_waitcnt lgkmcnt(0)
s_mov_b64 s[28:29], s[4:5]
s_mov_b64 s[32:33], s[6:7]
s_and_b32 s75, s74, 1
s_lshr_b32 s76, s74, 1
v_lshlrev_b32 v38, 4, v1
s_bfe_u32 s77, s2, 0x20001
s_bitcmp1_b32 s2, 0
s_cselect_b32 s90, 0, 4
s_add_u32 s77, s77, s90
s_lshl_b32 s77, s77, 2
s_and_b32 s90, s78, 1
s_xor_b32 s90, s90, s92
s_add_u32 s77, s77, s90
s_mov_b64 s[52:53], s[26:27]
s_mov_b32 s54, 9109504
s_mov_b32 s55, 0x20000
s_add_u32 s26, s52, 8519680
s_addc_u32 s27, s53, 0
s_cmp_ge_u32 s2, 68
s_cbranch_scc1 L_nz
s_and_b32 s90, s2, 3
s_lshl_b32 s90, s90, 2
s_add_u32 s90, s90, s74
s_mul_i32 s90, s90, 2560
s_add_u32 s100, s26, s90
s_addc_u32 s101, s27, 0
s_mov_b32 s71, 0
s_atomic_swap s71, s[100:101], 0
s_atomic_swap s71, s[100:101], 256
s_atomic_swap s71, s[100:101], 512
s_atomic_swap s71, s[100:101], 768
s_atomic_swap s71, s[100:101], 1024
s_atomic_swap s71, s[100:101], 1280
s_atomic_swap s71, s[100:101], 1536
s_atomic_swap s71, s[100:101], 1792
s_atomic_swap s71, s[100:101], 2048
s_atomic_swap s71, s[100:101], 2304
L_nz:
s_lshr_b32 s95, s73, 1
s_mul_i32 s95, s95, 22
s_and_b32 s90, s73, 1
s_mul_i32 s90, s90, 6
s_add_u32 s95, s95, s90
s_cmp_ge_u32 s73, 6
s_cselect_b32 s90, 8, 10
s_add_u32 s95, s95, s90
s_lshl_b32 s82, s95, 5
s_mul_i32 s89, s74, 6144
s_lshl_b32 s88, s74, 11
v_bfe_u32 v68, v1, 2, 2
v_and_b32 v69, 3, v1
v_lshlrev_b32 v69, 4, v69
v_lshrrev_b32 v70, 4, v1
s_lshl_b32 s90, s74, 4
v_add_u32_e64 v73, s90, v68
v_mul_u32_u24 v73, 2752, v73
v_lshl_add_u32 v74, v70, 6, v69
s_movk_i32 s90, 10816
v_add3_u32 v73, v73, v74, s82
v_add_u32 v71, 1, v70
v_lshrrev_b32_e64 v71, 2, v71
v_mad_u32_u24 v10, v71, s90, v73
v_add_u32 v71, 2, v70
v_lshrrev_b32 v71, 2, v71
v_mad_u32_u24 v11, v71, s90, v73
v_add_u32 v11, 10048, v11
v_add_u32 v71, 3, v70
v_lshrrev_b32 v71, 2, v71
v_mad_u32_u24 v12, v71, s90, v73
v_add_u32 v12, 20096, v12
v_and_b32 v71, 32, v1
v_xor_b32 v11, v71, v11
v_xor_b32 v12, 32, v12
v_lshrrev_b32 v71, 5, v1
v_lshl_add_u32 v71, v71, 2, v68
s_lshl_b32 s90, s74, 4
v_add_u32 v71, s90, v71
v_mul_u32_u24 v71, 3072, v71
v_and_b32_e64 v72, 1, v70
v_lshl_add_u32 v72, v72, 6, v69
v_add3_u32 v6, v71, v72, s81
v_add_u32 v7, 23552, v6
v_xor_b32 v7, 32, v7
s_mov_b64 s[36:37], s[14:15]
s_mov_b32 s38, 1409024
s_mov_b32 s39, 0x20000
s_mov_b64 s[40:41], s[16:17]
s_mov_b32 s42, 1409024
s_mov_b32 s43, 0x20000
s_mov_b64 s[44:45], s[10:11]
s_mov_b32 s46, 524288
s_mov_b32 s47, 0x20000
s_mov_b64 s[48:49], s[18:19]
s_mov_b32 s50, 1409024
s_mov_b32 s51, 0x20000
s_mov_b64 s[60:61], s[8:9]
s_mov_b32 s62, 16384
s_mov_b32 s63, 0x20000
s_mov_b64 s[56:57], s[22:23]
s_mov_b32 s58, 2097152
s_mov_b32 s59, 0x20000
v_bfe_u32 v68, v1, 2, 2
v_and_b32 v69, 3, v1
v_lshlrev_b32_e64 v69, 3, v69
v_lshl_add_u32 v43, v68, 6, v69
v_lshrrev_b32_e64 v70, 5, v1
v_bfe_u32 v71, v1, 4, 1
v_and_b32_e64 v72, 15, v1
v_bfe_u32 v73, v1, 1, 3
v_lshrrev_b32 v75, 4, v1
v_xor_b32 v73, v73, v75
v_lshlrev_b32_e64 v73, 4, v73
v_lshl_add_u32 v73, v72, 7, v73
s_lshl_b32 s90, s75, 13
v_add_u32 v16, s90, v73
v_xor_b32_e64 v17, 64, v16
v_xor_b32 v18, 0x1000, v16
v_xor_b32 v19, 0x1040, v16
v_lshl_add_u32 v74, v71, 5, v43
v_lshl_add_u32 v40, v70, 11, v74
v_add_u32_e64 v40, s87, v40
v_lshl_add_u32 v40, v71, 9, v40
v_add_u32 v41, 0x10000, v40
v_add_u32 v42, 0x20000, v40
v_xor_b32 v13, 32, v40
v_xor_b32 v14, 32, v41
v_xor_b32 v15, 32, v42
v_lshrrev_b32 v75, 1, v1
v_xor_b32 v75, v75, v1
v_and_b32 v75, 1, v75
v_mul_u32_u24 v75, 24, v75
v_xor_b32 v75, v75, v74
s_lshl_b32 s90, s76, 8
v_lshrrev_b32 v76, 4, v1
v_mul_u32_u24 v76, 1024, v76
v_add3_u32 v60, v76, v75, s90
v_xor_b32_e64 v61, 32, v60
v_add_u32 v62, 49152, v60
v_add_u32 v63, 49152, v61
v_lshl_add_u32 v76, v70, 2, v71
v_mul_u32_u24 v76, 1536, v76
v_add_u32 v76, v76, v75
s_mul_i32 s90, s76, 3
s_lshr_b32 s91, s90, 1
s_lshl_b32 s91, s91, 8
s_and_b32 s92, s90, 1
s_lshl_b32 s92, s92, 5
s_add_u32 s91, s91, 49152
v_xor_b32 v20, s92, v76
v_add_u32 v20, s91, v20
v_add_u32 v23, 49152, v20
s_add_u32 s90, s90, 1
s_lshr_b32 s91, s90, 1
s_lshl_b32 s91, s91, 8
s_and_b32 s92, s90, 1
s_lshl_b32 s92, s92, 5
s_add_u32 s91, s91, 49152
v_xor_b32 v21, s92, v76
v_add_u32_e64 v21, s91, v21
v_add_u32 v24, 49152, v21
s_add_u32 s90, s90, 1
s_lshr_b32 s91, s90, 1
s_lshl_b32 s91, s91, 8
s_and_b32 s92, s90, 1
s_lshl_b32 s92, s92, 5
s_add_u32 s91, s91, 49152
v_xor_b32 v22, s92, v76
v_add_u32_e64 v22, s91, v22
v_add_u32 v25, 49152, v22
v_mov_b32 v48, 0xbdd2d3e8
v_mov_b32 v49, 0xc0135761
v_mov_b32 v50, 0x3fb8aa3b
v_mov_b32 v51, 0x358637bd
s_mov_b32 s69, 1
s_mov_b32 s70, 256
s_mov_b32 s98, 0xffff0000
s_mov_b32 s99, 0xffff0000
s_lshl_b32 s91, s74, 3
s_or_b32 s91, s91, 0x80000
s_bfe_u32 s4, 0x2620100a, s91
s_bfe_u32 s5, 0x504a3c36, s91
s_bfe_u32 s6, 0x1b160500, s91
s_bfe_u32 s7, 0x4642312c, s91
s_mul_i32 s90, s77, 118
s_lshl_b32 s92, s78, 7
s_add_u32 s8, s4, s90
s_lshl_b32 s8, s8, 11
s_bitcmp1_b32 s2, 7
s_cbranch_scc1 L_qa
s_add_u32 m0, s87, 0
s_add_u32 s84, s79, 0
s_and_b32 s84, s84, 0x380
buffer_load_dwordx4 v2, s[28:31], s84 offen lds
buffer_load_dwordx4 v3, s[28:31], s84 offen offset:1024 lds
buffer_load_dwordx4 v4, s[28:31], s84 offen offset:2048 lds
buffer_load_dwordx4 v5, s[28:31], s84 offen offset:3072 lds
s_add_u32 m0, s87, 16384
s_add_u32 s84, s79, 128
s_and_b32 s84, s84, 0x380
buffer_load_dwordx4 v2, s[28:31], s84 offen lds
buffer_load_dwordx4 v3, s[28:31], s84 offen offset:1024 lds
buffer_load_dwordx4 v4, s[28:31], s84 offen offset:2048 lds
buffer_load_dwordx4 v5, s[28:31], s84 offen offset:3072 lds
s_add_u32 m0, s87, 32768
s_add_u32 s84, s79, 256
s_and_b32 s84, s84, 0x380
buffer_load_dwordx4 v2, s[28:31], s84 offen lds
buffer_load_dwordx4 v3, s[28:31], s84 offen offset:1024 lds
L_qa:
s_mov_b64 exec, 0
s_cmp_eq_u32 s74, 0
s_cbranch_scc1 L_pad_Q_1
s_cmp_eq_u32 s74, 1
s_cbranch_scc1 L_pad_Q_2
s_cmp_eq_u32 s74, 2
s_cbranch_scc1 L_pad_Q_3
s_branch L_pad_Q_4
L_warm_Q:
s_mov_b64 exec, -1
s_bitcmp1_b32 s2, 7
s_cbranch_scc0 L_qb
s_add_u32 m0, s87, 0
s_add_u32 s84, s79, 0
s_and_b32 s84, s84, 0x380
buffer_load_dwordx4 v2, s[28:31], s84 offen lds
buffer_load_dwordx4 v3, s[28:31], s84 offen offset:1024 lds
buffer_load_dwordx4 v4, s[28:31], s84 offen offset:2048 lds
buffer_load_dwordx4 v5, s[28:31], s84 offen offset:3072 lds
s_add_u32 m0, s87, 16384
s_add_u32 s84, s79, 128
s_and_b32 s84, s84, 0x380
buffer_load_dwordx4 v2, s[28:31], s84 offen lds
buffer_load_dwordx4 v3, s[28:31], s84 offen offset:1024 lds
buffer_load_dwordx4 v4, s[28:31], s84 offen offset:2048 lds
buffer_load_dwordx4 v5, s[28:31], s84 offen offset:3072 lds
s_add_u32 m0, s87, 32768
s_add_u32 s84, s79, 256
s_and_b32 s84, s84, 0x380
buffer_load_dwordx4 v2, s[28:31], s84 offen lds
buffer_load_dwordx4 v3, s[28:31], s84 offen offset:1024 lds
L_qb:
s_lshl_b32 s4, s4, 14
s_add_u32 s4, s4, s92
s_add_u32 s9, s5, s90
s_lshl_b32 s9, s9, 11
s_lshl_b32 s5, s5, 14
s_add_u32 s5, s5, s92
s_add_u32 s10, s6, s90
s_lshl_b32 s10, s10, 11
s_lshl_b32 s6, s6, 14
s_add_u32 s6, s6, s92
s_add_u32 s11, s7, s90
s_lshl_b32 s11, s11, 11
s_lshl_b32 s7, s7, 14
s_add_u32 s7, s7, s92
s_lshl_b32 s91, s74, 2
s_add_u32 s12, s91, s90
s_add_u32 s12, s12, 86
s_lshl_b32 s12, s12, 11
s_lshl_b32 s13, s74, 16
s_add_u32 s13, s13, s92
s_lshl_b32 s14, s77, 2
s_add_u32 s14, s14, s74
s_lshl_b32 s14, s14, 8
s_add_u32 s14, s14, 8192
s_mov_b64 s[18:19], s[6:7]
s_mov_b64 s[20:21], s[10:11]
s_add_u32 s22, s12, 32768
s_add_u32 s23, s13, 262144
s_xor_b32 s90, s78, s77
s_bitcmp1_b32 s90, 1
s_cselect_b32 s90, s5, s4
s_cselect_b32 s5, s4, s5
s_mov_b32 s4, s90
s_cselect_b32 s90, s7, s6
s_cselect_b32 s7, s6, s7
s_mov_b32 s6, s90
s_cselect_b32 s90, s9, s8
s_cselect_b32 s9, s8, s9
s_mov_b32 s8, s90
s_cselect_b32 s90, s11, s10
s_cselect_b32 s11, s10, s11
s_mov_b32 s10, s90
s_cselect_b32 s90, s22, s12
s_cselect_b32 s22, s12, s22
s_mov_b32 s12, s90
s_cselect_b32 s90, s23, s13
s_cselect_b32 s23, s13, s23
s_mov_b32 s13, s90
v_bfe_u32 v68, v1, 2, 2
v_and_b32 v69, 3, v1
v_lshlrev_b32 v69, 4, v69
v_lshrrev_b32 v70, 4, v1
v_and_b32 v71, 32, v1
v_xor_b32 v69, v69, v71
v_lshrrev_b32 v71, 5, v1
v_lshl_add_u32 v71, v71, 2, v68
v_mul_u32_u24 v71, 1024, v71
v_and_b32_e64 v72, 1, v70
v_lshl_add_u32 v72, v72, 6, v69
v_add3_u32 v32, v71, v72, 0
v_add_u32 v33, 7168, v32
v_add_u32 v34, 14336, v32
v_add_u32 v35, 21504, v32
s_cmp_ge_u32 s74, 2
s_cselect_b32 s90, 2146435072, 0
v_add_u32 v36, s90, v34
v_add_u32 v37, s90, v35
v_add_u32 v39, s90, v38
s_sub_u32 s91, s21, s20
s_add_u32 s90, s90, s91
v_and_b32_e64 v68, 15, v1
v_bfe_u32 v69, v1, 4, 1
v_lshlrev_b32_e64 v68, 4, v68
v_lshl_add_u32 v68, v69, 9, v68
v_lshrrev_b32_e64 v69, 5, v1
v_lshl_add_u32 v77, v69, 11, v68
v_mul_lo_u32 v69, v69, s90
v_add_u32_e64 v39, v68, v69
s_lshl_b32 s94, s72, 1
s_add_u32 s94, s94, s75
s_mul_i32 s94, s94, 241664
s_lshl_b32 s15, s73, 2
s_add_u32 s15, s15, s74
s_lshl_b32 s15, s15, 8
s_lshl_b32 s16, s72, 1
s_add_u32 s16, s16, s75
s_lshl_b32 s16, s16, 10
s_add_u32 s16, s16, 8192
s_and_b32 s17, s73, 3
s_lshl_b32 s17, s17, 8
s_add_u32 s17, s17, s16
s_and_b32 s15, s15, 0xfe00
s_lshr_b32 s90, s15, 9
s_lshl_b32 s91, s90, 12
s_add_u32 s91, s91, 176128
s_add_u32 s82, s91, s94
s_mul_i32 s91, s76, 3
s_add_u32 s91, s91, s95
s_lshl_b32 s91, s91, 11
s_add_u32 s92, s91, s94
s_add_u32 s93, s92, 4096
s_lshl_b32 s80, s90, 11
s_add_u32 s80, s80, 9043968
s_mul_i32 s90, s90, 1920
s_sub_u32 s90, 32768, s90
v_lshrrev_b32 v68, 5, v1
v_lshl_add_u32 v68, v68, 4, s90
v_add_u32 v69, 1024, v38
v_add_u32 v70, 32, v68
v_add_u32 v71, 64, v68
v_add_u32 v72, 0x60, v68
v_cndmask_b32 v28, v38, v68, s[98:99]
v_cndmask_b32 v29, v69, v70, s[98:99]
v_cndmask_b32 v30, v71, v38, s[98:99]
v_cndmask_b32 v31, v72, v69, s[98:99]
s_cmp_ge_u32 s2, 68
s_cbranch_scc1 L_nr
s_waitcnt lgkmcnt(0)
s_atomic_add s69, s[24:25], 0
L_nr:
buffer_load_dwordx4 v4, s[28:31], s84 offen offset:2048 lds
buffer_load_dwordx4 v5, s[28:31], s84 offen offset:3072 lds
s_add_u32 s84, s79, 0
s_and_b32 s84, s84, 0x380
s_add_u32 m0, s89, 49152
s_mul_i32 s86, s84, 1376
buffer_load_dwordx4 v10, s[36:39], s86 offen lds
buffer_load_dwordx4 v11, s[36:39], s86 offen offset:1024 lds
buffer_load_dwordx4 v12, s[36:39], s86 offen offset:2048 lds
s_add_u32 m0, s89, 52224
s_nop 0
buffer_load_dwordx4 v10, s[40:43], s86 offen lds
buffer_load_dwordx4 v11, s[40:43], s86 offen offset:1024 lds
buffer_load_dwordx4 v12, s[40:43], s86 offen offset:2048 lds
s_lshl_b32 s85, s73, 1
s_add_u32 s85, s85, s76
s_lshr_b32 s86, s87, 2
s_add_u32 m0, s86, 147456
s_lshl_b32 s85, s85, 10
buffer_load_dwordx4 v38, s[60:63], s85 offen lds
s_add_u32 s84, s79, 128
s_and_b32 s84, s84, 0x380
s_add_u32 m0, s89, 73728
s_mul_i32 s86, s84, 1376
buffer_load_dwordx4 v10, s[36:39], s86 offen lds
buffer_load_dwordx4 v11, s[36:39], s86 offen offset:1024 lds
buffer_load_dwordx4 v12, s[36:39], s86 offen offset:2048 lds
s_add_u32 m0, s89, 76800
s_nop 0
buffer_load_dwordx4 v10, s[40:43], s86 offen lds
buffer_load_dwordx4 v11, s[40:43], s86 offen offset:1024 lds
buffer_load_dwordx4 v12, s[40:43], s86 offen offset:2048 lds
s_add_u32 s84, s79, 256
s_and_b32 s84, s84, 0x380
s_add_u32 m0, s89, 98304
s_mul_i32 s86, s84, 1376
buffer_load_dwordx4 v10, s[36:39], s86 offen lds
buffer_load_dwordx4 v11, s[36:39], s86 offen offset:1024 lds
buffer_load_dwordx4 v12, s[36:39], s86 offen offset:2048 lds
s_add_u32 m0, s89, 101376
s_nop 0
buffer_load_dwordx4 v10, s[40:43], s86 offen lds
buffer_load_dwordx4 v11, s[40:43], s86 offen offset:1024 lds
buffer_load_dwordx4 v12, s[40:43], s86 offen offset:2048 lds
s_waitcnt vmcnt(6)
s_barrier
ds_read_b128 a[0:3], v16 offset:0
ds_read_b128 a[4:7], v16 offset:2048
ds_read_b64_tr_b16 v[80:81], v20 offset:0
ds_read_b64_tr_b16 v[82:83], v20 offset:768
ds_read_b64_tr_b16 v[84:85], v20 offset:3072
ds_read_b64_tr_b16 v[86:87], v20 offset:3840
ds_read_b64_tr_b16 v[88:89], v21 offset:0
ds_read_b64_tr_b16 v[90:91], v21 offset:768
ds_read_b128 a[8:11], v18 offset:0
ds_read_b128 a[12:15], v18 offset:2048
ds_read_b64_tr_b16 v[92:93], v21 offset:3072
ds_read_b64_tr_b16 v[94:95], v21 offset:3840
ds_read_b64_tr_b16 v[96:97], v22 offset:0
ds_read_b64_tr_b16 v[98:99], v22 offset:768
ds_read_b64_tr_b16 v[100:101], v22 offset:3072
ds_read_b64_tr_b16 v[102:103], v22 offset:3840
s_waitcnt lgkmcnt(12)
v_mfma_f32_16x16x32_bf16 v[128:131], v[80:83], a[0:3], 0
ds_read_b128 a[16:19], v17 offset:0
v_mfma_f32_16x16x32_bf16 v[132:135], v[80:83], a[4:7], 0
ds_read_b128 a[20:23], v17 offset:2048
s_waitcnt lgkmcnt(12)
v_mfma_f32_16x16x32_bf16 v[136:139], v[84:87], a[0:3], 0
ds_read_b64_tr_b16 v[104:105], v20 offset:12288
v_mfma_f32_16x16x32_bf16 v[140:143], v[84:87], a[4:7], 0
ds_read_b64_tr_b16 v[106:107], v20 offset:13056
s_waitcnt lgkmcnt(12)
v_mfma_f32_16x16x32_bf16 v[160:163], v[88:91], a[0:3], 0
ds_read_b64_tr_b16 v[108:109], v20 offset:15360
v_mfma_f32_16x16x32_bf16 v[164:167], v[88:91], a[4:7], 0
ds_read_b64_tr_b16 v[110:111], v20 offset:16128
s_waitcnt lgkmcnt(6)
v_mfma_f32_16x16x32_bf16 v[168:171], v[92:95], a[0:3], 0
ds_read_b64_tr_b16 v[112:113], v21 offset:12288
v_mfma_f32_16x16x32_bf16 v[172:175], v[92:95], a[4:7], 0
ds_read_b64_tr_b16 v[114:115], v21 offset:13056
v_mfma_f32_16x16x32_bf16 v[192:195], v[96:99], a[0:3], 0
v_mfma_f32_16x16x32_bf16 v[196:199], v[96:99], a[4:7], 0
v_mfma_f32_16x16x32_bf16 v[200:203], v[100:103], a[0:3], 0
v_mfma_f32_16x16x32_bf16 v[204:207], v[100:103], a[4:7], 0
v_mfma_f32_16x16x32_bf16 v[144:147], v[80:83], a[8:11], 0
ds_read_b128 a[24:27], v19 offset:0
v_mfma_f32_16x16x32_bf16 v[148:151], v[80:83], a[12:15], 0
ds_read_b128 a[28:31], v19 offset:2048
v_mfma_f32_16x16x32_bf16 v[152:155], v[84:87], a[8:11], 0
ds_read_b64_tr_b16 v[116:117], v21 offset:15360
v_mfma_f32_16x16x32_bf16 v[156:159], v[84:87], a[12:15], 0
ds_read_b64_tr_b16 v[118:119], v21 offset:16128
v_mfma_f32_16x16x32_bf16 v[176:179], v[88:91], a[8:11], 0
ds_read_b64_tr_b16 v[120:121], v22 offset:12288
v_mfma_f32_16x16x32_bf16 v[180:183], v[88:91], a[12:15], 0
ds_read_b64_tr_b16 v[122:123], v22 offset:13056
v_mfma_f32_16x16x32_bf16 v[184:187], v[92:95], a[8:11], 0
ds_read_b64_tr_b16 v[124:125], v22 offset:15360
v_mfma_f32_16x16x32_bf16 v[188:191], v[92:95], a[12:15], 0
ds_read_b64_tr_b16 v[126:127], v22 offset:16128
v_mfma_f32_16x16x32_bf16 v[208:211], v[96:99], a[8:11], 0
v_mfma_f32_16x16x32_bf16 v[212:215], v[96:99], a[12:15], 0
v_mfma_f32_16x16x32_bf16 v[216:219], v[100:103], a[8:11], 0
v_mfma_f32_16x16x32_bf16 v[220:223], v[100:103], a[12:15], 0
s_waitcnt lgkmcnt(0)
v_mfma_f32_16x16x32_bf16 v[128:131], v[104:107], a[16:19], v[128:131]
s_barrier
ds_read_b128 a[32:35], v16 offset:16384
v_mfma_f32_16x16x32_bf16 v[132:135], v[104:107], a[20:23], v[132:135]
ds_read_b128 a[36:39], v16 offset:18432
s_add_u32 m0, s87, 0
s_add_u32 s84, s79, 384
s_and_b32 s84, s84, 0x380
v_mfma_f32_16x16x32_bf16 v[136:139], v[108:111], a[16:19], v[136:139]
buffer_load_dwordx4 v2, s[28:31], s84 offen lds
v_mfma_f32_16x16x32_bf16 v[140:143], v[108:111], a[20:23], v[140:143]
ds_read_b64_tr_b16 v[80:81], v20 offset:24576
v_mfma_f32_16x16x32_bf16 v[160:163], v[112:115], a[16:19], v[160:163]
ds_read_b64_tr_b16 v[82:83], v20 offset:25344
v_mfma_f32_16x16x32_bf16 v[164:167], v[112:115], a[20:23], v[164:167]
ds_read_b64_tr_b16 v[84:85], v20 offset:27648
v_mfma_f32_16x16x32_bf16 v[168:171], v[116:119], a[16:19], v[168:171]
buffer_load_dwordx4 v3, s[28:31], s84 offen offset:1024 lds
v_mfma_f32_16x16x32_bf16 v[172:175], v[116:119], a[20:23], v[172:175]
ds_read_b64_tr_b16 v[86:87], v20 offset:28416
v_mfma_f32_16x16x32_bf16 v[192:195], v[120:123], a[16:19], v[192:195]
ds_read_b64_tr_b16 v[88:89], v21 offset:24576
v_mfma_f32_16x16x32_bf16 v[196:199], v[120:123], a[20:23], v[196:199]
ds_read_b64_tr_b16 v[90:91], v21 offset:25344
v_mfma_f32_16x16x32_bf16 v[200:203], v[124:127], a[16:19], v[200:203]
buffer_load_dwordx4 v4, s[28:31], s84 offen offset:2048 lds
v_mfma_f32_16x16x32_bf16 v[204:207], v[124:127], a[20:23], v[204:207]
v_mfma_f32_16x16x32_bf16 v[144:147], v[104:107], a[24:27], v[144:147]
ds_read_b128 a[40:43], v18 offset:16384
v_mfma_f32_16x16x32_bf16 v[148:151], v[104:107], a[28:31], v[148:151]
ds_read_b128 a[44:47], v18 offset:18432
v_mfma_f32_16x16x32_bf16 v[152:155], v[108:111], a[24:27], v[152:155]
buffer_load_dwordx4 v5, s[28:31], s84 offen offset:3072 lds
v_mfma_f32_16x16x32_bf16 v[156:159], v[108:111], a[28:31], v[156:159]
ds_read_b64_tr_b16 v[92:93], v21 offset:27648
s_add_u32 m0, s89, 122880
v_mfma_f32_16x16x32_bf16 v[176:179], v[112:115], a[24:27], v[176:179]
ds_read_b64_tr_b16 v[94:95], v21 offset:28416
s_mul_i32 s86, s84, 1376
v_mfma_f32_16x16x32_bf16 v[180:183], v[112:115], a[28:31], v[180:183]
ds_read_b64_tr_b16 v[96:97], v22 offset:24576
v_mfma_f32_16x16x32_bf16 v[184:187], v[116:119], a[24:27], v[184:187]
buffer_load_dwordx4 v10, s[36:39], s86 offen lds
v_mfma_f32_16x16x32_bf16 v[188:191], v[116:119], a[28:31], v[188:191]
ds_read_b64_tr_b16 v[98:99], v22 offset:25344
v_mfma_f32_16x16x32_bf16 v[208:211], v[120:123], a[24:27], v[208:211]
ds_read_b64_tr_b16 v[100:101], v22 offset:27648
v_mfma_f32_16x16x32_bf16 v[212:215], v[120:123], a[28:31], v[212:215]
ds_read_b64_tr_b16 v[102:103], v22 offset:28416
v_mfma_f32_16x16x32_bf16 v[216:219], v[124:127], a[24:27], v[216:219]
buffer_load_dwordx4 v11, s[36:39], s86 offen offset:1024 lds
v_mfma_f32_16x16x32_bf16 v[220:223], v[124:127], a[28:31], v[220:223]
s_waitcnt lgkmcnt(8)
v_mfma_f32_16x16x32_bf16 v[128:131], v[80:83], a[32:35], v[128:131]
ds_read_b128 a[48:51], v17 offset:16384
v_mfma_f32_16x16x32_bf16 v[132:135], v[80:83], a[36:39], v[132:135]
ds_read_b128 a[52:55], v17 offset:18432
v_mfma_f32_16x16x32_bf16 v[136:139], v[84:87], a[32:35], v[136:139]
buffer_load_dwordx4 v12, s[36:39], s86 offen offset:2048 lds
v_mfma_f32_16x16x32_bf16 v[140:143], v[84:87], a[36:39], v[140:143]
ds_read_b64_tr_b16 v[104:105], v20 offset:36864
s_add_u32 m0, s89, 125952
v_mfma_f32_16x16x32_bf16 v[160:163], v[88:91], a[32:35], v[160:163]
ds_read_b64_tr_b16 v[106:107], v20 offset:37632
v_mfma_f32_16x16x32_bf16 v[164:167], v[88:91], a[36:39], v[164:167]
ds_read_b64_tr_b16 v[108:109], v20 offset:39936
s_waitcnt lgkmcnt(5)
v_mfma_f32_16x16x32_bf16 v[168:171], v[92:95], a[32:35], v[168:171]
buffer_load_dwordx4 v10, s[40:43], s86 offen lds
v_mfma_f32_16x16x32_bf16 v[172:175], v[92:95], a[36:39], v[172:175]
ds_read_b64_tr_b16 v[110:111], v20 offset:40704
v_mfma_f32_16x16x32_bf16 v[192:195], v[96:99], a[32:35], v[192:195]
ds_read_b64_tr_b16 v[112:113], v21 offset:36864
v_mfma_f32_16x16x32_bf16 v[196:199], v[96:99], a[36:39], v[196:199]
ds_read_b64_tr_b16 v[114:115], v21 offset:37632
v_mfma_f32_16x16x32_bf16 v[200:203], v[100:103], a[32:35], v[200:203]
buffer_load_dwordx4 v11, s[40:43], s86 offen offset:1024 lds
v_mfma_f32_16x16x32_bf16 v[204:207], v[100:103], a[36:39], v[204:207]
v_mfma_f32_16x16x32_bf16 v[144:147], v[80:83], a[40:43], v[144:147]
ds_read_b128 a[56:59], v19 offset:16384
v_mfma_f32_16x16x32_bf16 v[148:151], v[80:83], a[44:47], v[148:151]
ds_read_b128 a[60:63], v19 offset:18432
v_mfma_f32_16x16x32_bf16 v[152:155], v[84:87], a[40:43], v[152:155]
ds_read_b64_tr_b16 v[116:117], v21 offset:39936
v_mfma_f32_16x16x32_bf16 v[156:159], v[84:87], a[44:47], v[156:159]
ds_read_b64_tr_b16 v[118:119], v21 offset:40704
v_mfma_f32_16x16x32_bf16 v[176:179], v[88:91], a[40:43], v[176:179]
ds_read_b64_tr_b16 v[120:121], v22 offset:36864
v_mfma_f32_16x16x32_bf16 v[180:183], v[88:91], a[44:47], v[180:183]
ds_read_b64_tr_b16 v[122:123], v22 offset:37632
v_mfma_f32_16x16x32_bf16 v[184:187], v[92:95], a[40:43], v[184:187]
ds_read_b64_tr_b16 v[124:125], v22 offset:39936
v_mfma_f32_16x16x32_bf16 v[188:191], v[92:95], a[44:47], v[188:191]
ds_read_b64_tr_b16 v[126:127], v22 offset:40704
v_mfma_f32_16x16x32_bf16 v[208:211], v[96:99], a[40:43], v[208:211]
v_mfma_f32_16x16x32_bf16 v[212:215], v[96:99], a[44:47], v[212:215]
v_mfma_f32_16x16x32_bf16 v[216:219], v[100:103], a[40:43], v[216:219]
buffer_load_dwordx4 v12, s[40:43], s86 offen offset:2048 lds
v_mfma_f32_16x16x32_bf16 v[220:223], v[100:103], a[44:47], v[220:223]
s_waitcnt lgkmcnt(0)
v_mfma_f32_16x16x32_bf16 v[128:131], v[104:107], a[48:51], v[128:131]
s_waitcnt vmcnt(10)
s_barrier
ds_read_b128 a[64:67], v16 offset:32768
v_mfma_f32_16x16x32_bf16 v[132:135], v[104:107], a[52:55], v[132:135]
ds_read_b128 a[68:71], v16 offset:34816
s_add_u32 m0, s87, 16384
s_add_u32 s84, s79, 512
s_and_b32 s84, s84, 0x380
v_mfma_f32_16x16x32_bf16 v[136:139], v[108:111], a[48:51], v[136:139]
buffer_load_dwordx4 v2, s[28:31], s84 offen lds
v_mfma_f32_16x16x32_bf16 v[140:143], v[108:111], a[52:55], v[140:143]
ds_read_b64_tr_b16 v[80:81], v23 offset:0
v_mfma_f32_16x16x32_bf16 v[160:163], v[112:115], a[48:51], v[160:163]
ds_read_b64_tr_b16 v[82:83], v23 offset:768
v_mfma_f32_16x16x32_bf16 v[164:167], v[112:115], a[52:55], v[164:167]
ds_read_b64_tr_b16 v[84:85], v23 offset:3072
v_mfma_f32_16x16x32_bf16 v[168:171], v[116:119], a[48:51], v[168:171]
buffer_load_dwordx4 v3, s[28:31], s84 offen offset:1024 lds
v_mfma_f32_16x16x32_bf16 v[172:175], v[116:119], a[52:55], v[172:175]
ds_read_b64_tr_b16 v[86:87], v23 offset:3840
v_mfma_f32_16x16x32_bf16 v[192:195], v[120:123], a[48:51], v[192:195]
ds_read_b64_tr_b16 v[88:89], v24 offset:0
v_mfma_f32_16x16x32_bf16 v[196:199], v[120:123], a[52:55], v[196:199]
ds_read_b64_tr_b16 v[90:91], v24 offset:768
v_mfma_f32_16x16x32_bf16 v[200:203], v[124:127], a[48:51], v[200:203]
buffer_load_dwordx4 v4, s[28:31], s84 offen offset:2048 lds
v_mfma_f32_16x16x32_bf16 v[204:207], v[124:127], a[52:55], v[204:207]
v_mfma_f32_16x16x32_bf16 v[144:147], v[104:107], a[56:59], v[144:147]
ds_read_b128 a[72:75], v18 offset:32768
v_mfma_f32_16x16x32_bf16 v[148:151], v[104:107], a[60:63], v[148:151]
ds_read_b128 a[76:79], v18 offset:34816
v_mfma_f32_16x16x32_bf16 v[152:155], v[108:111], a[56:59], v[152:155]
buffer_load_dwordx4 v5, s[28:31], s84 offen offset:3072 lds
v_mfma_f32_16x16x32_bf16 v[156:159], v[108:111], a[60:63], v[156:159]
ds_read_b64_tr_b16 v[92:93], v24 offset:3072
s_add_u32 m0, s89, 49152
v_mfma_f32_16x16x32_bf16 v[176:179], v[112:115], a[56:59], v[176:179]
ds_read_b64_tr_b16 v[94:95], v24 offset:3840
s_mul_i32 s86, s84, 1376
v_mfma_f32_16x16x32_bf16 v[180:183], v[112:115], a[60:63], v[180:183]
ds_read_b64_tr_b16 v[96:97], v25 offset:0
v_mfma_f32_16x16x32_bf16 v[184:187], v[116:119], a[56:59], v[184:187]
buffer_load_dwordx4 v10, s[36:39], s86 offen lds
v_mfma_f32_16x16x32_bf16 v[188:191], v[116:119], a[60:63], v[188:191]
ds_read_b64_tr_b16 v[98:99], v25 offset:768
v_mfma_f32_16x16x32_bf16 v[208:211], v[120:123], a[56:59], v[208:211]
ds_read_b64_tr_b16 v[100:101], v25 offset:3072
v_mfma_f32_16x16x32_bf16 v[212:215], v[120:123], a[60:63], v[212:215]
ds_read_b64_tr_b16 v[102:103], v25 offset:3840
v_mfma_f32_16x16x32_bf16 v[216:219], v[124:127], a[56:59], v[216:219]
buffer_load_dwordx4 v11, s[36:39], s86 offen offset:1024 lds
v_mfma_f32_16x16x32_bf16 v[220:223], v[124:127], a[60:63], v[220:223]
s_waitcnt lgkmcnt(8)
v_mfma_f32_16x16x32_bf16 v[128:131], v[80:83], a[64:67], v[128:131]
ds_read_b128 a[80:83], v17 offset:32768
L_pad_Q_1:
s_cbranch_execz L_pad_Q_2
s_nop 0
v_mfma_f32_16x16x32_bf16 v[132:135], v[80:83], a[68:71], v[132:135]
ds_read_b128 a[84:87], v17 offset:34816
v_mfma_f32_16x16x32_bf16 v[136:139], v[84:87], a[64:67], v[136:139]
buffer_load_dwordx4 v12, s[36:39], s86 offen offset:2048 lds
v_mfma_f32_16x16x32_bf16 v[140:143], v[84:87], a[68:71], v[140:143]
ds_read_b64_tr_b16 v[104:105], v23 offset:12288
s_add_u32 m0, s89, 52224
v_mfma_f32_16x16x32_bf16 v[160:163], v[88:91], a[64:67], v[160:163]
ds_read_b64_tr_b16 v[106:107], v23 offset:13056
v_mfma_f32_16x16x32_bf16 v[164:167], v[88:91], a[68:71], v[164:167]
ds_read_b64_tr_b16 v[108:109], v23 offset:15360
s_waitcnt lgkmcnt(5)
v_mfma_f32_16x16x32_bf16 v[168:171], v[92:95], a[64:67], v[168:171]
buffer_load_dwordx4 v10, s[40:43], s86 offen lds
v_mfma_f32_16x16x32_bf16 v[172:175], v[92:95], a[68:71], v[172:175]
ds_read_b64_tr_b16 v[110:111], v23 offset:16128
v_mfma_f32_16x16x32_bf16 v[192:195], v[96:99], a[64:67], v[192:195]
ds_read_b64_tr_b16 v[112:113], v24 offset:12288
v_mfma_f32_16x16x32_bf16 v[196:199], v[96:99], a[68:71], v[196:199]
ds_read_b64_tr_b16 v[114:115], v24 offset:13056
v_mfma_f32_16x16x32_bf16 v[200:203], v[100:103], a[64:67], v[200:203]
buffer_load_dwordx4 v11, s[40:43], s86 offen offset:1024 lds
v_mfma_f32_16x16x32_bf16 v[204:207], v[100:103], a[68:71], v[204:207]
v_mfma_f32_16x16x32_bf16 v[144:147], v[80:83], a[72:75], v[144:147]
ds_read_b128 a[88:91], v19 offset:32768
v_mfma_f32_16x16x32_bf16 v[148:151], v[80:83], a[76:79], v[148:151]
ds_read_b128 a[92:95], v19 offset:34816
v_mfma_f32_16x16x32_bf16 v[152:155], v[84:87], a[72:75], v[152:155]
ds_read_b64_tr_b16 v[116:117], v24 offset:15360
v_mfma_f32_16x16x32_bf16 v[156:159], v[84:87], a[76:79], v[156:159]
ds_read_b64_tr_b16 v[118:119], v24 offset:16128
v_mfma_f32_16x16x32_bf16 v[176:179], v[88:91], a[72:75], v[176:179]
ds_read_b64_tr_b16 v[120:121], v25 offset:12288
v_mfma_f32_16x16x32_bf16 v[180:183], v[88:91], a[76:79], v[180:183]
ds_read_b64_tr_b16 v[122:123], v25 offset:13056
v_mfma_f32_16x16x32_bf16 v[184:187], v[92:95], a[72:75], v[184:187]
ds_read_b64_tr_b16 v[124:125], v25 offset:15360
v_mfma_f32_16x16x32_bf16 v[188:191], v[92:95], a[76:79], v[188:191]
ds_read_b64_tr_b16 v[126:127], v25 offset:16128
v_mfma_f32_16x16x32_bf16 v[208:211], v[96:99], a[72:75], v[208:211]
v_mfma_f32_16x16x32_bf16 v[212:215], v[96:99], a[76:79], v[212:215]
v_mfma_f32_16x16x32_bf16 v[216:219], v[100:103], a[72:75], v[216:219]
buffer_load_dwordx4 v12, s[40:43], s86 offen offset:2048 lds
v_mfma_f32_16x16x32_bf16 v[220:223], v[100:103], a[76:79], v[220:223]
s_waitcnt lgkmcnt(0)
v_mfma_f32_16x16x32_bf16 v[128:131], v[104:107], a[80:83], v[128:131]
s_waitcnt vmcnt(10)
s_barrier
ds_read_b128 a[96:99], v16 offset:0
v_mfma_f32_16x16x32_bf16 v[132:135], v[104:107], a[84:87], v[132:135]
ds_read_b128 a[100:103], v16 offset:2048
s_add_u32 m0, s87, 32768
s_add_u32 s84, s79, 640
s_and_b32 s84, s84, 0x380
v_mfma_f32_16x16x32_bf16 v[136:139], v[108:111], a[80:83], v[136:139]
buffer_load_dwordx4 v2, s[28:31], s84 offen lds
v_mfma_f32_16x16x32_bf16 v[140:143], v[108:111], a[84:87], v[140:143]
ds_read_b64_tr_b16 v[80:81], v23 offset:24576
v_mfma_f32_16x16x32_bf16 v[160:163], v[112:115], a[80:83], v[160:163]
ds_read_b64_tr_b16 v[82:83], v23 offset:25344
v_mfma_f32_16x16x32_bf16 v[164:167], v[112:115], a[84:87], v[164:167]
ds_read_b64_tr_b16 v[84:85], v23 offset:27648
v_mfma_f32_16x16x32_bf16 v[168:171], v[116:119], a[80:83], v[168:171]
buffer_load_dwordx4 v3, s[28:31], s84 offen offset:1024 lds
v_mfma_f32_16x16x32_bf16 v[172:175], v[116:119], a[84:87], v[172:175]
ds_read_b64_tr_b16 v[86:87], v23 offset:28416
v_mfma_f32_16x16x32_bf16 v[192:195], v[120:123], a[80:83], v[192:195]
ds_read_b64_tr_b16 v[88:89], v24 offset:24576
v_mfma_f32_16x16x32_bf16 v[196:199], v[120:123], a[84:87], v[196:199]
ds_read_b64_tr_b16 v[90:91], v24 offset:25344
v_mfma_f32_16x16x32_bf16 v[200:203], v[124:127], a[80:83], v[200:203]
buffer_load_dwordx4 v4, s[28:31], s84 offen offset:2048 lds
v_mfma_f32_16x16x32_bf16 v[204:207], v[124:127], a[84:87], v[204:207]
v_mfma_f32_16x16x32_bf16 v[144:147], v[104:107], a[88:91], v[144:147]
ds_read_b128 a[104:107], v18 offset:0
v_mfma_f32_16x16x32_bf16 v[148:151], v[104:107], a[92:95], v[148:151]
ds_read_b128 a[108:111], v18 offset:2048
v_mfma_f32_16x16x32_bf16 v[152:155], v[108:111], a[88:91], v[152:155]
buffer_load_dwordx4 v5, s[28:31], s84 offen offset:3072 lds
v_mfma_f32_16x16x32_bf16 v[156:159], v[108:111], a[92:95], v[156:159]
ds_read_b64_tr_b16 v[92:93], v24 offset:27648
s_add_u32 m0, s89, 73728
v_mfma_f32_16x16x32_bf16 v[176:179], v[112:115], a[88:91], v[176:179]
ds_read_b64_tr_b16 v[94:95], v24 offset:28416
s_mul_i32 s86, s84, 1376
v_mfma_f32_16x16x32_bf16 v[180:183], v[112:115], a[92:95], v[180:183]
ds_read_b64_tr_b16 v[96:97], v25 offset:24576
v_mfma_f32_16x16x32_bf16 v[184:187], v[116:119], a[88:91], v[184:187]
buffer_load_dwordx4 v10, s[36:39], s86 offen lds
v_mfma_f32_16x16x32_bf16 v[188:191], v[116:119], a[92:95], v[188:191]
ds_read_b64_tr_b16 v[98:99], v25 offset:25344
v_mfma_f32_16x16x32_bf16 v[208:211], v[120:123], a[88:91], v[208:211]
ds_read_b64_tr_b16 v[100:101], v25 offset:27648
v_mfma_f32_16x16x32_bf16 v[212:215], v[120:123], a[92:95], v[212:215]
ds_read_b64_tr_b16 v[102:103], v25 offset:28416
v_mfma_f32_16x16x32_bf16 v[216:219], v[124:127], a[88:91], v[216:219]
buffer_load_dwordx4 v11, s[36:39], s86 offen offset:1024 lds
v_mfma_f32_16x16x32_bf16 v[220:223], v[124:127], a[92:95], v[220:223]
s_waitcnt lgkmcnt(8)
v_mfma_f32_16x16x32_bf16 v[128:131], v[80:83], a[96:99], v[128:131]
ds_read_b128 a[112:115], v17 offset:0
v_mfma_f32_16x16x32_bf16 v[132:135], v[80:83], a[100:103], v[132:135]
ds_read_b128 a[116:119], v17 offset:2048
v_mfma_f32_16x16x32_bf16 v[136:139], v[84:87], a[96:99], v[136:139]
buffer_load_dwordx4 v12, s[36:39], s86 offen offset:2048 lds
v_mfma_f32_16x16x32_bf16 v[140:143], v[84:87], a[100:103], v[140:143]
ds_read_b64_tr_b16 v[104:105], v23 offset:36864
s_add_u32 m0, s89, 76800
v_mfma_f32_16x16x32_bf16 v[160:163], v[88:91], a[96:99], v[160:163]
ds_read_b64_tr_b16 v[106:107], v23 offset:37632
v_mfma_f32_16x16x32_bf16 v[164:167], v[88:91], a[100:103], v[164:167]
ds_read_b64_tr_b16 v[108:109], v23 offset:39936
s_waitcnt lgkmcnt(5)
v_mfma_f32_16x16x32_bf16 v[168:171], v[92:95], a[96:99], v[168:171]
buffer_load_dwordx4 v10, s[40:43], s86 offen lds
v_mfma_f32_16x16x32_bf16 v[172:175], v[92:95], a[100:103], v[172:175]
ds_read_b64_tr_b16 v[110:111], v23 offset:40704
v_mfma_f32_16x16x32_bf16 v[192:195], v[96:99], a[96:99], v[192:195]
ds_read_b64_tr_b16 v[112:113], v24 offset:36864
v_mfma_f32_16x16x32_bf16 v[196:199], v[96:99], a[100:103], v[196:199]
ds_read_b64_tr_b16 v[114:115], v24 offset:37632
v_mfma_f32_16x16x32_bf16 v[200:203], v[100:103], a[96:99], v[200:203]
buffer_load_dwordx4 v11, s[40:43], s86 offen offset:1024 lds
v_mfma_f32_16x16x32_bf16 v[204:207], v[100:103], a[100:103], v[204:207]
v_mfma_f32_16x16x32_bf16 v[144:147], v[80:83], a[104:107], v[144:147]
ds_read_b128 a[120:123], v19 offset:0
v_mfma_f32_16x16x32_bf16 v[148:151], v[80:83], a[108:111], v[148:151]
ds_read_b128 a[124:127], v19 offset:2048
v_mfma_f32_16x16x32_bf16 v[152:155], v[84:87], a[104:107], v[152:155]
ds_read_b64_tr_b16 v[116:117], v24 offset:39936
v_mfma_f32_16x16x32_bf16 v[156:159], v[84:87], a[108:111], v[156:159]
ds_read_b64_tr_b16 v[118:119], v24 offset:40704
v_mfma_f32_16x16x32_bf16 v[176:179], v[88:91], a[104:107], v[176:179]
ds_read_b64_tr_b16 v[120:121], v25 offset:36864
v_mfma_f32_16x16x32_bf16 v[180:183], v[88:91], a[108:111], v[180:183]
ds_read_b64_tr_b16 v[122:123], v25 offset:37632
v_mfma_f32_16x16x32_bf16 v[184:187], v[92:95], a[104:107], v[184:187]
ds_read_b64_tr_b16 v[124:125], v25 offset:39936
v_mfma_f32_16x16x32_bf16 v[188:191], v[92:95], a[108:111], v[188:191]
ds_read_b64_tr_b16 v[126:127], v25 offset:40704
v_mfma_f32_16x16x32_bf16 v[208:211], v[96:99], a[104:107], v[208:211]
v_mfma_f32_16x16x32_bf16 v[212:215], v[96:99], a[108:111], v[212:215]
v_mfma_f32_16x16x32_bf16 v[216:219], v[100:103], a[104:107], v[216:219]
buffer_load_dwordx4 v12, s[40:43], s86 offen offset:2048 lds
v_mfma_f32_16x16x32_bf16 v[220:223], v[100:103], a[108:111], v[220:223]
s_waitcnt lgkmcnt(0)
v_mfma_f32_16x16x32_bf16 v[128:131], v[104:107], a[112:115], v[128:131]
s_waitcnt vmcnt(10)
s_barrier
ds_read_b128 a[128:131], v16 offset:16384
v_mfma_f32_16x16x32_bf16 v[132:135], v[104:107], a[116:119], v[132:135]
ds_read_b128 a[132:135], v16 offset:18432
s_add_u32 m0, s87, 0
s_add_u32 s84, s79, 768
s_and_b32 s84, s84, 0x380
v_mfma_f32_16x16x32_bf16 v[136:139], v[108:111], a[112:115], v[136:139]
buffer_load_dwordx4 v2, s[28:31], s84 offen lds
v_mfma_f32_16x16x32_bf16 v[140:143], v[108:111], a[116:119], v[140:143]
ds_read_b64_tr_b16 v[80:81], v20 offset:0
v_mfma_f32_16x16x32_bf16 v[160:163], v[112:115], a[112:115], v[160:163]
ds_read_b64_tr_b16 v[82:83], v20 offset:768
v_mfma_f32_16x16x32_bf16 v[164:167], v[112:115], a[116:119], v[164:167]
ds_read_b64_tr_b16 v[84:85], v20 offset:3072
v_mfma_f32_16x16x32_bf16 v[168:171], v[116:119], a[112:115], v[168:171]
buffer_load_dwordx4 v3, s[28:31], s84 offen offset:1024 lds
v_mfma_f32_16x16x32_bf16 v[172:175], v[116:119], a[116:119], v[172:175]
ds_read_b64_tr_b16 v[86:87], v20 offset:3840
v_mfma_f32_16x16x32_bf16 v[192:195], v[120:123], a[112:115], v[192:195]
ds_read_b64_tr_b16 v[88:89], v21 offset:0
v_mfma_f32_16x16x32_bf16 v[196:199], v[120:123], a[116:119], v[196:199]
ds_read_b64_tr_b16 v[90:91], v21 offset:768
v_mfma_f32_16x16x32_bf16 v[200:203], v[124:127], a[112:115], v[200:203]
buffer_load_dwordx4 v4, s[28:31], s84 offen offset:2048 lds
v_mfma_f32_16x16x32_bf16 v[204:207], v[124:127], a[116:119], v[204:207]
v_mfma_f32_16x16x32_bf16 v[144:147], v[104:107], a[120:123], v[144:147]
ds_read_b128 a[136:139], v18 offset:16384
v_mfma_f32_16x16x32_bf16 v[148:151], v[104:107], a[124:127], v[148:151]
ds_read_b128 a[140:143], v18 offset:18432
v_mfma_f32_16x16x32_bf16 v[152:155], v[108:111], a[120:123], v[152:155]
buffer_load_dwordx4 v5, s[28:31], s84 offen offset:3072 lds
v_mfma_f32_16x16x32_bf16 v[156:159], v[108:111], a[124:127], v[156:159]
ds_read_b64_tr_b16 v[92:93], v21 offset:3072
s_add_u32 m0, s89, 98304
v_mfma_f32_16x16x32_bf16 v[176:179], v[112:115], a[120:123], v[176:179]
ds_read_b64_tr_b16 v[94:95], v21 offset:3840
s_mul_i32 s86, s84, 1376
v_mfma_f32_16x16x32_bf16 v[180:183], v[112:115], a[124:127], v[180:183]
ds_read_b64_tr_b16 v[96:97], v22 offset:0
v_mfma_f32_16x16x32_bf16 v[184:187], v[116:119], a[120:123], v[184:187]
buffer_load_dwordx4 v10, s[36:39], s86 offen lds
v_mfma_f32_16x16x32_bf16 v[188:191], v[116:119], a[124:127], v[188:191]
ds_read_b64_tr_b16 v[98:99], v22 offset:768
v_mfma_f32_16x16x32_bf16 v[208:211], v[120:123], a[120:123], v[208:211]
ds_read_b64_tr_b16 v[100:101], v22 offset:3072
v_mfma_f32_16x16x32_bf16 v[212:215], v[120:123], a[124:127], v[212:215]
ds_read_b64_tr_b16 v[102:103], v22 offset:3840
v_mfma_f32_16x16x32_bf16 v[216:219], v[124:127], a[120:123], v[216:219]
buffer_load_dwordx4 v11, s[36:39], s86 offen offset:1024 lds
v_mfma_f32_16x16x32_bf16 v[220:223], v[124:127], a[124:127], v[220:223]
s_waitcnt lgkmcnt(8)
v_mfma_f32_16x16x32_bf16 v[128:131], v[80:83], a[128:131], v[128:131]
ds_read_b128 a[144:147], v17 offset:16384
v_mfma_f32_16x16x32_bf16 v[132:135], v[80:83], a[132:135], v[132:135]
ds_read_b128 a[148:151], v17 offset:18432
v_mfma_f32_16x16x32_bf16 v[136:139], v[84:87], a[128:131], v[136:139]
buffer_load_dwordx4 v12, s[36:39], s86 offen offset:2048 lds
v_mfma_f32_16x16x32_bf16 v[140:143], v[84:87], a[132:135], v[140:143]
ds_read_b64_tr_b16 v[104:105], v20 offset:12288
s_add_u32 m0, s89, 101376
v_mfma_f32_16x16x32_bf16 v[160:163], v[88:91], a[128:131], v[160:163]
ds_read_b64_tr_b16 v[106:107], v20 offset:13056
v_mfma_f32_16x16x32_bf16 v[164:167], v[88:91], a[132:135], v[164:167]
ds_read_b64_tr_b16 v[108:109], v20 offset:15360
s_waitcnt lgkmcnt(5)
v_mfma_f32_16x16x32_bf16 v[168:171], v[92:95], a[128:131], v[168:171]
buffer_load_dwordx4 v10, s[40:43], s86 offen lds
v_mfma_f32_16x16x32_bf16 v[172:175], v[92:95], a[132:135], v[172:175]
ds_read_b64_tr_b16 v[110:111], v20 offset:16128
v_mfma_f32_16x16x32_bf16 v[192:195], v[96:99], a[128:131], v[192:195]
ds_read_b64_tr_b16 v[112:113], v21 offset:12288
v_mfma_f32_16x16x32_bf16 v[196:199], v[96:99], a[132:135], v[196:199]
ds_read_b64_tr_b16 v[114:115], v21 offset:13056
v_mfma_f32_16x16x32_bf16 v[200:203], v[100:103], a[128:131], v[200:203]
buffer_load_dwordx4 v11, s[40:43], s86 offen offset:1024 lds
v_mfma_f32_16x16x32_bf16 v[204:207], v[100:103], a[132:135], v[204:207]
v_mfma_f32_16x16x32_bf16 v[144:147], v[80:83], a[136:139], v[144:147]
ds_read_b128 a[152:155], v19 offset:16384
v_mfma_f32_16x16x32_bf16 v[148:151], v[80:83], a[140:143], v[148:151]
ds_read_b128 a[156:159], v19 offset:18432
v_mfma_f32_16x16x32_bf16 v[152:155], v[84:87], a[136:139], v[152:155]
ds_read_b64_tr_b16 v[116:117], v21 offset:15360
v_mfma_f32_16x16x32_bf16 v[156:159], v[84:87], a[140:143], v[156:159]
ds_read_b64_tr_b16 v[118:119], v21 offset:16128
v_mfma_f32_16x16x32_bf16 v[176:179], v[88:91], a[136:139], v[176:179]
ds_read_b64_tr_b16 v[120:121], v22 offset:12288
v_mfma_f32_16x16x32_bf16 v[180:183], v[88:91], a[140:143], v[180:183]
ds_read_b64_tr_b16 v[122:123], v22 offset:13056
v_mfma_f32_16x16x32_bf16 v[184:187], v[92:95], a[136:139], v[184:187]
ds_read_b64_tr_b16 v[124:125], v22 offset:15360
v_mfma_f32_16x16x32_bf16 v[188:191], v[92:95], a[140:143], v[188:191]
ds_read_b64_tr_b16 v[126:127], v22 offset:16128
v_mfma_f32_16x16x32_bf16 v[208:211], v[96:99], a[136:139], v[208:211]
v_mfma_f32_16x16x32_bf16 v[212:215], v[96:99], a[140:143], v[212:215]
v_mfma_f32_16x16x32_bf16 v[216:219], v[100:103], a[136:139], v[216:219]
buffer_load_dwordx4 v12, s[40:43], s86 offen offset:2048 lds
v_mfma_f32_16x16x32_bf16 v[220:223], v[100:103], a[140:143], v[220:223]
s_waitcnt lgkmcnt(0)
v_mfma_f32_16x16x32_bf16 v[128:131], v[104:107], a[144:147], v[128:131]
s_waitcnt vmcnt(10)
s_barrier
ds_read_b128 a[160:163], v16 offset:32768
v_mfma_f32_16x16x32_bf16 v[132:135], v[104:107], a[148:151], v[132:135]
ds_read_b128 a[164:167], v16 offset:34816
s_add_u32 m0, s87, 16384
s_add_u32 s84, s79, 896
s_and_b32 s84, s84, 0x380
v_mfma_f32_16x16x32_bf16 v[136:139], v[108:111], a[144:147], v[136:139]
buffer_load_dwordx4 v2, s[28:31], s84 offen lds
v_mfma_f32_16x16x32_bf16 v[140:143], v[108:111], a[148:151], v[140:143]
ds_read_b64_tr_b16 v[80:81], v20 offset:24576
v_mfma_f32_16x16x32_bf16 v[160:163], v[112:115], a[144:147], v[160:163]
ds_read_b64_tr_b16 v[82:83], v20 offset:25344
v_mfma_f32_16x16x32_bf16 v[164:167], v[112:115], a[148:151], v[164:167]
ds_read_b64_tr_b16 v[84:85], v20 offset:27648
v_mfma_f32_16x16x32_bf16 v[168:171], v[116:119], a[144:147], v[168:171]
buffer_load_dwordx4 v3, s[28:31], s84 offen offset:1024 lds
v_mfma_f32_16x16x32_bf16 v[172:175], v[116:119], a[148:151], v[172:175]
ds_read_b64_tr_b16 v[86:87], v20 offset:28416
v_mfma_f32_16x16x32_bf16 v[192:195], v[120:123], a[144:147], v[192:195]
ds_read_b64_tr_b16 v[88:89], v21 offset:24576
v_mfma_f32_16x16x32_bf16 v[196:199], v[120:123], a[148:151], v[196:199]
ds_read_b64_tr_b16 v[90:91], v21 offset:25344
v_mfma_f32_16x16x32_bf16 v[200:203], v[124:127], a[144:147], v[200:203]
buffer_load_dwordx4 v4, s[28:31], s84 offen offset:2048 lds
v_mfma_f32_16x16x32_bf16 v[204:207], v[124:127], a[148:151], v[204:207]
v_mfma_f32_16x16x32_bf16 v[144:147], v[104:107], a[152:155], v[144:147]
ds_read_b128 a[168:171], v18 offset:32768
v_mfma_f32_16x16x32_bf16 v[148:151], v[104:107], a[156:159], v[148:151]
ds_read_b128 a[172:175], v18 offset:34816
v_mfma_f32_16x16x32_bf16 v[152:155], v[108:111], a[152:155], v[152:155]
buffer_load_dwordx4 v5, s[28:31], s84 offen offset:3072 lds
v_mfma_f32_16x16x32_bf16 v[156:159], v[108:111], a[156:159], v[156:159]
ds_read_b64_tr_b16 v[92:93], v21 offset:27648
s_add_u32 m0, s89, 122880
v_mfma_f32_16x16x32_bf16 v[176:179], v[112:115], a[152:155], v[176:179]
ds_read_b64_tr_b16 v[94:95], v21 offset:28416
s_mul_i32 s86, s84, 1376
v_mfma_f32_16x16x32_bf16 v[180:183], v[112:115], a[156:159], v[180:183]
ds_read_b64_tr_b16 v[96:97], v22 offset:24576
v_mfma_f32_16x16x32_bf16 v[184:187], v[116:119], a[152:155], v[184:187]
buffer_load_dwordx4 v10, s[36:39], s86 offen lds
v_mfma_f32_16x16x32_bf16 v[188:191], v[116:119], a[156:159], v[188:191]
ds_read_b64_tr_b16 v[98:99], v22 offset:25344
v_mfma_f32_16x16x32_bf16 v[208:211], v[120:123], a[152:155], v[208:211]
ds_read_b64_tr_b16 v[100:101], v22 offset:27648
v_mfma_f32_16x16x32_bf16 v[212:215], v[120:123], a[156:159], v[212:215]
ds_read_b64_tr_b16 v[102:103], v22 offset:28416
v_mfma_f32_16x16x32_bf16 v[216:219], v[124:127], a[152:155], v[216:219]
buffer_load_dwordx4 v11, s[36:39], s86 offen offset:1024 lds
v_mfma_f32_16x16x32_bf16 v[220:223], v[124:127], a[156:159], v[220:223]
s_waitcnt lgkmcnt(8)
v_mfma_f32_16x16x32_bf16 v[128:131], v[80:83], a[160:163], v[128:131]
ds_read_b128 a[176:179], v17 offset:32768
v_mfma_f32_16x16x32_bf16 v[132:135], v[80:83], a[164:167], v[132:135]
ds_read_b128 a[180:183], v17 offset:34816
v_mfma_f32_16x16x32_bf16 v[136:139], v[84:87], a[160:163], v[136:139]
buffer_load_dwordx4 v12, s[36:39], s86 offen offset:2048 lds
v_mfma_f32_16x16x32_bf16 v[140:143], v[84:87], a[164:167], v[140:143]
ds_read_b64_tr_b16 v[104:105], v20 offset:36864
s_add_u32 m0, s89, 125952
v_mfma_f32_16x16x32_bf16 v[160:163], v[88:91], a[160:163], v[160:163]
ds_read_b64_tr_b16 v[106:107], v20 offset:37632
v_mfma_f32_16x16x32_bf16 v[164:167], v[88:91], a[164:167], v[164:167]
ds_read_b64_tr_b16 v[108:109], v20 offset:39936
s_waitcnt lgkmcnt(5)
v_mfma_f32_16x16x32_bf16 v[168:171], v[92:95], a[160:163], v[168:171]
buffer_load_dwordx4 v10, s[40:43], s86 offen lds
v_mfma_f32_16x16x32_bf16 v[172:175], v[92:95], a[164:167], v[172:175]
ds_read_b64_tr_b16 v[110:111], v20 offset:40704
v_mfma_f32_16x16x32_bf16 v[192:195], v[96:99], a[160:163], v[192:195]
ds_read_b64_tr_b16 v[112:113], v21 offset:36864
v_mfma_f32_16x16x32_bf16 v[196:199], v[96:99], a[164:167], v[196:199]
ds_read_b64_tr_b16 v[114:115], v21 offset:37632
v_mfma_f32_16x16x32_bf16 v[200:203], v[100:103], a[160:163], v[200:203]
buffer_load_dwordx4 v11, s[40:43], s86 offen offset:1024 lds
v_mfma_f32_16x16x32_bf16 v[204:207], v[100:103], a[164:167], v[204:207]
v_mfma_f32_16x16x32_bf16 v[144:147], v[80:83], a[168:171], v[144:147]
ds_read_b128 a[184:187], v19 offset:32768
v_mfma_f32_16x16x32_bf16 v[148:151], v[80:83], a[172:175], v[148:151]
ds_read_b128 a[188:191], v19 offset:34816
v_mfma_f32_16x16x32_bf16 v[152:155], v[84:87], a[168:171], v[152:155]
ds_read_b64_tr_b16 v[116:117], v21 offset:39936
v_mfma_f32_16x16x32_bf16 v[156:159], v[84:87], a[172:175], v[156:159]
ds_read_b64_tr_b16 v[118:119], v21 offset:40704
v_mfma_f32_16x16x32_bf16 v[176:179], v[88:91], a[168:171], v[176:179]
ds_read_b64_tr_b16 v[120:121], v22 offset:36864
v_mfma_f32_16x16x32_bf16 v[180:183], v[88:91], a[172:175], v[180:183]
ds_read_b64_tr_b16 v[122:123], v22 offset:37632
v_mfma_f32_16x16x32_bf16 v[184:187], v[92:95], a[168:171], v[184:187]
buffer_load_dwordx4 v12, s[40:43], s86 offen offset:2048 lds
v_mfma_f32_16x16x32_bf16 v[188:191], v[92:95], a[172:175], v[188:191]
ds_read_b64_tr_b16 v[124:125], v22 offset:39936
s_add_u32 s83, s79, 0
s_and_b32 s83, s83, 0x380
s_add_u32 m0, s88, 49152
s_mul_i32 s85, s83, 1536
v_mfma_f32_16x16x32_bf16 v[208:211], v[96:99], a[168:171], v[208:211]
buffer_load_dwordx4 v6, s[32:35], s85 offen lds
v_mfma_f32_16x16x32_bf16 v[212:215], v[96:99], a[172:175], v[212:215]
ds_read_b64_tr_b16 v[126:127], v22 offset:40704
v_mfma_f32_16x16x32_bf16 v[216:219], v[100:103], a[168:171], v[216:219]
buffer_load_dwordx4 v7, s[32:35], s85 offen offset:1024 lds
v_mfma_f32_16x16x32_bf16 v[220:223], v[100:103], a[172:175], v[220:223]
s_waitcnt lgkmcnt(0)
v_mfma_f32_16x16x32_bf16 v[128:131], v[104:107], a[176:179], v[128:131]
s_waitcnt vmcnt(12)
s_barrier
ds_read_b128 a[192:195], v16 offset:0
v_mfma_f32_16x16x32_bf16 v[132:135], v[104:107], a[180:183], v[132:135]
ds_read_b128 a[196:199], v16 offset:2048
s_add_u32 s83, s79, 128
v_mfma_f32_16x16x32_bf16 v[136:139], v[108:111], a[176:179], v[136:139]
ds_read_b64_tr_b16 v[80:81], v23 offset:0
s_and_b32 s83, s83, 0x380
v_mfma_f32_16x16x32_bf16 v[140:143], v[108:111], a[180:183], v[140:143]
ds_read_b64_tr_b16 v[82:83], v23 offset:768
s_add_u32 m0, s88, 57344
s_mul_i32 s85, s83, 1536
v_mfma_f32_16x16x32_bf16 v[160:163], v[112:115], a[176:179], v[160:163]
buffer_load_dwordx4 v6, s[32:35], s85 offen lds
v_mfma_f32_16x16x32_bf16 v[164:167], v[112:115], a[180:183], v[164:167]
ds_read_b64_tr_b16 v[84:85], v23 offset:3072
v_mfma_f32_16x16x32_bf16 v[168:171], v[116:119], a[176:179], v[168:171]
ds_read_b64_tr_b16 v[86:87], v23 offset:3840
v_mfma_f32_16x16x32_bf16 v[172:175], v[116:119], a[180:183], v[172:175]
ds_read_b64_tr_b16 v[88:89], v24 offset:0
v_mfma_f32_16x16x32_bf16 v[192:195], v[120:123], a[176:179], v[192:195]
ds_read_b64_tr_b16 v[90:91], v24 offset:768
v_mfma_f32_16x16x32_bf16 v[196:199], v[120:123], a[180:183], v[196:199]
v_mfma_f32_16x16x32_bf16 v[200:203], v[124:127], a[176:179], v[200:203]
buffer_load_dwordx4 v7, s[32:35], s85 offen offset:1024 lds
v_mfma_f32_16x16x32_bf16 v[204:207], v[124:127], a[180:183], v[204:207]
v_mfma_f32_16x16x32_bf16 v[144:147], v[104:107], a[184:187], v[144:147]
ds_read_b128 a[200:203], v18 offset:0
s_add_u32 s83, s79, 256
v_mfma_f32_16x16x32_bf16 v[148:151], v[104:107], a[188:191], v[148:151]
ds_read_b128 a[204:207], v18 offset:2048
s_and_b32 s83, s83, 0x380
v_mfma_f32_16x16x32_bf16 v[152:155], v[108:111], a[184:187], v[152:155]
ds_read_b64_tr_b16 v[92:93], v24 offset:3072
s_add_u32 m0, s88, 65536
v_mfma_f32_16x16x32_bf16 v[156:159], v[108:111], a[188:191], v[156:159]
ds_read_b64_tr_b16 v[94:95], v24 offset:3840
s_mul_i32 s85, s83, 1536
v_mfma_f32_16x16x32_bf16 v[176:179], v[112:115], a[184:187], v[176:179]
buffer_load_dwordx4 v6, s[32:35], s85 offen lds
v_mfma_f32_16x16x32_bf16 v[180:183], v[112:115], a[188:191], v[180:183]
ds_read_b64_tr_b16 v[96:97], v25 offset:0
v_mfma_f32_16x16x32_bf16 v[184:187], v[116:119], a[184:187], v[184:187]
ds_read_b64_tr_b16 v[98:99], v25 offset:768
v_mfma_f32_16x16x32_bf16 v[188:191], v[116:119], a[188:191], v[188:191]
ds_read_b64_tr_b16 v[100:101], v25 offset:3072
v_mfma_f32_16x16x32_bf16 v[208:211], v[120:123], a[184:187], v[208:211]
ds_read_b64_tr_b16 v[102:103], v25 offset:3840
v_mfma_f32_16x16x32_bf16 v[212:215], v[120:123], a[188:191], v[212:215]
v_mfma_f32_16x16x32_bf16 v[216:219], v[124:127], a[184:187], v[216:219]
buffer_load_dwordx4 v7, s[32:35], s85 offen offset:1024 lds
v_mfma_f32_16x16x32_bf16 v[220:223], v[124:127], a[188:191], v[220:223]
s_waitcnt lgkmcnt(8)
v_mfma_f32_16x16x32_bf16 v[128:131], v[80:83], a[192:195], v[128:131]
ds_read_b128 a[208:211], v17 offset:0
s_add_u32 s83, s79, 384
v_mfma_f32_16x16x32_bf16 v[132:135], v[80:83], a[196:199], v[132:135]
ds_read_b128 a[212:215], v17 offset:2048
s_and_b32 s83, s83, 0x380
v_mfma_f32_16x16x32_bf16 v[136:139], v[84:87], a[192:195], v[136:139]
ds_read_b64_tr_b16 v[104:105], v23 offset:12288
s_add_u32 m0, s88, 73728
v_mfma_f32_16x16x32_bf16 v[140:143], v[84:87], a[196:199], v[140:143]
ds_read_b64_tr_b16 v[106:107], v23 offset:13056
s_mul_i32 s85, s83, 1536
v_mfma_f32_16x16x32_bf16 v[160:163], v[88:91], a[192:195], v[160:163]
buffer_load_dwordx4 v6, s[32:35], s85 offen lds
v_mfma_f32_16x16x32_bf16 v[164:167], v[88:91], a[196:199], v[164:167]
ds_read_b64_tr_b16 v[108:109], v23 offset:15360
s_waitcnt lgkmcnt(5)
v_mfma_f32_16x16x32_bf16 v[168:171], v[92:95], a[192:195], v[168:171]
ds_read_b64_tr_b16 v[110:111], v23 offset:16128
v_mfma_f32_16x16x32_bf16 v[172:175], v[92:95], a[196:199], v[172:175]
ds_read_b64_tr_b16 v[112:113], v24 offset:12288
v_mfma_f32_16x16x32_bf16 v[192:195], v[96:99], a[192:195], v[192:195]
ds_read_b64_tr_b16 v[114:115], v24 offset:13056
v_mfma_f32_16x16x32_bf16 v[196:199], v[96:99], a[196:199], v[196:199]
v_mfma_f32_16x16x32_bf16 v[200:203], v[100:103], a[192:195], v[200:203]
buffer_load_dwordx4 v7, s[32:35], s85 offen offset:1024 lds
v_mfma_f32_16x16x32_bf16 v[204:207], v[100:103], a[196:199], v[204:207]
v_mfma_f32_16x16x32_bf16 v[144:147], v[80:83], a[200:203], v[144:147]
ds_read_b128 a[216:219], v19 offset:0
s_add_u32 s83, s79, 512
v_mfma_f32_16x16x32_bf16 v[148:151], v[80:83], a[204:207], v[148:151]
ds_read_b128 a[220:223], v19 offset:2048
s_and_b32 s83, s83, 0x380
v_mfma_f32_16x16x32_bf16 v[152:155], v[84:87], a[200:203], v[152:155]
ds_read_b64_tr_b16 v[116:117], v24 offset:15360
s_add_u32 m0, s88, 81920
v_mfma_f32_16x16x32_bf16 v[156:159], v[84:87], a[204:207], v[156:159]
ds_read_b64_tr_b16 v[118:119], v24 offset:16128
s_mul_i32 s85, s83, 1536
v_mfma_f32_16x16x32_bf16 v[176:179], v[88:91], a[200:203], v[176:179]
ds_read_b64_tr_b16 v[120:121], v25 offset:12288
v_mfma_f32_16x16x32_bf16 v[180:183], v[88:91], a[204:207], v[180:183]
ds_read_b64_tr_b16 v[122:123], v25 offset:13056
v_mfma_f32_16x16x32_bf16 v[184:187], v[92:95], a[200:203], v[184:187]
ds_read_b64_tr_b16 v[124:125], v25 offset:15360
v_mfma_f32_16x16x32_bf16 v[188:191], v[92:95], a[204:207], v[188:191]
ds_read_b64_tr_b16 v[126:127], v25 offset:16128
v_mfma_f32_16x16x32_bf16 v[208:211], v[96:99], a[200:203], v[208:211]
buffer_load_dwordx4 v6, s[32:35], s85 offen lds
v_mfma_f32_16x16x32_bf16 v[212:215], v[96:99], a[204:207], v[212:215]
v_mfma_f32_16x16x32_bf16 v[216:219], v[100:103], a[200:203], v[216:219]
buffer_load_dwordx4 v7, s[32:35], s85 offen offset:1024 lds
v_mfma_f32_16x16x32_bf16 v[220:223], v[100:103], a[204:207], v[220:223]
s_waitcnt lgkmcnt(0)
v_mfma_f32_16x16x32_bf16 v[128:131], v[104:107], a[208:211], v[128:131]
s_waitcnt vmcnt(10)
s_barrier
ds_read_b128 a[224:227], v16 offset:16384
v_mfma_f32_16x16x32_bf16 v[132:135], v[104:107], a[212:215], v[132:135]
ds_read_b128 a[228:231], v16 offset:18432
s_add_u32 s83, s79, 640
v_mfma_f32_16x16x32_bf16 v[136:139], v[108:111], a[208:211], v[136:139]
ds_read_b64_tr_b16 v[80:81], v23 offset:24576
s_and_b32 s83, s83, 0x380
v_mfma_f32_16x16x32_bf16 v[140:143], v[108:111], a[212:215], v[140:143]
ds_read_b64_tr_b16 v[82:83], v23 offset:25344
s_add_u32 m0, s88, 90112
s_mul_i32 s85, s83, 1536
v_mfma_f32_16x16x32_bf16 v[160:163], v[112:115], a[208:211], v[160:163]
buffer_load_dwordx4 v6, s[32:35], s85 offen lds
v_mfma_f32_16x16x32_bf16 v[164:167], v[112:115], a[212:215], v[164:167]
ds_read_b64_tr_b16 v[84:85], v23 offset:27648
v_mfma_f32_16x16x32_bf16 v[168:171], v[116:119], a[208:211], v[168:171]
ds_read_b64_tr_b16 v[86:87], v23 offset:28416
v_mfma_f32_16x16x32_bf16 v[172:175], v[116:119], a[212:215], v[172:175]
ds_read_b64_tr_b16 v[88:89], v24 offset:24576
v_mfma_f32_16x16x32_bf16 v[192:195], v[120:123], a[208:211], v[192:195]
ds_read_b64_tr_b16 v[90:91], v24 offset:25344
v_mfma_f32_16x16x32_bf16 v[196:199], v[120:123], a[212:215], v[196:199]
v_mfma_f32_16x16x32_bf16 v[200:203], v[124:127], a[208:211], v[200:203]
buffer_load_dwordx4 v7, s[32:35], s85 offen offset:1024 lds
v_mfma_f32_16x16x32_bf16 v[204:207], v[124:127], a[212:215], v[204:207]
v_lshrrev_b32 v68, 5, v1
v_bfe_u32 v69, v1, 2, 2
v_lshl_add_u32 v68, v68, 2, v69
v_mfma_f32_16x16x32_bf16 v[144:147], v[104:107], a[216:219], v[144:147]
ds_read_b128 a[232:235], v18 offset:16384
s_add_u32 m0, s87, 32768
v_mfma_f32_16x16x32_bf16 v[148:151], v[104:107], a[220:223], v[148:151]
ds_read_b128 a[236:239], v18 offset:18432
s_add_u32 s85, s13, 0
v_mfma_f32_16x16x32_bf16 v[152:155], v[108:111], a[216:219], v[152:155]
ds_read_b64_tr_b16 v[92:93], v24 offset:27648
v_mfma_f32_16x16x32_bf16 v[156:159], v[108:111], a[220:223], v[156:159]
ds_read_b64_tr_b16 v[94:95], v24 offset:28416
v_mfma_f32_16x16x32_bf16 v[176:179], v[112:115], a[216:219], v[176:179]
buffer_load_dwordx4 v32, s[44:47], s85 offen lds
v_mfma_f32_16x16x32_bf16 v[180:183], v[112:115], a[220:223], v[180:183]
ds_read_b64_tr_b16 v[96:97], v25 offset:24576
v_mfma_f32_16x16x32_bf16 v[184:187], v[116:119], a[216:219], v[184:187]
ds_read_b64_tr_b16 v[98:99], v25 offset:25344
v_mfma_f32_16x16x32_bf16 v[188:191], v[116:119], a[220:223], v[188:191]
ds_read_b64_tr_b16 v[100:101], v25 offset:27648
v_mfma_f32_16x16x32_bf16 v[208:211], v[120:123], a[216:219], v[208:211]
ds_read_b64_tr_b16 v[102:103], v25 offset:28416
v_mfma_f32_16x16x32_bf16 v[212:215], v[120:123], a[220:223], v[212:215]
v_mfma_f32_16x16x32_bf16 v[216:219], v[124:127], a[216:219], v[216:219]
buffer_load_dwordx4 v33, s[44:47], s85 offen offset:1024 lds
v_mfma_f32_16x16x32_bf16 v[220:223], v[124:127], a[220:223], v[220:223]
v_lshlrev_b32 v68, 5, v68
v_and_b32_e64 v69, 3, v1
v_lshl_add_u32 v68, v69, 3, v68
s_waitcnt lgkmcnt(8)
v_mfma_f32_16x16x32_bf16 v[128:131], v[80:83], a[224:227], v[128:131]
ds_read_b128 a[240:243], v17 offset:16384
v_mfma_f32_16x16x32_bf16 v[132:135], v[80:83], a[228:231], v[132:135]
ds_read_b128 a[244:247], v17 offset:18432
L_pad_Q_2:
s_cbranch_execz L_pad_Q_3
s_nop 0
v_mfma_f32_16x16x32_bf16 v[136:139], v[84:87], a[224:227], v[136:139]
ds_read_b64_tr_b16 v[104:105], v23 offset:36864
v_mfma_f32_16x16x32_bf16 v[140:143], v[84:87], a[228:231], v[140:143]
ds_read_b64_tr_b16 v[106:107], v23 offset:37632
v_mfma_f32_16x16x32_bf16 v[160:163], v[88:91], a[224:227], v[160:163]
buffer_load_dwordx4 v34, s[44:47], s85 offen offset:2048 lds
v_mfma_f32_16x16x32_bf16 v[164:167], v[88:91], a[228:231], v[164:167]
ds_read_b64_tr_b16 v[108:109], v23 offset:39936
s_waitcnt lgkmcnt(5)
v_mfma_f32_16x16x32_bf16 v[168:171], v[92:95], a[224:227], v[168:171]
ds_read_b64_tr_b16 v[110:111], v23 offset:40704
v_mfma_f32_16x16x32_bf16 v[172:175], v[92:95], a[228:231], v[172:175]
ds_read_b64_tr_b16 v[112:113], v24 offset:36864
v_mfma_f32_16x16x32_bf16 v[192:195], v[96:99], a[224:227], v[192:195]
ds_read_b64_tr_b16 v[114:115], v24 offset:37632
v_mfma_f32_16x16x32_bf16 v[196:199], v[96:99], a[228:231], v[196:199]
v_mfma_f32_16x16x32_bf16 v[200:203], v[100:103], a[224:227], v[200:203]
buffer_load_dwordx4 v35, s[44:47], s85 offen offset:3072 lds
v_mfma_f32_16x16x32_bf16 v[204:207], v[100:103], a[228:231], v[204:207]
v_bfe_u32 v69, v1, 4, 1
v_lshl_add_u32 v68, v69, 9, v68
s_lshr_b32 s91, s87, 2
v_mfma_f32_16x16x32_bf16 v[144:147], v[80:83], a[232:235], v[144:147]
ds_read_b128 a[248:251], v19 offset:16384
s_add_u32 s83, s79, 768
v_mfma_f32_16x16x32_bf16 v[148:151], v[80:83], a[236:239], v[148:151]
ds_read_b128 a[252:255], v19 offset:18432
s_and_b32 s83, s83, 0x380
v_mfma_f32_16x16x32_bf16 v[152:155], v[84:87], a[232:235], v[152:155]
ds_read_b64_tr_b16 v[116:117], v24 offset:39936
s_add_u32 m0, s88, 0
v_mfma_f32_16x16x32_bf16 v[156:159], v[84:87], a[236:239], v[156:159]
ds_read_b64_tr_b16 v[118:119], v24 offset:40704
s_mul_i32 s85, s83, 1536
v_mfma_f32_16x16x32_bf16 v[176:179], v[88:91], a[232:235], v[176:179]
ds_read_b64_tr_b16 v[120:121], v25 offset:36864
v_mfma_f32_16x16x32_bf16 v[180:183], v[88:91], a[236:239], v[180:183]
ds_read_b64_tr_b16 v[122:123], v25 offset:37632
v_mfma_f32_16x16x32_bf16 v[184:187], v[92:95], a[232:235], v[184:187]
ds_read_b64_tr_b16 v[124:125], v25 offset:39936
v_mfma_f32_16x16x32_bf16 v[188:191], v[92:95], a[236:239], v[188:191]
ds_read_b64_tr_b16 v[126:127], v25 offset:40704
v_mfma_f32_16x16x32_bf16 v[208:211], v[96:99], a[232:235], v[208:211]
buffer_load_dwordx4 v6, s[32:35], s85 offen lds
v_mfma_f32_16x16x32_bf16 v[212:215], v[96:99], a[236:239], v[212:215]
v_mfma_f32_16x16x32_bf16 v[216:219], v[100:103], a[232:235], v[216:219]
buffer_load_dwordx4 v7, s[32:35], s85 offen offset:1024 lds
v_mfma_f32_16x16x32_bf16 v[220:223], v[100:103], a[236:239], v[220:223]
s_add_u32 s91, s91, 147456
v_add_u32 v68, s91, v68
s_waitcnt lgkmcnt(0)
v_mfma_f32_16x16x32_bf16 v[128:131], v[104:107], a[240:243], v[128:131]
s_barrier
s_add_u32 s83, s79, 896
v_mfma_f32_16x16x32_bf16 v[132:135], v[104:107], a[244:247], v[132:135]
s_and_b32 s83, s83, 0x380
s_add_u32 m0, s88, 8192
s_mul_i32 s85, s83, 1536
v_mfma_f32_16x16x32_bf16 v[136:139], v[108:111], a[240:243], v[136:139]
v_mfma_f32_16x16x32_bf16 v[140:143], v[108:111], a[244:247], v[140:143]
v_mfma_f32_16x16x32_bf16 v[160:163], v[112:115], a[240:243], v[160:163]
buffer_load_dwordx4 v6, s[32:35], s85 offen lds
v_mfma_f32_16x16x32_bf16 v[164:167], v[112:115], a[244:247], v[164:167]
v_mfma_f32_16x16x32_bf16 v[168:171], v[116:119], a[240:243], v[168:171]
v_mfma_f32_16x16x32_bf16 v[172:175], v[116:119], a[244:247], v[172:175]
v_mfma_f32_16x16x32_bf16 v[192:195], v[120:123], a[240:243], v[192:195]
v_mfma_f32_16x16x32_bf16 v[196:199], v[120:123], a[244:247], v[196:199]
v_mfma_f32_16x16x32_bf16 v[200:203], v[124:127], a[240:243], v[200:203]
buffer_load_dwordx4 v7, s[32:35], s85 offen offset:1024 lds
v_mfma_f32_16x16x32_bf16 v[204:207], v[124:127], a[244:247], v[204:207]
ds_read_b64_tr_b16 v[64:65], v68
ds_read_b64_tr_b16 v[66:67], v68 offset:256
v_mfma_f32_16x16x32_bf16 v[144:147], v[104:107], a[248:251], v[144:147]
s_add_u32 m0, s87, 98304
s_add_u32 s85, s13, 32768
v_mfma_f32_16x16x32_bf16 v[148:151], v[104:107], a[252:255], v[148:151]
v_mfma_f32_16x16x32_bf16 v[152:155], v[108:111], a[248:251], v[152:155]
v_mfma_f32_16x16x32_bf16 v[156:159], v[108:111], a[252:255], v[156:159]
v_mfma_f32_16x16x32_bf16 v[176:179], v[112:115], a[248:251], v[176:179]
buffer_load_dwordx4 v32, s[44:47], s85 offen lds
v_mfma_f32_16x16x32_bf16 v[180:183], v[112:115], a[252:255], v[180:183]
v_mfma_f32_16x16x32_bf16 v[184:187], v[116:119], a[248:251], v[184:187]
v_mfma_f32_16x16x32_bf16 v[188:191], v[116:119], a[252:255], v[188:191]
v_mfma_f32_16x16x32_bf16 v[208:211], v[120:123], a[248:251], v[208:211]
v_mfma_f32_16x16x32_bf16 v[212:215], v[120:123], a[252:255], v[212:215]
v_mfma_f32_16x16x32_bf16 v[216:219], v[124:127], a[248:251], v[216:219]
buffer_load_dwordx4 v33, s[44:47], s85 offen offset:1024 lds
v_mfma_f32_16x16x32_bf16 v[220:223], v[124:127], a[252:255], v[220:223]
s_load_dword s68, s[24:25], 0
v_pk_mul_f32 v[80:81], v[128:129], v[128:129]
v_pk_mul_f32 v[82:83], v[130:131], v[130:131]
v_pk_mul_f32 v[84:85], v[132:133], v[132:133]
v_pk_mul_f32 v[86:87], v[134:135], v[134:135]
v_pk_fma_f32 v[80:81], v[80:81], v[48:49], v[48:49] op_sel:[0,0,1] op_sel_hi:[1,0,1]
v_pk_fma_f32 v[82:83], v[82:83], v[48:49], v[48:49] op_sel:[0,0,1] op_sel_hi:[1,0,1]
v_pk_fma_f32 v[84:85], v[84:85], v[48:49], v[48:49] op_sel:[0,0,1] op_sel_hi:[1,0,1]
v_pk_fma_f32 v[86:87], v[86:87], v[48:49], v[48:49] op_sel:[0,0,1] op_sel_hi:[1,0,1]
v_pk_mul_f32 v[80:81], v[80:81], v[128:129]
v_pk_mul_f32 v[82:83], v[82:83], v[130:131]
v_pk_mul_f32 v[84:85], v[84:85], v[132:133]
v_pk_mul_f32 v[86:87], v[86:87], v[134:135]
v_exp_f32 v80, v80
v_exp_f32_e64 v81, v81
buffer_load_dwordx4 v34, s[44:47], s85 offen offset:2048 lds
v_pk_mul_f32 v[88:89], v[128:129], v[136:137]
v_exp_f32 v82, v82
v_exp_f32 v83, v83
v_pk_mul_f32 v[90:91], v[130:131], v[138:139]
v_exp_f32 v84, v84
v_exp_f32 v85, v85
v_pk_mul_f32 v[92:93], v[132:133], v[140:141]
v_exp_f32 v86, v86
v_exp_f32 v87, v87
v_pk_mul_f32 v[94:95], v[134:135], v[142:143]
buffer_load_dwordx4 v35, s[44:47], s85 offen offset:3072 lds
v_pk_add_f32 v[80:81], v[80:81], 1.0 op_sel_hi:[1,0]
v_pk_add_f32 v[82:83], v[82:83], 1.0 op_sel_hi:[1,0]
v_pk_add_f32 v[84:85], v[84:85], 1.0 op_sel_hi:[1,0]
v_pk_add_f32 v[86:87], v[86:87], 1.0 op_sel_hi:[1,0]
v_rcp_f32 v80, v80
v_rcp_f32 v81, v81
v_rcp_f32 v82, v82
v_rcp_f32 v83, v83
v_rcp_f32 v84, v84
v_rcp_f32 v85, v85
s_add_u32 m0, s87, 16384
s_add_u32 s85, s23, 0
buffer_load_dwordx4 v32, s[44:47], s85 offen lds
v_rcp_f32 v86, v86
v_rcp_f32_e64 v87, v87
v_pk_mul_f32 v[88:89], v[88:89], v[80:81]
v_pk_mul_f32 v[90:91], v[90:91], v[82:83]
v_pk_mul_f32 v[92:93], v[92:93], v[84:85]
v_pk_mul_f32 v[94:95], v[94:95], v[86:87]
v_cvt_pk_bf16_f32 v128, v88, v89
v_cvt_pk_bf16_f32 v129, v90, v91
v_cvt_pk_bf16_f32 v130, v92, v93
v_cvt_pk_bf16_f32 v131, v94, v95
v_pk_mul_f32 v[80:81], v[144:145], v[144:145]
v_pk_mul_f32 v[82:83], v[146:147], v[146:147]
v_pk_mul_f32 v[84:85], v[148:149], v[148:149]
v_pk_mul_f32 v[86:87], v[150:151], v[150:151]
buffer_load_dwordx4 v33, s[44:47], s85 offen offset:1024 lds
v_pk_fma_f32 v[80:81], v[80:81], v[48:49], v[48:49] op_sel:[0,0,1] op_sel_hi:[1,0,1]
v_pk_fma_f32 v[82:83], v[82:83], v[48:49], v[48:49] op_sel:[0,0,1] op_sel_hi:[1,0,1]
v_pk_fma_f32 v[84:85], v[84:85], v[48:49], v[48:49] op_sel:[0,0,1] op_sel_hi:[1,0,1]
v_pk_fma_f32 v[86:87], v[86:87], v[48:49], v[48:49] op_sel:[0,0,1] op_sel_hi:[1,0,1]
v_pk_mul_f32 v[80:81], v[80:81], v[144:145]
v_pk_mul_f32 v[82:83], v[82:83], v[146:147]
v_pk_mul_f32 v[84:85], v[84:85], v[148:149]
v_pk_mul_f32 v[86:87], v[86:87], v[150:151]
v_exp_f32 v80, v80
v_exp_f32 v81, v81
v_pk_mul_f32 v[88:89], v[144:145], v[152:153]
v_exp_f32 v82, v82
v_exp_f32 v83, v83
buffer_load_dwordx4 v34, s[44:47], s85 offen offset:2048 lds
v_pk_mul_f32 v[90:91], v[146:147], v[154:155]
v_exp_f32 v84, v84
v_exp_f32 v85, v85
v_pk_mul_f32 v[92:93], v[148:149], v[156:157]
v_exp_f32 v86, v86
v_exp_f32 v87, v87
v_pk_mul_f32 v[94:95], v[150:151], v[158:159]
v_pk_add_f32 v[80:81], v[80:81], 1.0 op_sel_hi:[1,0]
v_pk_add_f32 v[82:83], v[82:83], 1.0 op_sel_hi:[1,0]
v_pk_add_f32 v[84:85], v[84:85], 1.0 op_sel_hi:[1,0]
v_pk_add_f32 v[86:87], v[86:87], 1.0 op_sel_hi:[1,0]
v_rcp_f32_e64 v80, v80
buffer_load_dwordx4 v35, s[44:47], s85 offen offset:3072 lds
v_rcp_f32 v81, v81
v_rcp_f32 v82, v82
v_rcp_f32 v83, v83
v_rcp_f32 v84, v84
v_rcp_f32 v85, v85
v_rcp_f32 v86, v86
v_rcp_f32_e64 v87, v87
v_pk_mul_f32 v[88:89], v[88:89], v[80:81]
v_pk_mul_f32 v[90:91], v[90:91], v[82:83]
s_add_u32 m0, s87, 114688
s_add_u32 s85, s23, 32768
buffer_load_dwordx4 v32, s[44:47], s85 offen lds
v_pk_mul_f32 v[92:93], v[92:93], v[84:85]
v_pk_mul_f32 v[94:95], v[94:95], v[86:87]
v_cvt_pk_bf16_f32 v144, v88, v89
v_cvt_pk_bf16_f32 v145, v90, v91
v_cvt_pk_bf16_f32 v146, v92, v93
v_cvt_pk_bf16_f32 v147, v94, v95
v_pk_mul_f32 v[80:81], v[160:161], v[160:161]
v_pk_mul_f32 v[82:83], v[162:163], v[162:163]
v_pk_mul_f32 v[84:85], v[164:165], v[164:165]
v_pk_mul_f32 v[86:87], v[166:167], v[166:167]
v_pk_fma_f32 v[80:81], v[80:81], v[48:49], v[48:49] op_sel:[0,0,1] op_sel_hi:[1,0,1]
v_pk_fma_f32 v[82:83], v[82:83], v[48:49], v[48:49] op_sel:[0,0,1] op_sel_hi:[1,0,1]
v_pk_fma_f32 v[84:85], v[84:85], v[48:49], v[48:49] op_sel:[0,0,1] op_sel_hi:[1,0,1]
v_pk_fma_f32 v[86:87], v[86:87], v[48:49], v[48:49] op_sel:[0,0,1] op_sel_hi:[1,0,1]
v_pk_mul_f32 v[80:81], v[80:81], v[160:161]
v_pk_mul_f32 v[82:83], v[82:83], v[162:163]
buffer_load_dwordx4 v33, s[44:47], s85 offen offset:1024 lds
v_pk_mul_f32 v[84:85], v[84:85], v[164:165]
v_pk_mul_f32 v[86:87], v[86:87], v[166:167]
v_exp_f32 v80, v80
v_exp_f32 v81, v81
v_pk_mul_f32 v[88:89], v[160:161], v[168:169]
v_exp_f32 v82, v82
v_exp_f32 v83, v83
v_pk_mul_f32 v[90:91], v[162:163], v[170:171]
v_exp_f32 v84, v84
v_exp_f32 v85, v85
buffer_load_dwordx4 v34, s[44:47], s85 offen offset:2048 lds
v_pk_mul_f32 v[92:93], v[164:165], v[172:173]
v_exp_f32 v86, v86
v_exp_f32 v87, v87
v_pk_mul_f32 v[94:95], v[166:167], v[174:175]
v_pk_add_f32 v[80:81], v[80:81], 1.0 op_sel_hi:[1,0]
v_pk_add_f32 v[82:83], v[82:83], 1.0 op_sel_hi:[1,0]
v_pk_add_f32 v[84:85], v[84:85], 1.0 op_sel_hi:[1,0]
v_pk_add_f32 v[86:87], v[86:87], 1.0 op_sel_hi:[1,0]
v_rcp_f32 v80, v80
v_rcp_f32 v81, v81
v_rcp_f32_e64 v82, v82
buffer_load_dwordx4 v35, s[44:47], s85 offen offset:3072 lds
v_rcp_f32 v83, v83
v_rcp_f32 v84, v84
v_rcp_f32 v85, v85
v_rcp_f32 v86, v86
v_rcp_f32_e64 v87, v87
v_pk_mul_f32 v[88:89], v[88:89], v[80:81]
v_pk_mul_f32 v[90:91], v[90:91], v[82:83]
v_pk_mul_f32 v[92:93], v[92:93], v[84:85]
v_pk_mul_f32 v[94:95], v[94:95], v[86:87]
v_cvt_pk_bf16_f32 v160, v88, v89
v_cvt_pk_bf16_f32 v161, v90, v91
s_add_u32 m0, s87, 131072
s_add_u32 s85, s4, 0
buffer_load_dwordx4 v32, s[48:51], s85 offen lds
v_cvt_pk_bf16_f32 v162, v92, v93
v_cvt_pk_bf16_f32 v163, v94, v95
v_pk_mul_f32 v[80:81], v[176:177], v[176:177]
v_pk_mul_f32 v[82:83], v[178:179], v[178:179]
v_pk_mul_f32 v[84:85], v[180:181], v[180:181]
v_pk_mul_f32 v[86:87], v[182:183], v[182:183]
v_pk_fma_f32 v[80:81], v[80:81], v[48:49], v[48:49] op_sel:[0,0,1] op_sel_hi:[1,0,1]
v_pk_fma_f32 v[82:83], v[82:83], v[48:49], v[48:49] op_sel:[0,0,1] op_sel_hi:[1,0,1]
v_pk_fma_f32 v[84:85], v[84:85], v[48:49], v[48:49] op_sel:[0,0,1] op_sel_hi:[1,0,1]
v_pk_fma_f32 v[86:87], v[86:87], v[48:49], v[48:49] op_sel:[0,0,1] op_sel_hi:[1,0,1]
v_pk_mul_f32 v[80:81], v[80:81], v[176:177]
v_pk_mul_f32 v[82:83], v[82:83], v[178:179]
v_pk_mul_f32 v[84:85], v[84:85], v[180:181]
v_pk_mul_f32 v[86:87], v[86:87], v[182:183]
v_exp_f32 v80, v80
buffer_load_dwordx4 v33, s[48:51], s85 offen offset:1024 lds
v_exp_f32_e64 v81, v81
v_pk_mul_f32 v[88:89], v[176:177], v[184:185]
v_exp_f32 v82, v82
v_exp_f32 v83, v83
v_pk_mul_f32 v[90:91], v[178:179], v[186:187]
v_exp_f32 v84, v84
v_exp_f32 v85, v85
v_pk_mul_f32 v[92:93], v[180:181], v[188:189]
v_exp_f32 v86, v86
v_exp_f32 v87, v87
buffer_load_dwordx4 v34, s[48:51], s85 offen offset:2048 lds
v_pk_mul_f32 v[94:95], v[182:183], v[190:191]
v_pk_add_f32 v[80:81], v[80:81], 1.0 op_sel_hi:[1,0]
v_pk_add_f32 v[82:83], v[82:83], 1.0 op_sel_hi:[1,0]
v_pk_add_f32 v[84:85], v[84:85], 1.0 op_sel_hi:[1,0]
v_pk_add_f32 v[86:87], v[86:87], 1.0 op_sel_hi:[1,0]
v_rcp_f32 v80, v80
v_rcp_f32 v81, v81
v_rcp_f32 v82, v82
v_rcp_f32 v83, v83
v_rcp_f32 v84, v84
v_rcp_f32 v85, v85
buffer_load_dwordx4 v35, s[48:51], s85 offen offset:3072 lds
v_rcp_f32 v86, v86
v_rcp_f32 v87, v87
v_pk_mul_f32 v[88:89], v[88:89], v[80:81]
v_pk_mul_f32 v[90:91], v[90:91], v[82:83]
v_pk_mul_f32 v[92:93], v[92:93], v[84:85]
v_pk_mul_f32 v[94:95], v[94:95], v[86:87]
v_cvt_pk_bf16_f32 v176, v88, v89
v_cvt_pk_bf16_f32 v177, v90, v91
v_cvt_pk_bf16_f32 v178, v92, v93
v_cvt_pk_bf16_f32 v179, v94, v95
v_permlane16_swap_b32 v128, v130
v_permlane16_swap_b32 v129, v131
buffer_store_dwordx4 v[128:131], v38, s[52:55], s92 offen offset:0 sc1
v_permlane16_swap_b32 v144, v146
v_permlane16_swap_b32 v145, v147
buffer_store_dwordx4 v[144:147], v38, s[52:55], s92 offen offset:1024 sc1
v_permlane16_swap_b32 v160, v162
v_permlane16_swap_b32 v161, v163
buffer_store_dwordx4 v[160:163], v38, s[52:55], s92 offen offset:2048 sc1
v_permlane16_swap_b32 v176, v178
v_permlane16_swap_b32 v177, v179
buffer_store_dwordx4 v[176:179], v38, s[52:55], s92 offen offset:3072 sc1
s_waitcnt lgkmcnt(0)
s_bfe_u32 s97, s68, 524288
s_cmp_lt_u32 s97, 16
s_cbranch_scc1 L_slow_Q0
L_back_Q0:
v_pk_mul_f32 v[80:81], v[192:193], v[192:193]
v_pk_mul_f32 v[82:83], v[194:195], v[194:195]
v_pk_mul_f32 v[84:85], v[196:197], v[196:197]
v_pk_mul_f32 v[86:87], v[198:199], v[198:199]
v_pk_fma_f32 v[80:81], v[80:81], v[48:49], v[48:49] op_sel:[0,0,1] op_sel_hi:[1,0,1]
v_pk_fma_f32 v[82:83], v[82:83], v[48:49], v[48:49] op_sel:[0,0,1] op_sel_hi:[1,0,1]
v_pk_fma_f32 v[84:85], v[84:85], v[48:49], v[48:49] op_sel:[0,0,1] op_sel_hi:[1,0,1]
v_pk_fma_f32 v[86:87], v[86:87], v[48:49], v[48:49] op_sel:[0,0,1] op_sel_hi:[1,0,1]
v_pk_mul_f32 v[80:81], v[80:81], v[192:193]
v_pk_mul_f32 v[82:83], v[82:83], v[194:195]
v_pk_mul_f32 v[84:85], v[84:85], v[196:197]
v_pk_mul_f32 v[86:87], v[86:87], v[198:199]
v_exp_f32 v80, v80
v_exp_f32_e64 v81, v81
v_pk_mul_f32 v[88:89], v[192:193], v[200:201]
v_exp_f32 v82, v82
v_exp_f32 v83, v83
v_pk_mul_f32 v[90:91], v[194:195], v[202:203]
v_exp_f32 v84, v84
v_exp_f32 v85, v85
v_pk_mul_f32 v[92:93], v[196:197], v[204:205]
v_exp_f32 v86, v86
v_exp_f32 v87, v87
v_pk_mul_f32 v[94:95], v[198:199], v[206:207]
v_pk_add_f32 v[80:81], v[80:81], 1.0 op_sel_hi:[1,0]
v_pk_add_f32 v[82:83], v[82:83], 1.0 op_sel_hi:[1,0]
v_pk_add_f32 v[84:85], v[84:85], 1.0 op_sel_hi:[1,0]
v_pk_add_f32 v[86:87], v[86:87], 1.0 op_sel_hi:[1,0]
v_rcp_f32 v80, v80
v_rcp_f32 v81, v81
v_rcp_f32 v82, v82
v_rcp_f32 v83, v83
v_rcp_f32 v84, v84
v_rcp_f32 v85, v85
v_rcp_f32 v86, v86
v_rcp_f32 v87, v87
v_pk_mul_f32 v[88:89], v[88:89], v[80:81]
v_pk_mul_f32 v[90:91], v[90:91], v[82:83]
v_pk_mul_f32 v[92:93], v[92:93], v[84:85]
v_pk_mul_f32 v[94:95], v[94:95], v[86:87]
v_cvt_pk_bf16_f32 v192, v88, v89
v_cvt_pk_bf16_f32 v193, v90, v91
v_cvt_pk_bf16_f32 v194, v92, v93
v_cvt_pk_bf16_f32 v195, v94, v95
s_waitcnt vmcnt(20)
s_barrier
ds_read_b64_tr_b16 v[96:97], v62 offset:0
ds_read_b64_tr_b16 v[98:99], v62 offset:512
ds_read_b64_tr_b16 v[100:101], v63 offset:0
ds_read_b64_tr_b16 v[102:103], v63 offset:512
ds_read_b64_tr_b16 v[104:105], v62 offset:4096
ds_read_b64_tr_b16 v[106:107], v62 offset:4608
v_pk_mul_f32 v[80:81], v[208:209], v[208:209]
v_pk_mul_f32 v[82:83], v[210:211], v[210:211]
v_pk_mul_f32 v[84:85], v[212:213], v[212:213]
v_pk_mul_f32 v[86:87], v[214:215], v[214:215]
v_pk_fma_f32 v[80:81], v[80:81], v[48:49], v[48:49] op_sel:[0,0,1] op_sel_hi:[1,0,1]
v_pk_fma_f32 v[82:83], v[82:83], v[48:49], v[48:49] op_sel:[0,0,1] op_sel_hi:[1,0,1]
v_pk_fma_f32 v[84:85], v[84:85], v[48:49], v[48:49] op_sel:[0,0,1] op_sel_hi:[1,0,1]
v_pk_fma_f32 v[86:87], v[86:87], v[48:49], v[48:49] op_sel:[0,0,1] op_sel_hi:[1,0,1]
v_pk_mul_f32 v[80:81], v[80:81], v[208:209]
v_pk_mul_f32 v[82:83], v[82:83], v[210:211]
v_pk_mul_f32 v[84:85], v[84:85], v[212:213]
v_pk_mul_f32 v[86:87], v[86:87], v[214:215]
v_exp_f32 v80, v80
v_exp_f32 v81, v81
v_pk_mul_f32 v[88:89], v[208:209], v[216:217]
v_exp_f32 v82, v82
v_exp_f32 v83, v83
v_pk_mul_f32 v[90:91], v[210:211], v[218:219]
v_exp_f32 v84, v84
v_exp_f32 v85, v85
v_pk_mul_f32 v[92:93], v[212:213], v[220:221]
v_exp_f32 v86, v86
v_exp_f32 v87, v87
v_pk_mul_f32 v[94:95], v[214:215], v[222:223]
v_pk_add_f32 v[80:81], v[80:81], 1.0 op_sel_hi:[1,0]
v_pk_add_f32 v[82:83], v[82:83], 1.0 op_sel_hi:[1,0]
v_pk_add_f32 v[84:85], v[84:85], 1.0 op_sel_hi:[1,0]
v_pk_add_f32 v[86:87], v[86:87], 1.0 op_sel_hi:[1,0]
v_rcp_f32 v80, v80
v_rcp_f32 v81, v81
v_rcp_f32 v82, v82
v_rcp_f32 v83, v83
v_rcp_f32 v84, v84
v_rcp_f32 v85, v85
v_rcp_f32 v86, v86
v_rcp_f32 v87, v87
v_pk_mul_f32 v[88:89], v[88:89], v[80:81]
v_pk_mul_f32 v[90:91], v[90:91], v[82:83]
v_pk_mul_f32 v[92:93], v[92:93], v[84:85]
v_pk_mul_f32 v[94:95], v[94:95], v[86:87]
v_cvt_pk_bf16_f32 v208, v88, v89
v_cvt_pk_bf16_f32 v209, v90, v91
v_cvt_pk_bf16_f32 v210, v92, v93
v_cvt_pk_bf16_f32 v211, v94, v95
v_permlane16_swap_b32 v192, v194
v_permlane16_swap_b32 v193, v195
buffer_store_dwordx4 v[192:195], v38, s[52:55], s93 offen offset:0 sc1
v_permlane16_swap_b32 v208, v210
v_permlane16_swap_b32 v209, v211
buffer_store_dwordx4 v[208:211], v38, s[52:55], s93 offen offset:1024 sc1
s_waitcnt lgkmcnt(4)
v_mfma_f32_16x16x32_bf16 v[224:227], v[96:99], a[0:3], 0
ds_read_b64_tr_b16 v[108:109], v63 offset:4096
v_mfma_f32_16x16x32_bf16 v[228:231], v[96:99], a[4:7], 0
ds_read_b64_tr_b16 v[110:111], v63 offset:4608
s_waitcnt lgkmcnt(4)
v_mfma_f32_16x16x32_bf16 v[232:235], v[100:103], a[0:3], 0
v_mfma_f32_16x16x32_bf16 v[236:239], v[100:103], a[4:7], 0
v_mfma_f32_16x16x32_bf16 v[240:243], v[96:99], a[8:11], 0
ds_read_b64_tr_b16 v[112:113], v62 offset:8192
v_mfma_f32_16x16x32_bf16 v[244:247], v[96:99], a[12:15], 0
ds_read_b64_tr_b16 v[114:115], v62 offset:8704
v_mfma_f32_16x16x32_bf16 v[248:251], v[100:103], a[8:11], 0
ds_read_b64_tr_b16 a[0:1], v40 offset:32768
v_mfma_f32_16x16x32_bf16 v[252:255], v[100:103], a[12:15], 0
ds_read_b64_tr_b16 a[2:3], v40 offset:33792
s_waitcnt lgkmcnt(6)
v_mfma_f32_16x16x32_bf16 v[224:227], v[104:107], a[16:19], v[224:227]
ds_read_b64_tr_b16 v[116:117], v63 offset:8192
v_mfma_f32_16x16x32_bf16 v[228:231], v[104:107], a[20:23], v[228:231]
ds_read_b64_tr_b16 v[118:119], v63 offset:8704
s_waitcnt lgkmcnt(6)
v_mfma_f32_16x16x32_bf16 v[232:235], v[108:111], a[16:19], v[232:235]
ds_read_b64_tr_b16 a[4:5], v13 offset:32768
v_mfma_f32_16x16x32_bf16 v[236:239], v[108:111], a[20:23], v[236:239]
ds_read_b64_tr_b16 a[6:7], v13 offset:33792
v_mfma_f32_16x16x32_bf16 v[240:243], v[104:107], a[24:27], v[240:243]
ds_read_b64_tr_b16 v[96:97], v62 offset:12288
v_mfma_f32_16x16x32_bf16 v[244:247], v[104:107], a[28:31], v[244:247]
ds_read_b64_tr_b16 v[98:99], v62 offset:12800
v_mfma_f32_16x16x32_bf16 v[248:251], v[108:111], a[24:27], v[248:251]
ds_read_b64_tr_b16 a[8:9], v40 offset:33024
v_mfma_f32_16x16x32_bf16 v[252:255], v[108:111], a[28:31], v[252:255]
ds_read_b64_tr_b16 a[10:11], v40 offset:34048
s_waitcnt lgkmcnt(10)
v_mfma_f32_16x16x32_bf16 v[224:227], v[112:115], a[32:35], v[224:227]
ds_read_b64_tr_b16 v[100:101], v63 offset:12288
v_mfma_f32_16x16x32_bf16 v[228:231], v[112:115], a[36:39], v[228:231]
ds_read_b64_tr_b16 v[102:103], v63 offset:12800
s_waitcnt lgkmcnt(8)
v_mfma_f32_16x16x32_bf16 v[232:235], v[116:119], a[32:35], v[232:235]
ds_read_b64_tr_b16 a[12:13], v13 offset:33024
v_mfma_f32_16x16x32_bf16 v[236:239], v[116:119], a[36:39], v[236:239]
ds_read_b64_tr_b16 a[14:15], v13 offset:34048
s_waitcnt lgkmcnt(0)
v_mfma_f32_16x16x32_bf16 v[240:243], v[112:115], a[40:43], v[240:243]
s_barrier
s_waitcnt vmcnt(18)
ds_read_b64_tr_b16 v[104:105], v62 offset:16384
ds_read_b64_tr_b16 v[106:107], v62 offset:16896
v_mfma_f32_16x16x32_bf16 v[244:247], v[112:115], a[44:47], v[244:247]
ds_read_b64_tr_b16 a[16:17], v41 offset:32768
s_add_u32 m0, s87, 49152
s_add_u32 s85, s4, 32768
v_mfma_f32_16x16x32_bf16 v[248:251], v[116:119], a[40:43], v[248:251]
buffer_load_dwordx4 v32, s[48:51], s85 offen lds
v_mfma_f32_16x16x32_bf16 v[252:255], v[116:119], a[44:47], v[252:255]
ds_read_b64_tr_b16 a[18:19], v41 offset:33792
v_mfma_f32_16x16x32_bf16 v[224:227], v[96:99], a[48:51], v[224:227]
ds_read_b64_tr_b16 v[108:109], v63 offset:16384
ds_read_b64_tr_b16 v[110:111], v63 offset:16896
v_mfma_f32_16x16x32_bf16 v[228:231], v[96:99], a[52:55], v[228:231]
ds_read_b64_tr_b16 a[20:21], v14 offset:32768
v_mfma_f32_16x16x32_bf16 v[232:235], v[100:103], a[48:51], v[232:235]
buffer_load_dwordx4 v33, s[48:51], s85 offen offset:1024 lds
v_mfma_f32_16x16x32_bf16 v[236:239], v[100:103], a[52:55], v[236:239]
ds_read_b64_tr_b16 a[22:23], v14 offset:33792
v_mfma_f32_16x16x32_bf16 v[240:243], v[96:99], a[56:59], v[240:243]
ds_read_b64_tr_b16 v[112:113], v62 offset:20480
ds_read_b64_tr_b16 v[114:115], v62 offset:20992
v_mfma_f32_16x16x32_bf16 v[244:247], v[96:99], a[60:63], v[244:247]
ds_read_b64_tr_b16 a[24:25], v41 offset:33024
v_mfma_f32_16x16x32_bf16 v[248:251], v[100:103], a[56:59], v[248:251]
buffer_load_dwordx4 v34, s[48:51], s85 offen offset:2048 lds
v_mfma_f32_16x16x32_bf16 v[252:255], v[100:103], a[60:63], v[252:255]
ds_read_b64_tr_b16 a[26:27], v41 offset:34048
s_waitcnt lgkmcnt(10)
v_mfma_f32_16x16x32_bf16 v[224:227], v[104:107], a[64:67], v[224:227]
ds_read_b64_tr_b16 v[116:117], v63 offset:20480
ds_read_b64_tr_b16 v[118:119], v63 offset:20992
v_mfma_f32_16x16x32_bf16 v[228:231], v[104:107], a[68:71], v[228:231]
ds_read_b64_tr_b16 a[28:29], v14 offset:33024
s_waitcnt lgkmcnt(9)
v_mfma_f32_16x16x32_bf16 v[232:235], v[108:111], a[64:67], v[232:235]
buffer_load_dwordx4 v35, s[48:51], s85 offen offset:3072 lds
v_mfma_f32_16x16x32_bf16 v[236:239], v[108:111], a[68:71], v[236:239]
ds_read_b64_tr_b16 a[30:31], v14 offset:34048
v_mfma_f32_16x16x32_bf16 v[240:243], v[104:107], a[72:75], v[240:243]
s_waitcnt vmcnt(18)
ds_read_b64_tr_b16 v[96:97], v62 offset:24576
ds_read_b64_tr_b16 v[98:99], v62 offset:25088
v_mfma_f32_16x16x32_bf16 v[244:247], v[104:107], a[76:79], v[244:247]
ds_read_b64_tr_b16 a[32:33], v40 offset:16384
s_add_u32 m0, s87, 32768
s_add_u32 s85, s4, 65536
v_mfma_f32_16x16x32_bf16 v[248:251], v[108:111], a[72:75], v[248:251]
buffer_load_dwordx4 v32, s[48:51], s85 offen lds
v_mfma_f32_16x16x32_bf16 v[252:255], v[108:111], a[76:79], v[252:255]
ds_read_b64_tr_b16 a[34:35], v40 offset:17408
s_waitcnt lgkmcnt(10)
v_mfma_f32_16x16x32_bf16 v[224:227], v[112:115], a[80:83], v[224:227]
ds_read_b64_tr_b16 v[100:101], v63 offset:24576
ds_read_b64_tr_b16 v[102:103], v63 offset:25088
v_mfma_f32_16x16x32_bf16 v[228:231], v[112:115], a[84:87], v[228:231]
ds_read_b64_tr_b16 a[36:37], v13 offset:16384
s_waitcnt vmcnt(5)
s_atomic_add s69, s[26:27], s17
s_waitcnt lgkmcnt(9)
v_mfma_f32_16x16x32_bf16 v[232:235], v[116:119], a[80:83], v[232:235]
buffer_load_dwordx4 v33, s[48:51], s85 offen offset:1024 lds
v_mfma_f32_16x16x32_bf16 v[236:239], v[116:119], a[84:87], v[236:239]
ds_read_b64_tr_b16 a[38:39], v13 offset:17408
v_mfma_f32_16x16x32_bf16 v[240:243], v[112:115], a[88:91], v[240:243]
ds_read_b64_tr_b16 v[104:105], v62 offset:28672
ds_read_b64_tr_b16 v[106:107], v62 offset:29184
v_mfma_f32_16x16x32_bf16 v[244:247], v[112:115], a[92:95], v[244:247]
ds_read_b64_tr_b16 a[40:41], v40 offset:16640
v_mfma_f32_16x16x32_bf16 v[248:251], v[116:119], a[88:91], v[248:251]
buffer_load_dwordx4 v34, s[48:51], s85 offen offset:2048 lds
v_mfma_f32_16x16x32_bf16 v[252:255], v[116:119], a[92:95], v[252:255]
ds_read_b64_tr_b16 a[42:43], v40 offset:17664
s_waitcnt lgkmcnt(10)
v_mfma_f32_16x16x32_bf16 v[224:227], v[96:99], a[96:99], v[224:227]
ds_read_b64_tr_b16 v[108:109], v63 offset:28672
ds_read_b64_tr_b16 v[110:111], v63 offset:29184
v_mfma_f32_16x16x32_bf16 v[228:231], v[96:99], a[100:103], v[228:231]
ds_read_b64_tr_b16 a[44:45], v13 offset:16640
ds_read_b64_tr_b16 a[46:47], v13 offset:17664
s_waitcnt lgkmcnt(10)
v_mfma_f32_16x16x32_bf16 v[232:235], v[100:103], a[96:99], v[232:235]
buffer_load_dwordx4 v35, s[48:51], s85 offen offset:3072 lds
v_mfma_f32_16x16x32_bf16 v[236:239], v[100:103], a[100:103], v[236:239]
ds_read_b32 v47, v43
s_waitcnt lgkmcnt(1)
v_mfma_f32_16x16x32_bf16 v[240:243], v[96:99], a[104:107], v[240:243]
s_barrier
ds_read_b64_tr_b16 v[112:113], v62 offset:32768
ds_read_b64_tr_b16 v[114:115], v62 offset:33280
v_mfma_f32_16x16x32_bf16 v[244:247], v[96:99], a[108:111], v[244:247]
ds_read_b64_tr_b16 a[48:49], v41 offset:49152
s_add_u32 m0, s87, 98304
s_add_u32 s85, s5, 0
v_mfma_f32_16x16x32_bf16 v[248:251], v[100:103], a[104:107], v[248:251]
buffer_load_dwordx4 v32, s[48:51], s85 offen lds
v_mfma_f32_16x16x32_bf16 v[252:255], v[100:103], a[108:111], v[252:255]
ds_read_b64_tr_b16 a[50:51], v41 offset:50176
v_mfma_f32_16x16x32_bf16 v[224:227], v[104:107], a[112:115], v[224:227]
ds_read_b64_tr_b16 v[116:117], v63 offset:32768
ds_read_b64_tr_b16 v[118:119], v63 offset:33280
v_mfma_f32_16x16x32_bf16 v[228:231], v[104:107], a[116:119], v[228:231]
ds_read_b64_tr_b16 a[52:53], v14 offset:49152
v_mfma_f32_16x16x32_bf16 v[232:235], v[108:111], a[112:115], v[232:235]
buffer_load_dwordx4 v33, s[48:51], s85 offen offset:1024 lds
v_mfma_f32_16x16x32_bf16 v[236:239], v[108:111], a[116:119], v[236:239]
ds_read_b64_tr_b16 a[54:55], v14 offset:50176
v_mfma_f32_16x16x32_bf16 v[240:243], v[104:107], a[120:123], v[240:243]
ds_read_b64_tr_b16 v[96:97], v62 offset:36864
ds_read_b64_tr_b16 v[98:99], v62 offset:37376
v_mfma_f32_16x16x32_bf16 v[244:247], v[104:107], a[124:127], v[244:247]
ds_read_b64_tr_b16 a[56:57], v41 offset:49408
v_mfma_f32_16x16x32_bf16 v[248:251], v[108:111], a[120:123], v[248:251]
buffer_load_dwordx4 v34, s[48:51], s85 offen offset:2048 lds
v_mfma_f32_16x16x32_bf16 v[252:255], v[108:111], a[124:127], v[252:255]
ds_read_b64_tr_b16 a[58:59], v41 offset:50432
s_waitcnt lgkmcnt(10)
v_mfma_f32_16x16x32_bf16 v[224:227], v[112:115], a[128:131], v[224:227]
ds_read_b64_tr_b16 v[100:101], v63 offset:36864
ds_read_b64_tr_b16 v[102:103], v63 offset:37376
v_mfma_f32_16x16x32_bf16 v[228:231], v[112:115], a[132:135], v[228:231]
ds_read_b64_tr_b16 a[60:61], v14 offset:49408
s_waitcnt lgkmcnt(9)
v_mfma_f32_16x16x32_bf16 v[232:235], v[116:119], a[128:131], v[232:235]
buffer_load_dwordx4 v35, s[48:51], s85 offen offset:3072 lds
v_mfma_f32_16x16x32_bf16 v[236:239], v[116:119], a[132:135], v[236:239]
ds_read_b64_tr_b16 a[62:63], v14 offset:50432
L_pad_Q_3:
s_cbranch_execz L_pad_Q_4
s_nop 0
v_mfma_f32_16x16x32_bf16 v[240:243], v[112:115], a[136:139], v[240:243]
ds_read_b64_tr_b16 v[104:105], v62 offset:40960
ds_read_b64_tr_b16 v[106:107], v62 offset:41472
v_mfma_f32_16x16x32_bf16 v[244:247], v[112:115], a[140:143], v[244:247]
ds_read_b64_tr_b16 a[64:65], v42 offset:0
s_add_u32 m0, s87, 16384
s_add_u32 s85, s5, 32768
v_mfma_f32_16x16x32_bf16 v[248:251], v[116:119], a[136:139], v[248:251]
buffer_load_dwordx4 v32, s[48:51], s85 offen lds
v_mfma_f32_16x16x32_bf16 v[252:255], v[116:119], a[140:143], v[252:255]
ds_read_b64_tr_b16 a[66:67], v42 offset:1024
s_waitcnt lgkmcnt(10)
v_mfma_f32_16x16x32_bf16 v[224:227], v[96:99], a[144:147], v[224:227]
ds_read_b64_tr_b16 v[108:109], v63 offset:40960
ds_read_b64_tr_b16 v[110:111], v63 offset:41472
v_mfma_f32_16x16x32_bf16 v[228:231], v[96:99], a[148:151], v[228:231]
ds_read_b64_tr_b16 a[68:69], v15 offset:0
s_waitcnt lgkmcnt(9)
v_mfma_f32_16x16x32_bf16 v[232:235], v[100:103], a[144:147], v[232:235]
buffer_load_dwordx4 v33, s[48:51], s85 offen offset:1024 lds
v_mfma_f32_16x16x32_bf16 v[236:239], v[100:103], a[148:151], v[236:239]
ds_read_b64_tr_b16 a[70:71], v15 offset:1024
v_mfma_f32_16x16x32_bf16 v[240:243], v[96:99], a[152:155], v[240:243]
ds_read_b64_tr_b16 v[112:113], v62 offset:45056
ds_read_b64_tr_b16 v[114:115], v62 offset:45568
v_mfma_f32_16x16x32_bf16 v[244:247], v[96:99], a[156:159], v[244:247]
ds_read_b64_tr_b16 a[72:73], v42 offset:256
v_mfma_f32_16x16x32_bf16 v[248:251], v[100:103], a[152:155], v[248:251]
buffer_load_dwordx4 v34, s[48:51], s85 offen offset:2048 lds
v_mfma_f32_16x16x32_bf16 v[252:255], v[100:103], a[156:159], v[252:255]
ds_read_b64_tr_b16 a[74:75], v42 offset:1280
s_waitcnt lgkmcnt(10)
v_mfma_f32_16x16x32_bf16 v[224:227], v[104:107], a[160:163], v[224:227]
ds_read_b64_tr_b16 v[116:117], v63 offset:45056
ds_read_b64_tr_b16 v[118:119], v63 offset:45568
v_mfma_f32_16x16x32_bf16 v[228:231], v[104:107], a[164:167], v[228:231]
ds_read_b64_tr_b16 a[76:77], v15 offset:256
ds_read_b64_tr_b16 a[78:79], v15 offset:1280
s_waitcnt lgkmcnt(10)
v_mfma_f32_16x16x32_bf16 v[232:235], v[108:111], a[160:163], v[232:235]
buffer_load_dwordx4 v35, s[48:51], s85 offen offset:3072 lds
v_mfma_f32_16x16x32_bf16 v[236:239], v[108:111], a[164:167], v[236:239]
ds_read_b32 v47, v43
s_waitcnt lgkmcnt(1)
v_mfma_f32_16x16x32_bf16 v[240:243], v[104:107], a[168:171], v[240:243]
s_barrier
s_waitcnt vmcnt(12)
ds_read_b64_tr_b16 v[96:97], v60 offset:0
ds_read_b64_tr_b16 v[98:99], v60 offset:512
v_mfma_f32_16x16x32_bf16 v[244:247], v[104:107], a[172:175], v[244:247]
ds_read_b64_tr_b16 a[80:81], v40 offset:49152
s_add_u32 m0, s87, 114688
s_add_u32 s85, s5, 65536
v_mfma_f32_16x16x32_bf16 v[248:251], v[108:111], a[168:171], v[248:251]
buffer_load_dwordx4 v32, s[48:51], s85 offen lds
v_mfma_f32_16x16x32_bf16 v[252:255], v[108:111], a[172:175], v[252:255]
ds_read_b64_tr_b16 a[82:83], v40 offset:50176
v_mfma_f32_16x16x32_bf16 v[224:227], v[112:115], a[176:179], v[224:227]
ds_read_b64_tr_b16 v[100:101], v61 offset:0
ds_read_b64_tr_b16 v[102:103], v61 offset:512
v_mfma_f32_16x16x32_bf16 v[228:231], v[112:115], a[180:183], v[228:231]
ds_read_b64_tr_b16 a[84:85], v13 offset:49152
v_mfma_f32_16x16x32_bf16 v[232:235], v[116:119], a[176:179], v[232:235]
buffer_load_dwordx4 v33, s[48:51], s85 offen offset:1024 lds
v_mfma_f32_16x16x32_bf16 v[236:239], v[116:119], a[180:183], v[236:239]
ds_read_b64_tr_b16 a[86:87], v13 offset:50176
v_mfma_f32_16x16x32_bf16 v[240:243], v[112:115], a[184:187], v[240:243]
ds_read_b64_tr_b16 v[104:105], v60 offset:4096
ds_read_b64_tr_b16 v[106:107], v60 offset:4608
v_mfma_f32_16x16x32_bf16 v[244:247], v[112:115], a[188:191], v[244:247]
ds_read_b64_tr_b16 a[88:89], v40 offset:49408
v_mfma_f32_16x16x32_bf16 v[248:251], v[116:119], a[184:187], v[248:251]
buffer_load_dwordx4 v34, s[48:51], s85 offen offset:2048 lds
v_mfma_f32_16x16x32_bf16 v[252:255], v[116:119], a[188:191], v[252:255]
ds_read_b64_tr_b16 a[90:91], v40 offset:50432
s_waitcnt lgkmcnt(10)
v_mfma_f32_16x16x32_bf16 v[224:227], v[96:99], a[192:195], v[224:227]
ds_read_b64_tr_b16 v[108:109], v61 offset:4096
ds_read_b64_tr_b16 v[110:111], v61 offset:4608
v_mfma_f32_16x16x32_bf16 v[228:231], v[96:99], a[196:199], v[228:231]
ds_read_b64_tr_b16 a[92:93], v13 offset:49408
s_waitcnt lgkmcnt(9)
v_mfma_f32_16x16x32_bf16 v[232:235], v[100:103], a[192:195], v[232:235]
buffer_load_dwordx4 v35, s[48:51], s85 offen offset:3072 lds
v_mfma_f32_16x16x32_bf16 v[236:239], v[100:103], a[196:199], v[236:239]
ds_read_b64_tr_b16 a[94:95], v13 offset:50432
v_mfma_f32_16x16x32_bf16 v[240:243], v[96:99], a[200:203], v[240:243]
ds_read_b64_tr_b16 v[112:113], v60 offset:8192
s_add_u32 m0, s87, 131072
v_mfma_f32_16x16x32_bf16 v[244:247], v[96:99], a[204:207], v[244:247]
ds_read_b64_tr_b16 v[114:115], v60 offset:8704
s_add_u32 s85, s6, 0
v_mfma_f32_16x16x32_bf16 v[248:251], v[100:103], a[200:203], v[248:251]
buffer_load_dwordx4 v32, s[48:51], s85 offen lds
v_mfma_f32_16x16x32_bf16 v[252:255], v[100:103], a[204:207], v[252:255]
s_waitcnt lgkmcnt(8)
v_mfma_f32_16x16x32_bf16 v[224:227], v[104:107], a[208:211], v[224:227]
ds_read_b64_tr_b16 v[116:117], v61 offset:8192
v_mfma_f32_16x16x32_bf16 v[228:231], v[104:107], a[212:215], v[228:231]
ds_read_b64_tr_b16 v[118:119], v61 offset:8704
s_waitcnt lgkmcnt(6)
v_mfma_f32_16x16x32_bf16 v[232:235], v[108:111], a[208:211], v[232:235]
buffer_load_dwordx4 v33, s[48:51], s85 offen offset:1024 lds
v_mfma_f32_16x16x32_bf16 v[236:239], v[108:111], a[212:215], v[236:239]
v_mfma_f32_16x16x32_bf16 v[240:243], v[104:107], a[216:219], v[240:243]
ds_read_b64_tr_b16 v[96:97], v60 offset:12288
v_mfma_f32_16x16x32_bf16 v[244:247], v[104:107], a[220:223], v[244:247]
ds_read_b64_tr_b16 v[98:99], v60 offset:12800
v_mfma_f32_16x16x32_bf16 v[248:251], v[108:111], a[216:219], v[248:251]
buffer_load_dwordx4 v34, s[48:51], s85 offen offset:2048 lds
v_mfma_f32_16x16x32_bf16 v[252:255], v[108:111], a[220:223], v[252:255]
s_waitcnt lgkmcnt(4)
v_mfma_f32_16x16x32_bf16 v[224:227], v[112:115], a[224:227], v[224:227]
ds_read_b64_tr_b16 v[100:101], v61 offset:12288
s_load_dword s68, s[26:27], s14 glc
v_mfma_f32_16x16x32_bf16 v[228:231], v[112:115], a[228:231], v[228:231]
ds_read_b64_tr_b16 v[102:103], v61 offset:12800
s_waitcnt lgkmcnt(4)
v_mfma_f32_16x16x32_bf16 v[232:235], v[116:119], a[224:227], v[232:235]
buffer_load_dwordx4 v35, s[48:51], s85 offen offset:3072 lds
v_mfma_f32_16x16x32_bf16 v[236:239], v[116:119], a[228:231], v[236:239]
ds_read_b32 v47, v43
s_waitcnt lgkmcnt(1)
v_mfma_f32_16x16x32_bf16 v[240:243], v[112:115], a[232:235], v[240:243]
s_barrier
s_add_u32 m0, s87, 0
v_mfma_f32_16x16x32_bf16 v[244:247], v[112:115], a[236:239], v[244:247]
s_add_u32 s85, s6, 32768
v_mfma_f32_16x16x32_bf16 v[248:251], v[116:119], a[232:235], v[248:251]
buffer_load_dwordx4 v32, s[48:51], s85 offen lds
v_mfma_f32_16x16x32_bf16 v[252:255], v[116:119], a[236:239], v[252:255]
v_mfma_f32_16x16x32_bf16 v[224:227], v[96:99], a[240:243], v[224:227]
v_mfma_f32_16x16x32_bf16 v[228:231], v[96:99], a[244:247], v[228:231]
v_mfma_f32_16x16x32_bf16 v[232:235], v[100:103], a[240:243], v[232:235]
buffer_load_dwordx4 v33, s[48:51], s85 offen offset:1024 lds
v_mfma_f32_16x16x32_bf16 v[236:239], v[100:103], a[244:247], v[236:239]
v_mfma_f32_16x16x32_bf16 v[240:243], v[96:99], a[248:251], v[240:243]
v_mfma_f32_16x16x32_bf16 v[244:247], v[96:99], a[252:255], v[244:247]
v_mfma_f32_16x16x32_bf16 v[248:251], v[100:103], a[248:251], v[248:251]
buffer_load_dwordx4 v34, s[48:51], s85 offen offset:2048 lds
v_mfma_f32_16x16x32_bf16 v[252:255], v[100:103], a[252:255], v[252:255]
s_nop 0
v_cvt_pk_bf16_f32 v117, v234, v235
v_cvt_pk_bf16_f32 v115, v230, v231
v_cvt_pk_bf16_f32 v116, v232, v233
v_cvt_pk_bf16_f32 v112, v224, v225
v_cvt_pk_bf16_f32 v119, v238, v239
v_cvt_pk_bf16_f32 v124, v248, v249
v_cvt_pk_bf16_f32 v114, v228, v229
v_permlane16_swap_b32_e64 v117, v119
v_cvt_pk_bf16_f32 v118, v236, v237
v_cvt_pk_bf16_f32 v120, v240, v241
v_permlane16_swap_b32 v112, v114
v_permlane16_swap_b32 v116, v118
v_cvt_pk_bf16_f32 v113, v226, v227
buffer_load_dwordx4 v35, s[48:51], s85 offen offset:3072 lds
v_cvt_pk_bf16_f32 v126, v252, v253
v_mfma_f32_32x32x16_bf16 v[144:159], v[64:67], v[116:119], 0
v_permlane16_swap_b32 v113, v115
v_permlane16_swap_b32 v124, v126
v_cvt_pk_bf16_f32 v122, v244, v245
v_cvt_pk_bf16_f32 v127, v254, v255
v_mfma_f32_32x32x16_bf16 v[128:143], v[64:67], v[112:115], 0
v_permlane16_swap_b32_e64 v120, v122
v_cvt_pk_bf16_f32 v121, v242, v243
v_cvt_pk_bf16_f32 v125, v250, v251
v_cvt_pk_bf16_f32 v123, v246, v247
s_add_u32 m0, s87, 49152
s_add_u32 s85, s18, 65536
buffer_load_dwordx4 v32, s[48:51], s85 offen lds
v_permlane16_swap_b32 v125, v127
v_permlane16_swap_b32 v121, v123
v_max3_f32 v70, v152, v153, v154
v_mfma_f32_32x32x16_bf16 v[176:191], v[64:67], v[124:127], 0
v_max3_f32 v70, v70, v155, v156
v_max3_f32 v70, v70, v157, v158
v_max_f32_e64 v70, v70, v159
v_max3_f32 v69, -v128, -v129, -v130
v_max3_f32 v69, v69, -v131, -v132
v_max3_f32 v68, v128, v129, v130
v_mfma_f32_32x32x16_bf16 v[160:175], v[64:67], v[120:123], 0
buffer_load_dwordx4 v33, s[48:51], s85 offen offset:1024 lds
v_max3_f32 v68, v68, v131, v132
v_max3_f32 v68, v68, v133, v134
v_max_f32_e64 v68, v68, v135
v_max3_f32 v71, -v152, -v153, -v154
v_max3_f32 v71, v71, -v155, -v156
v_max3_f32 v71, v71, -v157, -v158
v_max_f32 v71, v71, -v159
v_max3_f32 v69, v69, -v133, -v134
v_max_f32 v69, v69, -v135
v_permlane32_swap_b32 v70, v71
v_max_f32 v70, v70, v71
v_mul_f32 v71, -v70, v50
v_mul_f32 v70, -v70, v50
v_permlane32_swap_b32_e64 v68, v69
s_add_u32 s85, s19, 49152
buffer_load_dwordx4 v36, s[48:51], s85 offen offset:2048 lds
v_max_f32 v68, v68, v69
v_permlane32_swap_b32 v70, v71
v_pk_fma_f32 v[210:211], v[154:155], v[50:51], v[70:71] op_sel_hi:[1,0,0]
v_pk_fma_f32 v[208:209], v[152:153], v[50:51], v[70:71] op_sel_hi:[1,0,0]
v_exp_f32_e64 v211, v211
v_pk_fma_f32 v[220:221], v[156:157], v[50:51], v[70:71] op_sel:[0,0,1] op_sel_hi:[1,0,1] neg_lo:[1,0,0] neg_hi:[1,0,0]
v_exp_f32 v208, v208
s_waitcnt lgkmcnt(0)
s_bfe_u32 s97, s68, 524288
s_cmp_lt_u32 s97, 4
s_cbranch_scc1 L_slow_Q1
L_back_Q1:
v_pk_fma_f32 v[218:219], v[154:155], v[50:51], v[70:71] op_sel:[0,0,1] op_sel_hi:[1,0,1] neg_lo:[1,0,0] neg_hi:[1,0,0]
v_exp_f32_e64 v219, v219
buffer_load_dwordx4 v37, s[48:51], s85 offen offset:3072 lds
v_pk_fma_f32 v[212:213], v[156:157], v[50:51], v[70:71] op_sel_hi:[1,0,0]
v_exp_f32 v213, v213
v_exp_f32 v209, v209
v_exp_f32_e64 v220, v220
v_pk_fma_f32 v[216:217], v[152:153], v[50:51], v[70:71] op_sel:[0,0,1] op_sel_hi:[1,0,1] neg_lo:[1,0,0] neg_hi:[1,0,0]
v_exp_f32_e64 v217, v217
v_mul_f32 v69, -v68, v50
v_mul_f32 v68, -v68, v50
v_pk_fma_f32 v[222:223], v[158:159], v[50:51], v[70:71] op_sel:[0,0,1] op_sel_hi:[1,0,1] neg_lo:[1,0,0] neg_hi:[1,0,0]
v_exp_f32_e64 v223, v223
v_exp_f32 v212, v212
s_add_u32 s86, s8, 0
buffer_load_dwordx4 a[96:99], v77, s[52:55], s86 offen offset:0 sc1
v_exp_f32 v216, v216
v_exp_f32 v222, v222
v_pk_fma_f32 v[214:215], v[158:159], v[50:51], v[70:71] op_sel_hi:[1,0,0]
v_exp_f32 v214, v214
v_permlane32_swap_b32 v68, v69
v_pk_fma_f32 v[194:195], v[130:131], v[50:51], v[68:69] op_sel_hi:[1,0,0]
v_pk_fma_f32 v[204:205], v[132:133], v[50:51], v[68:69] op_sel:[0,0,1] op_sel_hi:[1,0,1] neg_lo:[1,0,0] neg_hi:[1,0,0]
v_pk_fma_f32 v[192:193], v[128:129], v[50:51], v[68:69] op_sel_hi:[1,0,0]
v_exp_f32_e64 v193, v193
v_pk_fma_f32 v[206:207], v[134:135], v[50:51], v[68:69] op_sel:[0,0,1] op_sel_hi:[1,0,1] neg_lo:[1,0,0] neg_hi:[1,0,0]
v_exp_f32_e64 v207, v207
buffer_load_dwordx4 a[100:103], v77, s[52:55], s86 offen offset:256 sc1
v_pk_fma_f32 v[198:199], v[134:135], v[50:51], v[68:69] op_sel_hi:[1,0,0]
v_exp_f32 v199, v199
v_exp_f32 v198, v198
v_pk_fma_f32 v[196:197], v[132:133], v[50:51], v[68:69] op_sel_hi:[1,0,0]
v_exp_f32 v197, v197
v_exp_f32 v195, v195
v_exp_f32 v205, v205
v_exp_f32 v192, v192
v_pk_fma_f32 v[200:201], v[128:129], v[50:51], v[68:69] op_sel:[0,0,1] op_sel_hi:[1,0,1] neg_lo:[1,0,0] neg_hi:[1,0,0]
v_exp_f32_e64 v200, v200
buffer_load_dwordx4 a[104:107], v77, s[52:55], s86 offen offset:1024 sc1
v_exp_f32 v201, v201
v_exp_f32 v204, v204
v_pk_fma_f32 v[202:203], v[130:131], v[50:51], v[68:69] op_sel:[0,0,1] op_sel_hi:[1,0,1] neg_lo:[1,0,0] neg_hi:[1,0,0]
v_exp_f32 v202, v202
v_exp_f32 v196, v196
v_exp_f32_e64 v203, v203
v_pk_add_f32 v[130:131], v[196:197], v[198:199]
v_pk_add_f32 v[132:133], v[200:201], v[202:203]
v_exp_f32 v221, v221
v_exp_f32 v218, v218
buffer_load_dwordx4 a[108:111], v77, s[52:55], s86 offen offset:1280 sc1
v_pk_add_f32 v[158:159], v[220:221], v[222:223]
v_pk_add_f32 v[156:157], v[216:217], v[218:219]
v_pk_add_f32 v[156:157], v[156:157], v[158:159]
v_add_f32 v71, v156, v157
v_exp_f32 v206, v206
s_load_dword s68, s[26:27], s15 glc
v_exp_f32_e64 v215, v215
v_pk_add_f32 v[134:135], v[204:205], v[206:207]
v_pk_add_f32 v[132:133], v[132:133], v[134:135]
v_add_f32_e64 v69, v132, v133
v_pk_add_f32 v[154:155], v[212:213], v[214:215]
v_exp_f32 v210, v210
v_exp_f32 v194, v194
s_add_u32 s86, s8, 4096
buffer_load_dwordx4 a[112:115], v77, s[52:55], s86 offen offset:0 sc1
v_pk_add_f32 v[152:153], v[208:209], v[210:211]
v_pk_add_f32 v[128:129], v[192:193], v[194:195]
v_pk_add_f32 v[128:129], v[128:129], v[130:131]
v_add_f32_e64 v68, v128, v129
v_pk_add_f32 v[152:153], v[152:153], v[154:155]
v_add_f32 v70, v152, v153
v_permlane32_swap_b32 v68, v69
v_add_f32 v68, v68, v69
v_rcp_f32 v68, v68
v_permlane32_swap_b32 v70, v71
v_mov_b32 v69, v68
v_add_f32 v70, v70, v71
v_rcp_f32 v70, v70
buffer_load_dwordx4 a[116:119], v77, s[52:55], s86 offen offset:256 sc1
v_permlane32_swap_b32_e64 v68, v69
v_pk_mul_f32 v[206:207], v[206:207], v[68:69] op_sel:[0,1] op_sel_hi:[1,1]
v_pk_mul_f32 v[202:203], v[202:203], v[68:69] op_sel:[0,1] op_sel_hi:[1,1]
v_pk_mul_f32 v[194:195], v[194:195], v[68:69] op_sel_hi:[1,0]
v_cvt_pk_bf16_f32 v225, v194, v195
v_pk_mul_f32 v[204:205], v[204:205], v[68:69] op_sel:[0,1] op_sel_hi:[1,1]
v_pk_mul_f32 v[198:199], v[198:199], v[68:69] op_sel_hi:[1,0]
v_cvt_pk_bf16_f32 v227, v198, v199
v_cvt_pk_bf16_f32 v231, v206, v207
v_cvt_pk_bf16_f32 v229, v202, v203
v_pk_mul_f32 v[196:197], v[196:197], v[68:69] op_sel_hi:[1,0]
v_cvt_pk_bf16_f32 v226, v196, v197
v_pk_mul_f32 v[192:193], v[192:193], v[68:69] op_sel_hi:[1,0]
v_cvt_pk_bf16_f32 v230, v204, v205
v_mov_b32_e64 v71, v70
buffer_load_dwordx4 a[120:123], v77, s[52:55], s86 offen offset:1024 sc1
v_pk_mul_f32 v[200:201], v[200:201], v[68:69] op_sel:[0,1] op_sel_hi:[1,1]
v_cvt_pk_bf16_f32 v228, v200, v201
v_permlane32_swap_b32_e64 v70, v71
v_pk_mul_f32 v[220:221], v[220:221], v[70:71] op_sel:[0,1] op_sel_hi:[1,1]
v_cvt_pk_bf16_f32 v238, v220, v221
v_pk_mul_f32 v[222:223], v[222:223], v[70:71] op_sel:[0,1] op_sel_hi:[1,1]
v_pk_mul_f32 v[218:219], v[218:219], v[70:71] op_sel:[0,1] op_sel_hi:[1,1]
v_cvt_pk_bf16_f32 v237, v218, v219
v_pk_mul_f32 v[212:213], v[212:213], v[70:71] op_sel_hi:[1,0]
v_pk_mul_f32 v[208:209], v[208:209], v[70:71] op_sel_hi:[1,0]
v_cvt_pk_bf16_f32 v239, v222, v223
v_pk_mul_f32 v[214:215], v[214:215], v[70:71] op_sel_hi:[1,0]
v_pk_mul_f32 v[216:217], v[216:217], v[70:71] op_sel:[0,1] op_sel_hi:[1,1]
v_cvt_pk_bf16_f32 v236, v216, v217
v_cvt_pk_bf16_f32 v232, v208, v209
buffer_load_dwordx4 a[124:127], v77, s[52:55], s86 offen offset:1280 sc1
v_pk_mul_f32 v[210:211], v[210:211], v[70:71] op_sel_hi:[1,0]
v_cvt_pk_bf16_f32 v235, v214, v215
v_cvt_pk_bf16_f32 v233, v210, v211
v_cvt_pk_bf16_f32 v234, v212, v213
v_cvt_pk_bf16_f32 v224, v192, v193
v_max3_f32 v70, v184, v185, v186
v_max3_f32 v68, v160, v161, v162
v_max3_f32 v71, -v184, -v185, -v186
v_max3_f32 v71, v71, -v187, -v188
v_max3_f32 v71, v71, -v189, -v190
v_max_f32 v71, v71, -v191
v_max3_f32 v68, v68, v163, v164
v_max3_f32 v68, v68, v165, v166
v_max3_f32 v70, v70, v187, v188
v_max3_f32 v70, v70, v189, v190
v_max_f32_e64 v70, v70, v191
v_max3_f32 v69, -v160, -v161, -v162
v_max3_f32 v69, v69, -v163, -v164
v_max3_f32 v69, v69, -v165, -v166
v_max_f32 v69, v69, -v167
v_permlane32_swap_b32_e64 v70, v71
s_add_u32 s86, s8, 8192
buffer_load_dwordx4 a[128:131], v77, s[52:55], s86 offen offset:0 sc1
v_max_f32 v68, v68, v167
v_max_f32 v70, v70, v71
v_mul_f32 v71, -v70, v50
v_mul_f32 v70, -v70, v50
v_permlane32_swap_b32 v68, v69
v_max_f32 v68, v68, v69
v_mul_f32 v69, -v68, v50
v_mul_f32 v68, -v68, v50
v_permlane32_swap_b32_e64 v70, v71
v_pk_fma_f32 v[220:221], v[188:189], v[50:51], v[70:71] op_sel:[0,0,1] op_sel_hi:[1,0,1] neg_lo:[1,0,0] neg_hi:[1,0,0]
v_exp_f32_e64 v221, v221
v_pk_fma_f32 v[218:219], v[186:187], v[50:51], v[70:71] op_sel:[0,0,1] op_sel_hi:[1,0,1] neg_lo:[1,0,0] neg_hi:[1,0,0]
v_exp_f32_e64 v219, v219
buffer_load_dwordx4 a[132:135], v77, s[52:55], s86 offen offset:256 sc1
v_pk_fma_f32 v[208:209], v[184:185], v[50:51], v[70:71] op_sel_hi:[1,0,0]
v_exp_f32_e64 v209, v209
v_pk_fma_f32 v[212:213], v[188:189], v[50:51], v[70:71] op_sel_hi:[1,0,0]
v_exp_f32_e64 v212, v212
v_pk_fma_f32 v[214:215], v[190:191], v[50:51], v[70:71] op_sel_hi:[1,0,0]
v_pk_fma_f32 v[222:223], v[190:191], v[50:51], v[70:71] op_sel:[0,0,1] op_sel_hi:[1,0,1] neg_lo:[1,0,0] neg_hi:[1,0,0]
v_pk_fma_f32 v[216:217], v[184:185], v[50:51], v[70:71] op_sel:[0,0,1] op_sel_hi:[1,0,1] neg_lo:[1,0,0] neg_hi:[1,0,0]
v_exp_f32 v216, v216
v_exp_f32 v217, v217
v_pk_fma_f32 v[210:211], v[186:187], v[50:51], v[70:71] op_sel_hi:[1,0,0]
s_waitcnt lgkmcnt(0)
s_bfe_u32 s97, s68, 524296
s_cmp_lt_u32 s97, 5
s_cbranch_scc1 L_slow_Q2
L_back_Q2:
buffer_load_dwordx4 v[80:83], v28, s[52:55], s80 offen sc1
buffer_load_dwordx4 v[84:87], v29, s[52:55], s80 offen sc1
buffer_load_dwordx4 v[88:91], v30, s[52:55], s80 offen sc1
buffer_load_dwordx4 v[92:95], v31, s[52:55], s80 offen sc1
v_exp_f32 v213, v213
buffer_load_dwordx4 a[136:139], v77, s[52:55], s86 offen offset:1024 sc1
v_permlane32_swap_b32_e64 v68, v69
v_pk_fma_f32 v[202:203], v[162:163], v[50:51], v[68:69] op_sel:[0,0,1] op_sel_hi:[1,0,1] neg_lo:[1,0,0] neg_hi:[1,0,0]
v_exp_f32_e64 v203, v203
v_pk_fma_f32 v[206:207], v[166:167], v[50:51], v[68:69] op_sel:[0,0,1] op_sel_hi:[1,0,1] neg_lo:[1,0,0] neg_hi:[1,0,0]
v_exp_f32_e64 v206, v206
v_pk_fma_f32 v[204:205], v[164:165], v[50:51], v[68:69] op_sel:[0,0,1] op_sel_hi:[1,0,1] neg_lo:[1,0,0] neg_hi:[1,0,0]
v_exp_f32 v202, v202
v_exp_f32 v204, v204
v_exp_f32 v207, v207
v_exp_f32 v210, v210
buffer_load_dwordx4 a[140:143], v77, s[52:55], s86 offen offset:1280 sc1
v_exp_f32 v223, v223
v_exp_f32 v218, v218
v_exp_f32_e64 v220, v220
v_pk_add_f32 v[188:189], v[216:217], v[218:219]
v_exp_f32_e64 v214, v214
v_pk_fma_f32 v[196:197], v[164:165], v[50:51], v[68:69] op_sel_hi:[1,0,0]
v_exp_f32 v196, v196
v_exp_f32 v197, v197
v_pk_fma_f32 v[192:193], v[160:161], v[50:51], v[68:69] op_sel_hi:[1,0,0]
v_exp_f32 v193, v193
s_add_u32 s86, s9, 0
buffer_load_dwordx4 a[144:147], v77, s[52:55], s86 offen offset:0 sc1
v_exp_f32_e64 v192, v192
v_pk_fma_f32 v[200:201], v[160:161], v[50:51], v[68:69] op_sel:[0,0,1] op_sel_hi:[1,0,1] neg_lo:[1,0,0] neg_hi:[1,0,0]
v_exp_f32 v200, v200
v_exp_f32 v201, v201
v_exp_f32_e64 v215, v215
v_pk_add_f32 v[164:165], v[200:201], v[202:203]
v_pk_add_f32 v[186:187], v[212:213], v[214:215]
v_exp_f32_e64 v211, v211
v_pk_fma_f32 v[198:199], v[166:167], v[50:51], v[68:69] op_sel_hi:[1,0,0]
v_exp_f32_e64 v198, v198
buffer_load_dwordx4 a[148:151], v77, s[52:55], s86 offen offset:256 sc1
v_exp_f32_e64 v199, v199
v_pk_fma_f32 v[194:195], v[162:163], v[50:51], v[68:69] op_sel_hi:[1,0,0]
v_exp_f32_e64 v195, v195
v_pk_add_f32 v[162:163], v[196:197], v[198:199]
v_exp_f32 v194, v194
v_exp_f32 v222, v222
v_pk_add_f32 v[160:161], v[192:193], v[194:195]
v_pk_add_f32 v[190:191], v[220:221], v[222:223]
v_pk_add_f32 v[160:161], v[160:161], v[162:163]
v_pk_add_f32 v[188:189], v[188:189], v[190:191]
v_add_f32 v71, v188, v189
v_add_f32 v68, v160, v161
buffer_load_dwordx4 a[152:155], v77, s[52:55], s86 offen offset:1024 sc1
v_exp_f32 v208, v208
v_exp_f32 v205, v205
v_pk_add_f32 v[184:185], v[208:209], v[210:211]
v_pk_add_f32 v[166:167], v[204:205], v[206:207]
v_pk_add_f32 v[164:165], v[164:165], v[166:167]
v_add_f32_e64 v69, v164, v165
v_pk_add_f32 v[184:185], v[184:185], v[186:187]
v_add_f32 v70, v184, v185
v_permlane32_swap_b32 v68, v69
v_add_f32 v68, v68, v69
v_permlane32_swap_b32 v70, v71
v_add_f32_e64 v70, v70, v71
buffer_load_dwordx4 a[156:159], v77, s[52:55], s86 offen offset:1280 sc1
v_rcp_f32 v70, v70
v_rcp_f32 v68, v68
v_mov_b32 v71, v70
v_mov_b32 v69, v68
s_nop 0
v_permlane32_swap_b32 v70, v71
v_pk_mul_f32 v[208:209], v[208:209], v[70:71] op_sel_hi:[1,0]
v_pk_mul_f32 v[214:215], v[214:215], v[70:71] op_sel_hi:[1,0]
v_cvt_pk_bf16_f32 v248, v208, v209
v_cvt_pk_bf16_f32 v251, v214, v215
v_pk_mul_f32 v[220:221], v[220:221], v[70:71] op_sel:[0,1] op_sel_hi:[1,1]
v_pk_mul_f32 v[210:211], v[210:211], v[70:71] op_sel_hi:[1,0]
v_pk_mul_f32 v[222:223], v[222:223], v[70:71] op_sel:[0,1] op_sel_hi:[1,1]
v_cvt_pk_bf16_f32 v255, v222, v223
s_add_u32 s86, s9, 4096
buffer_load_dwordx4 a[160:163], v77, s[52:55], s86 offen offset:0 sc1
v_cvt_pk_bf16_f32 v254, v220, v221
v_pk_mul_f32 v[216:217], v[216:217], v[70:71] op_sel:[0,1] op_sel_hi:[1,1]
v_pk_mul_f32 v[218:219], v[218:219], v[70:71] op_sel:[0,1] op_sel_hi:[1,1]
v_cvt_pk_bf16_f32 v252, v216, v217
s_waitcnt vmcnt(7)
v_pk_mul_f32 v[212:213], v[212:213], v[70:71] op_sel_hi:[1,0]
v_permlane32_swap_b32 v68, v69
v_pk_mul_f32 v[194:195], v[194:195], v[68:69] op_sel_hi:[1,0]
v_pk_mul_f32 v[202:203], v[202:203], v[68:69] op_sel:[0,1] op_sel_hi:[1,1]
v_pk_mul_f32 v[204:205], v[204:205], v[68:69] op_sel:[0,1] op_sel_hi:[1,1]
v_pk_mul_f32 v[192:193], v[192:193], v[68:69] op_sel_hi:[1,0]
v_pk_mul_f32 v[200:201], v[200:201], v[68:69] op_sel:[0,1] op_sel_hi:[1,1]
v_pk_mul_f32 v[198:199], v[198:199], v[68:69] op_sel_hi:[1,0]
v_pk_mul_f32 v[196:197], v[196:197], v[68:69] op_sel_hi:[1,0]
v_pk_mul_f32 v[206:207], v[206:207], v[68:69] op_sel:[0,1] op_sel_hi:[1,1]
buffer_load_dwordx4 a[164:167], v77, s[52:55], s86 offen offset:256 sc1
v_cvt_pk_bf16_f32 v244, v200, v201
v_mfma_f32_32x32x16_bf16 v[128:143], v[80:83], v[224:227], 0
v_cvt_pk_bf16_f32 v246, v204, v205
v_cvt_pk_bf16_f32 v240, v192, v193
v_cvt_pk_bf16_f32 v242, v196, v197
v_cvt_pk_bf16_f32 v245, v202, v203
v_cvt_pk_bf16_f32 v241, v194, v195
v_cvt_pk_bf16_f32 v247, v206, v207
v_mfma_f32_32x32x16_bf16 v[128:143], v[84:87], v[228:231], v[128:143]
v_cvt_pk_bf16_f32 v243, v198, v199
v_cvt_pk_bf16_f32 v249, v210, v211
v_cvt_pk_bf16_f32 v253, v218, v219
v_cvt_pk_bf16_f32 v250, v212, v213
s_nop 1
v_mfma_f32_32x32x16_bf16 v[192:207], v[88:91], v[248:251], 0
buffer_load_dwordx4 a[168:171], v77, s[52:55], s86 offen offset:1024 sc1
v_mfma_f32_32x32x16_bf16 v[192:207], v[92:95], v[252:255], v[192:207]
s_nop 2
v_add_f32 v136, v136, v51
v_rcp_f32 v136, v136
s_nop 0
v_mul_f32 v130, v130, v136
v_mul_f32_e64 v131, v131, v136
v_mfma_f32_32x32x16_bf16 v[144:159], v[88:91], v[232:235], 0
v_mul_f32 v128, v128, v136
v_mul_f32 v135, v135, v136
v_mul_f32_e64 v129, v129, v136
v_cvt_pk_bf16_f32 v140, v128, v129
v_cvt_pk_bf16_f32 v141, v130, v131
v_mul_f32_e64 v133, v133, v136
v_mfma_f32_32x32x16_bf16 v[144:159], v[92:95], v[236:239], v[144:159]
buffer_load_dwordx4 a[172:175], v77, s[52:55], s86 offen offset:1280 sc1
v_add_f32 v192, v192, v51
v_mul_f32 v134, v134, v136
v_cvt_pk_bf16_f32 v143, v134, v135
v_rcp_f32 v192, v192
v_mul_f32 v132, v132, v136
v_mfma_f32_32x32x16_bf16 v[96:111], v[80:83], v[240:243], 0
v_cvt_pk_bf16_f32 v142, v132, v133
s_nop 3
v_add_f32 v144, v144, v51
v_mfma_f32_32x32x16_bf16 v[96:111], v[84:87], v[244:247], v[96:111]
v_rcp_f32 v144, v144
s_nop 0
v_mul_f32 v157, v157, v144
v_mul_f32 v153, v153, v144
v_mul_f32 v159, v159, v144
v_mul_f32 v156, v156, v144
v_cvt_pk_bf16_f32 v150, v156, v157
v_mul_f32_e64 v158, v158, v144
v_pk_mul_f32 v[204:205], v[204:205], v[192:193] op_sel_hi:[1,0]
v_pk_mul_f32 v[206:207], v[206:207], v[192:193] op_sel_hi:[1,0]
v_cvt_pk_bf16_f32 v199, v206, v207
v_cvt_pk_bf16_f32 v151, v158, v159
v_mul_f32_e64 v152, v152, v144
v_cvt_pk_bf16_f32 v148, v152, v153
v_add_f32_e64 v104, v104, v51
v_pk_mul_f32 v[202:203], v[202:203], v[192:193] op_sel_hi:[1,0]
v_cvt_pk_bf16_f32 v197, v202, v203
v_pk_mul_f32 v[200:201], v[200:201], v[192:193] op_sel_hi:[1,0]
v_cvt_pk_bf16_f32 v196, v200, v201
v_mul_f32 v155, v155, v144
v_rcp_f32 v104, v104
v_cvt_pk_bf16_f32 v198, v204, v205
v_pk_mul_f32 v[100:101], v[100:101], v[104:105] op_sel_hi:[1,0]
v_pk_mul_f32 v[102:103], v[102:103], v[104:105] op_sel_hi:[1,0]
v_cvt_pk_bf16_f32 v111, v102, v103
v_pk_mul_f32 v[98:99], v[98:99], v[104:105] op_sel_hi:[1,0]
v_cvt_pk_bf16_f32 v109, v98, v99
v_pk_mul_f32 v[96:97], v[96:97], v[104:105] op_sel_hi:[1,0]
v_cvt_pk_bf16_f32 v108, v96, v97
v_cvt_pk_bf16_f32 v110, v100, v101
v_mul_f32_e64 v154, v154, v144
v_cvt_pk_bf16_f32 v149, v154, v155
buffer_store_dwordx4 v[140:143], v38, s[52:55], s82 offen offset:0 sc1
buffer_store_dwordx4 v[148:151], v38, s[52:55], s82 offen offset:2048 sc1
buffer_store_dwordx4 v[108:111], v38, s[52:55], s82 offen offset:1024 sc1
buffer_store_dwordx4 v[196:199], v38, s[52:55], s82 offen offset:3072 sc1
v_mfma_f32_16x16x32_bf16 v[128:131], a[64:67], a[96:99], 0
s_add_u32 s86, s9, 8192
v_mfma_f32_16x16x32_bf16 v[144:147], a[64:67], a[100:103], 0
v_mfma_f32_16x16x32_bf16 v[132:135], a[68:71], a[96:99], 0
buffer_load_dwordx4 a[176:179], v77, s[52:55], s86 offen offset:0 sc1
v_mfma_f32_16x16x32_bf16 v[148:151], a[68:71], a[100:103], 0
v_mfma_f32_16x16x32_bf16 v[136:139], a[72:75], a[96:99], 0
v_mfma_f32_16x16x32_bf16 v[152:155], a[72:75], a[100:103], 0
v_mfma_f32_16x16x32_bf16 v[140:143], a[76:79], a[96:99], 0
buffer_load_dwordx4 a[180:183], v77, s[52:55], s86 offen offset:256 sc1
v_mfma_f32_16x16x32_bf16 v[156:159], a[76:79], a[100:103], 0
v_and_b32 v72, 15, v1
v_lshrrev_b32 v73, 4, v1
v_xor_b32 v73, v73, v1
v_and_b32 v73, 7, v73
v_mfma_f32_16x16x32_bf16 v[160:163], a[64:67], a[104:107], 0
v_mfma_f32_16x16x32_bf16 v[176:179], a[64:67], a[108:111], 0
v_mfma_f32_16x16x32_bf16 v[164:167], a[68:71], a[104:107], 0
buffer_load_dwordx4 a[184:187], v77, s[52:55], s86 offen offset:1024 sc1
v_mfma_f32_16x16x32_bf16 v[180:183], a[68:71], a[108:111], 0
v_mfma_f32_16x16x32_bf16 v[168:171], a[72:75], a[104:107], 0
v_mfma_f32_16x16x32_bf16 v[184:187], a[72:75], a[108:111], 0
v_mfma_f32_16x16x32_bf16 v[172:175], a[76:79], a[104:107], 0
buffer_load_dwordx4 a[188:191], v77, s[52:55], s86 offen offset:1280 sc1
v_mfma_f32_16x16x32_bf16 v[188:191], a[76:79], a[108:111], 0
v_lshlrev_b32_e64 v73, 4, v73
v_lshl_add_u32 v72, v72, 8, v73
v_add_u32 v112, s87, v72
v_xor_b32 v113, 64, v112
v_mfma_f32_16x16x32_bf16 v[128:131], a[80:83], a[112:115], v[128:131]
L_pad_Q_4:
s_cbranch_execz L_pad_Q_5
s_nop 0
ds_read_b64_tr_b16 v[80:81], v40 offset:32768
v_mfma_f32_16x16x32_bf16 v[144:147], a[80:83], a[116:119], v[144:147]
ds_read_b64_tr_b16 v[82:83], v40 offset:33792
s_add_u32 m0, s87, 65536
s_add_u32 s85, s7, 0
v_mfma_f32_16x16x32_bf16 v[132:135], a[84:87], a[112:115], v[132:135]
buffer_load_dwordx4 v32, s[48:51], s85 offen lds
v_mfma_f32_16x16x32_bf16 v[148:151], a[84:87], a[116:119], v[148:151]
ds_read_b64_tr_b16 v[84:85], v13 offset:32768
v_mfma_f32_16x16x32_bf16 v[136:139], a[88:91], a[112:115], v[136:139]
ds_read_b64_tr_b16 v[86:87], v13 offset:33792
v_mfma_f32_16x16x32_bf16 v[152:155], a[88:91], a[116:119], v[152:155]
v_mfma_f32_16x16x32_bf16 v[140:143], a[92:95], a[112:115], v[140:143]
buffer_load_dwordx4 v33, s[48:51], s85 offen offset:1024 lds
v_mfma_f32_16x16x32_bf16 v[156:159], a[92:95], a[116:119], v[156:159]
v_lshlrev_b32 v75, 2, v1
v_lshrrev_b32 v72, 3, v0
v_and_b32 v73, 7, v0
v_lshlrev_b32_e64 v74, 10, v72
v_mfma_f32_16x16x32_bf16 v[160:163], a[80:83], a[120:123], v[160:163]
ds_read_b64_tr_b16 v[88:89], v40 offset:33024
v_lshl_add_u32 v118, v73, 4, v74
v_mfma_f32_16x16x32_bf16 v[176:179], a[80:83], a[124:127], v[176:179]
ds_read_b64_tr_b16 v[90:91], v40 offset:34048
v_lshlrev_b32_e64 v73, 1, v73
v_mfma_f32_16x16x32_bf16 v[164:167], a[84:87], a[120:123], v[164:167]
ds_read_b64_tr_b16 v[92:93], v13 offset:33024
v_and_b32_e64 v74, 7, v72
v_mfma_f32_16x16x32_bf16 v[180:183], a[84:87], a[124:127], v[180:183]
ds_read_b64_tr_b16 v[94:95], v13 offset:34048
v_xor_b32_e64 v73, v73, v74
v_mfma_f32_16x16x32_bf16 v[168:171], a[88:91], a[120:123], v[168:171]
v_mfma_f32_16x16x32_bf16 v[184:187], a[88:91], a[124:127], v[184:187]
v_mfma_f32_16x16x32_bf16 v[172:175], a[92:95], a[120:123], v[172:175]
v_mfma_f32_16x16x32_bf16 v[188:191], a[92:95], a[124:127], v[188:191]
s_waitcnt lgkmcnt(4)
v_mfma_f32_16x16x32_bf16 v[128:131], v[80:83], a[128:131], v[128:131]
ds_read_b64_tr_b16 v[96:97], v41 offset:32768
v_mfma_f32_16x16x32_bf16 v[144:147], v[80:83], a[132:135], v[144:147]
ds_read_b64_tr_b16 v[98:99], v41 offset:33792
v_and_b32 v74, 15, v72
v_mfma_f32_16x16x32_bf16 v[132:135], v[84:87], a[128:131], v[132:135]
ds_read_b64_tr_b16 v[100:101], v14 offset:32768
v_lshlrev_b32_e64 v74, 8, v74
v_mfma_f32_16x16x32_bf16 v[148:151], v[84:87], a[132:135], v[148:151]
ds_read_b64_tr_b16 v[102:103], v14 offset:33792
s_waitcnt lgkmcnt(4)
v_mfma_f32_16x16x32_bf16 v[136:139], v[88:91], a[128:131], v[136:139]
v_lshl_add_u32 v73, v73, 4, v74
v_lshrrev_b32 v72, 4, v72
v_mfma_f32_16x16x32_bf16 v[152:155], v[88:91], a[132:135], v[152:155]
v_mfma_f32_16x16x32_bf16 v[140:143], v[92:95], a[128:131], v[140:143]
v_mfma_f32_16x16x32_bf16 v[156:159], v[92:95], a[132:135], v[156:159]
s_waitcnt vmcnt(19)
v_mfma_f32_16x16x32_bf16 v[160:163], v[80:83], a[136:139], v[160:163]
ds_read_b64_tr_b16 v[104:105], v41 offset:33024
v_lshl_add_u32 v116, v72, 14, v73
s_waitcnt vmcnt(18)
v_mfma_f32_16x16x32_bf16 v[176:179], v[80:83], a[140:143], v[176:179]
ds_read_b64_tr_b16 v[106:107], v41 offset:34048
v_xor_b32_e64 v117, 16, v116
v_mfma_f32_16x16x32_bf16 v[164:167], v[84:87], a[136:139], v[164:167]
ds_read_b64_tr_b16 v[108:109], v14 offset:33024
s_lshl_b32 s90, s77, 16
v_mfma_f32_16x16x32_bf16 v[180:183], v[84:87], a[140:143], v[180:183]
ds_read_b64_tr_b16 v[110:111], v14 offset:34048
s_lshl_b32 s91, s78, 7
v_mfma_f32_16x16x32_bf16 v[168:171], v[88:91], a[136:139], v[168:171]
v_mfma_f32_16x16x32_bf16 v[184:187], v[88:91], a[140:143], v[184:187]
v_mfma_f32_16x16x32_bf16 v[172:175], v[92:95], a[136:139], v[172:175]
v_mfma_f32_16x16x32_bf16 v[188:191], v[92:95], a[140:143], v[188:191]
s_waitcnt lgkmcnt(4)
s_waitcnt vmcnt(17)
v_mfma_f32_16x16x32_bf16 v[128:131], v[96:99], a[144:147], v[128:131]
ds_read_b64_tr_b16 v[80:81], v40 offset:16384
s_waitcnt vmcnt(16)
v_mfma_f32_16x16x32_bf16 v[144:147], v[96:99], a[148:151], v[144:147]
ds_read_b64_tr_b16 v[82:83], v40 offset:17408
s_waitcnt vmcnt(6)
s_atomic_add s70, s[26:27], s17
s_load_dword s68, s[26:27], s14 glc
v_mfma_f32_16x16x32_bf16 v[132:135], v[100:103], a[144:147], v[132:135]
buffer_load_dwordx4 v34, s[48:51], s85 offen offset:2048 lds
v_mfma_f32_16x16x32_bf16 v[148:151], v[100:103], a[148:151], v[148:151]
ds_read_b64_tr_b16 v[84:85], v13 offset:16384
s_waitcnt lgkmcnt(3)
v_mfma_f32_16x16x32_bf16 v[136:139], v[104:107], a[144:147], v[136:139]
ds_read_b64_tr_b16 v[86:87], v13 offset:17408
v_mfma_f32_16x16x32_bf16 v[152:155], v[104:107], a[148:151], v[152:155]
ds_read_b32 v47, v43
v_mfma_f32_16x16x32_bf16 v[140:143], v[108:111], a[144:147], v[140:143]
buffer_load_dwordx4 v35, s[48:51], s85 offen offset:3072 lds
v_mfma_f32_16x16x32_bf16 v[156:159], v[108:111], a[148:151], v[156:159]
ds_read_b32 v47, v43
s_add_u32 s90, s90, s91
s_add_u32 s91, s90, 32768
s_lshl_b32 s93, s77, 8
s_add_u32 s93, s93, 8454144
v_mfma_f32_16x16x32_bf16 v[160:163], v[96:99], a[152:155], v[160:163]
ds_read_b64_tr_b16 v[88:89], v40 offset:16640
s_add_u32 m0, s87, 32768
v_mfma_f32_16x16x32_bf16 v[176:179], v[96:99], a[156:159], v[176:179]
ds_read_b64_tr_b16 v[90:91], v40 offset:17664
s_add_u32 s85, s7, 32768
v_mfma_f32_16x16x32_bf16 v[164:167], v[100:103], a[152:155], v[164:167]
buffer_load_dwordx4 v32, s[48:51], s85 offen lds
v_mfma_f32_16x16x32_bf16 v[180:183], v[100:103], a[156:159], v[180:183]
ds_read_b64_tr_b16 v[92:93], v13 offset:16640
v_mfma_f32_16x16x32_bf16 v[168:171], v[104:107], a[152:155], v[168:171]
ds_read_b64_tr_b16 v[94:95], v13 offset:17664
v_mfma_f32_16x16x32_bf16 v[184:187], v[104:107], a[156:159], v[184:187]
ds_read_b32 v47, v43
v_mfma_f32_16x16x32_bf16 v[172:175], v[108:111], a[152:155], v[172:175]
buffer_load_dwordx4 v33, s[48:51], s85 offen offset:1024 lds
v_mfma_f32_16x16x32_bf16 v[188:191], v[108:111], a[156:159], v[188:191]
ds_read_b32 v47, v43
s_waitcnt lgkmcnt(6)
v_mfma_f32_16x16x32_bf16 v[128:131], v[80:83], a[160:163], v[128:131]
ds_read_b64_tr_b16 v[96:97], v41 offset:49152
v_mfma_f32_16x16x32_bf16 v[144:147], v[80:83], a[164:167], v[144:147]
ds_read_b64_tr_b16 v[98:99], v41 offset:50176
v_mfma_f32_16x16x32_bf16 v[132:135], v[84:87], a[160:163], v[132:135]
buffer_load_dwordx4 v34, s[48:51], s85 offen offset:2048 lds
v_mfma_f32_16x16x32_bf16 v[148:151], v[84:87], a[164:167], v[148:151]
ds_read_b64_tr_b16 v[100:101], v14 offset:49152
s_waitcnt lgkmcnt(3)
v_mfma_f32_16x16x32_bf16 v[136:139], v[88:91], a[160:163], v[136:139]
ds_read_b64_tr_b16 v[102:103], v14 offset:50176
v_mfma_f32_16x16x32_bf16 v[152:155], v[88:91], a[164:167], v[152:155]
ds_read_b32 v47, v43
v_mfma_f32_16x16x32_bf16 v[140:143], v[92:95], a[160:163], v[140:143]
buffer_load_dwordx4 v35, s[48:51], s85 offen offset:3072 lds
v_mfma_f32_16x16x32_bf16 v[156:159], v[92:95], a[164:167], v[156:159]
ds_read_b32 v47, v43
v_mfma_f32_16x16x32_bf16 v[160:163], v[80:83], a[168:171], v[160:163]
ds_read_b64_tr_b16 v[104:105], v41 offset:49408
v_mfma_f32_16x16x32_bf16 v[176:179], v[80:83], a[172:175], v[176:179]
ds_read_b64_tr_b16 v[106:107], v41 offset:50432
v_mfma_f32_16x16x32_bf16 v[164:167], v[84:87], a[168:171], v[164:167]
ds_read_b64_tr_b16 v[108:109], v14 offset:49408
v_mfma_f32_16x16x32_bf16 v[180:183], v[84:87], a[172:175], v[180:183]
ds_read_b64_tr_b16 v[110:111], v14 offset:50432
v_mfma_f32_16x16x32_bf16 v[168:171], v[88:91], a[168:171], v[168:171]
ds_read_b32 v47, v43
v_mfma_f32_16x16x32_bf16 v[184:187], v[88:91], a[172:175], v[184:187]
ds_read_b32 v47, v43
v_mfma_f32_16x16x32_bf16 v[172:175], v[92:95], a[168:171], v[172:175]
v_mfma_f32_16x16x32_bf16 v[188:191], v[92:95], a[172:175], v[188:191]
s_waitcnt lgkmcnt(0)
s_bfe_u32 s97, s68, 524304
s_cmp_lt_u32 s97, 6
s_cbranch_scc1 L_slow_Q3
L_back_Q3:
buffer_load_dword v120, v75, s[52:55], s93 offen sc1
s_add_u32 s86, s10, 0
buffer_load_dwordx4 a[192:195], v77, s[52:55], s86 offen offset:0 sc1
buffer_load_dwordx4 a[196:199], v77, s[52:55], s86 offen offset:256 sc1
buffer_load_dwordx4 a[200:203], v77, s[52:55], s86 offen offset:1024 sc1
buffer_load_dwordx4 a[204:207], v77, s[52:55], s86 offen offset:1280 sc1
s_add_u32 s86, s10, 4096
buffer_load_dwordx4 a[208:211], v77, s[52:55], s86 offen offset:0 sc1
buffer_load_dwordx4 a[212:215], v77, s[52:55], s86 offen offset:256 sc1
buffer_load_dwordx4 a[216:219], v77, s[52:55], s86 offen offset:1024 sc1
s_waitcnt vmcnt(19)
v_mfma_f32_16x16x32_bf16 v[128:131], v[96:99], a[176:179], v[128:131]
ds_read_b64_tr_b16 v[80:81], v42 offset:0
s_waitcnt vmcnt(18)
v_mfma_f32_16x16x32_bf16 v[144:147], v[96:99], a[180:183], v[144:147]
ds_read_b64_tr_b16 v[82:83], v42 offset:1024
v_mfma_f32_16x16x32_bf16 v[132:135], v[100:103], a[176:179], v[132:135]
buffer_load_dwordx4 a[220:223], v77, s[52:55], s86 offen offset:1280 sc1
v_mfma_f32_16x16x32_bf16 v[148:151], v[100:103], a[180:183], v[148:151]
ds_read_b64_tr_b16 v[84:85], v15 offset:0
v_mfma_f32_16x16x32_bf16 v[136:139], v[104:107], a[176:179], v[136:139]
ds_read_b64_tr_b16 v[86:87], v15 offset:1024
s_add_u32 s86, s20, 8192
v_mfma_f32_16x16x32_bf16 v[152:155], v[104:107], a[180:183], v[152:155]
v_mfma_f32_16x16x32_bf16 v[140:143], v[108:111], a[176:179], v[140:143]
buffer_load_dwordx4 a[224:227], v39, s[52:55], s86 offen offset:0 sc1
v_mfma_f32_16x16x32_bf16 v[156:159], v[108:111], a[180:183], v[156:159]
s_waitcnt vmcnt(19)
v_mfma_f32_16x16x32_bf16 v[160:163], v[96:99], a[184:187], v[160:163]
ds_read_b64_tr_b16 v[88:89], v42 offset:256
s_waitcnt vmcnt(18)
v_mfma_f32_16x16x32_bf16 v[176:179], v[96:99], a[188:191], v[176:179]
ds_read_b64_tr_b16 v[90:91], v42 offset:1280
v_mfma_f32_16x16x32_bf16 v[164:167], v[100:103], a[184:187], v[164:167]
buffer_load_dwordx4 a[228:231], v39, s[52:55], s86 offen offset:256 sc1
v_mfma_f32_16x16x32_bf16 v[180:183], v[100:103], a[188:191], v[180:183]
ds_read_b64_tr_b16 v[92:93], v15 offset:256
v_mfma_f32_16x16x32_bf16 v[168:171], v[104:107], a[184:187], v[168:171]
ds_read_b64_tr_b16 v[94:95], v15 offset:1280
v_mfma_f32_16x16x32_bf16 v[184:187], v[104:107], a[188:191], v[184:187]
v_mfma_f32_16x16x32_bf16 v[172:175], v[108:111], a[184:187], v[172:175]
buffer_load_dwordx4 a[232:235], v39, s[52:55], s86 offen offset:1024 sc1
v_mfma_f32_16x16x32_bf16 v[188:191], v[108:111], a[188:191], v[188:191]
s_waitcnt lgkmcnt(4)
s_waitcnt vmcnt(10)
v_mfma_f32_16x16x32_bf16 v[128:131], v[80:83], a[192:195], v[128:131]
ds_read_b64_tr_b16 v[96:97], v40 offset:0
s_waitcnt vmcnt(9)
v_mfma_f32_16x16x32_bf16 v[144:147], v[80:83], a[196:199], v[144:147]
ds_read_b64_tr_b16 v[98:99], v40 offset:1024
v_mfma_f32_16x16x32_bf16 v[132:135], v[84:87], a[192:195], v[132:135]
buffer_load_dwordx4 a[236:239], v39, s[52:55], s86 offen offset:1280 sc1
v_mfma_f32_16x16x32_bf16 v[148:151], v[84:87], a[196:199], v[148:151]
ds_read_b64_tr_b16 v[100:101], v13 offset:0
s_waitcnt lgkmcnt(3)
v_mfma_f32_16x16x32_bf16 v[136:139], v[88:91], a[192:195], v[136:139]
ds_read_b64_tr_b16 v[102:103], v13 offset:1024
s_add_u32 s86, s11, 0
v_mfma_f32_16x16x32_bf16 v[152:155], v[88:91], a[196:199], v[152:155]
v_mfma_f32_16x16x32_bf16 v[140:143], v[92:95], a[192:195], v[140:143]
buffer_load_dwordx4 a[240:243], v77, s[52:55], s86 offen offset:0 sc1
v_mfma_f32_16x16x32_bf16 v[156:159], v[92:95], a[196:199], v[156:159]
s_waitcnt vmcnt(10)
v_mfma_f32_16x16x32_bf16 v[160:163], v[80:83], a[200:203], v[160:163]
ds_read_b64_tr_b16 v[104:105], v40 offset:256
s_load_dword s68, s[26:27], s14 glc
s_waitcnt vmcnt(9)
v_mfma_f32_16x16x32_bf16 v[176:179], v[80:83], a[204:207], v[176:179]
ds_read_b64_tr_b16 v[106:107], v40 offset:1280
v_mfma_f32_16x16x32_bf16 v[164:167], v[84:87], a[200:203], v[164:167]
buffer_load_dwordx4 a[244:247], v77, s[52:55], s86 offen offset:256 sc1
v_mfma_f32_16x16x32_bf16 v[180:183], v[84:87], a[204:207], v[180:183]
ds_read_b64_tr_b16 v[108:109], v13 offset:256
v_mfma_f32_16x16x32_bf16 v[168:171], v[88:91], a[200:203], v[168:171]
ds_read_b64_tr_b16 v[110:111], v13 offset:1280
v_mfma_f32_16x16x32_bf16 v[184:187], v[88:91], a[204:207], v[184:187]
ds_read_b32 v47, v43
v_mfma_f32_16x16x32_bf16 v[172:175], v[92:95], a[200:203], v[172:175]
buffer_load_dwordx4 a[248:251], v77, s[52:55], s86 offen offset:1024 sc1
v_mfma_f32_16x16x32_bf16 v[188:191], v[92:95], a[204:207], v[188:191]
s_waitcnt lgkmcnt(5)
s_waitcnt vmcnt(10)
v_mfma_f32_16x16x32_bf16 v[128:131], v[96:99], a[208:211], v[128:131]
ds_read_b64_tr_b16 v[80:81], v40 offset:49152
s_waitcnt vmcnt(9)
v_mfma_f32_16x16x32_bf16 v[144:147], v[96:99], a[212:215], v[144:147]
ds_read_b64_tr_b16 v[82:83], v40 offset:50176
v_mfma_f32_16x16x32_bf16 v[132:135], v[100:103], a[208:211], v[132:135]
buffer_load_dwordx4 a[252:255], v77, s[52:55], s86 offen offset:1280 sc1
v_mfma_f32_16x16x32_bf16 v[148:151], v[100:103], a[212:215], v[148:151]
ds_read_b64_tr_b16 v[84:85], v13 offset:49152
s_waitcnt lgkmcnt(3)
v_mfma_f32_16x16x32_bf16 v[136:139], v[104:107], a[208:211], v[136:139]
ds_read_b64_tr_b16 v[86:87], v13 offset:50176
s_add_u32 s86, s11, 4096
v_mfma_f32_16x16x32_bf16 v[152:155], v[104:107], a[212:215], v[152:155]
ds_read_b32 v47, v43
v_mfma_f32_16x16x32_bf16 v[140:143], v[108:111], a[208:211], v[140:143]
buffer_load_dwordx4 a[96:99], v77, s[52:55], s86 offen offset:0 sc1
v_mfma_f32_16x16x32_bf16 v[156:159], v[108:111], a[212:215], v[156:159]
s_waitcnt vmcnt(10)
v_mfma_f32_16x16x32_bf16 v[160:163], v[96:99], a[216:219], v[160:163]
ds_read_b64_tr_b16 v[88:89], v40 offset:49408
s_waitcnt vmcnt(9)
v_mfma_f32_16x16x32_bf16 v[176:179], v[96:99], a[220:223], v[176:179]
ds_read_b64_tr_b16 v[90:91], v40 offset:50432
v_mfma_f32_16x16x32_bf16 v[164:167], v[100:103], a[216:219], v[164:167]
buffer_load_dwordx4 a[100:103], v77, s[52:55], s86 offen offset:256 sc1
v_mfma_f32_16x16x32_bf16 v[180:183], v[100:103], a[220:223], v[180:183]
ds_read_b64_tr_b16 v[92:93], v13 offset:49408
v_mfma_f32_16x16x32_bf16 v[168:171], v[104:107], a[216:219], v[168:171]
ds_read_b64_tr_b16 v[94:95], v13 offset:50432
v_mfma_f32_16x16x32_bf16 v[184:187], v[104:107], a[220:223], v[184:187]
ds_read_b32 v47, v43
v_mfma_f32_16x16x32_bf16 v[172:175], v[108:111], a[216:219], v[172:175]
buffer_load_dwordx4 a[104:107], v77, s[52:55], s86 offen offset:1024 sc1
v_mfma_f32_16x16x32_bf16 v[188:191], v[108:111], a[220:223], v[188:191]
s_waitcnt lgkmcnt(5)
s_waitcnt vmcnt(10)
v_mfma_f32_16x16x32_bf16 v[128:131], v[80:83], a[224:227], v[128:131]
ds_read_b64_tr_b16 v[96:97], v41 offset:0
s_waitcnt vmcnt(9)
v_mfma_f32_16x16x32_bf16 v[144:147], v[80:83], a[228:231], v[144:147]
ds_read_b64_tr_b16 v[98:99], v41 offset:1024
v_mfma_f32_16x16x32_bf16 v[132:135], v[84:87], a[224:227], v[132:135]
ds_read_b64_tr_b16 v[100:101], v14 offset:0
v_mfma_f32_16x16x32_bf16 v[148:151], v[84:87], a[228:231], v[148:151]
ds_read_b64_tr_b16 v[102:103], v14 offset:1024
s_waitcnt lgkmcnt(4)
v_mfma_f32_16x16x32_bf16 v[136:139], v[88:91], a[224:227], v[136:139]
ds_read_b32 v47, v43
v_mfma_f32_16x16x32_bf16 v[152:155], v[88:91], a[228:231], v[152:155]
v_mfma_f32_16x16x32_bf16 v[140:143], v[92:95], a[224:227], v[140:143]
buffer_load_dwordx4 a[108:111], v77, s[52:55], s86 offen offset:1280 sc1
v_mfma_f32_16x16x32_bf16 v[156:159], v[92:95], a[228:231], v[156:159]
s_waitcnt lgkmcnt(0)
s_bfe_u32 s97, s68, 524296
s_cmp_lt_u32 s97, 4
s_cbranch_scc1 L_slow_Q4
L_back_Q4:
s_add_u32 s86, s12, 0
buffer_load_dwordx4 a[112:115], v77, s[52:55], s86 offen offset:0 sc1
buffer_load_dwordx4 a[116:119], v77, s[52:55], s86 offen offset:256 sc1
s_add_u32 s86, s12, 4096
buffer_load_dwordx4 a[128:131], v77, s[52:55], s86 offen offset:0 sc1
buffer_load_dwordx4 a[132:135], v77, s[52:55], s86 offen offset:256 sc1
s_add_u32 s86, s22, 0
buffer_load_dwordx4 a[144:147], v77, s[52:55], s86 offen offset:0 sc1
buffer_load_dwordx4 a[148:151], v77, s[52:55], s86 offen offset:256 sc1
s_add_u32 s86, s22, 4096
buffer_load_dwordx4 a[160:163], v77, s[52:55], s86 offen offset:0 sc1
buffer_load_dwordx4 a[164:167], v77, s[52:55], s86 offen offset:256 sc1
s_waitcnt vmcnt(17)
v_mfma_f32_16x16x32_bf16 v[160:163], v[80:83], a[232:235], v[160:163]
ds_read_b64_tr_b16 v[104:105], v41 offset:256
s_add_u32 s86, s12, 0
s_waitcnt vmcnt(16)
v_mfma_f32_16x16x32_bf16 v[176:179], v[80:83], a[236:239], v[176:179]
ds_read_b64_tr_b16 v[106:107], v41 offset:1280
v_mfma_f32_16x16x32_bf16 v[164:167], v[84:87], a[232:235], v[164:167]
buffer_load_dwordx4 a[120:123], v77, s[52:55], s86 offen offset:1024 sc1
v_mfma_f32_16x16x32_bf16 v[180:183], v[84:87], a[236:239], v[180:183]
ds_read_b64_tr_b16 v[108:109], v14 offset:256
v_mfma_f32_16x16x32_bf16 v[168:171], v[88:91], a[232:235], v[168:171]
ds_read_b64_tr_b16 v[110:111], v14 offset:1280
v_mfma_f32_16x16x32_bf16 v[184:187], v[88:91], a[236:239], v[184:187]
v_mfma_f32_16x16x32_bf16 v[172:175], v[92:95], a[232:235], v[172:175]
buffer_load_dwordx4 a[124:127], v77, s[52:55], s86 offen offset:1280 sc1
v_mfma_f32_16x16x32_bf16 v[188:191], v[92:95], a[236:239], v[188:191]
s_waitcnt vmcnt(17)
v_mfma_f32_16x16x32_bf16 v[128:131], v[96:99], a[240:243], v[128:131]
ds_read_b64_tr_b16 v[80:81], v40 offset:32768
s_waitcnt vmcnt(16)
v_mfma_f32_16x16x32_bf16 v[144:147], v[96:99], a[244:247], v[144:147]
ds_read_b64_tr_b16 v[82:83], v40 offset:33792
s_add_u32 s86, s12, 4096
v_mfma_f32_16x16x32_bf16 v[132:135], v[100:103], a[240:243], v[132:135]
buffer_load_dwordx4 a[136:139], v77, s[52:55], s86 offen offset:1024 sc1
v_mfma_f32_16x16x32_bf16 v[148:151], v[100:103], a[244:247], v[148:151]
ds_read_b64_tr_b16 v[84:85], v13 offset:32768
s_waitcnt lgkmcnt(3)
v_mfma_f32_16x16x32_bf16 v[136:139], v[104:107], a[240:243], v[136:139]
ds_read_b64_tr_b16 v[86:87], v13 offset:33792
v_mfma_f32_16x16x32_bf16 v[152:155], v[104:107], a[244:247], v[152:155]
v_mfma_f32_16x16x32_bf16 v[140:143], v[108:111], a[240:243], v[140:143]
buffer_load_dwordx4 a[140:143], v77, s[52:55], s86 offen offset:1280 sc1
v_mfma_f32_16x16x32_bf16 v[156:159], v[108:111], a[244:247], v[156:159]
v_mul_f32 v120, -v120, v50
v_exp_f32 v120, v120
s_nop 0
v_add_f32 v120, 1.0, v120
v_rcp_f32 v120, v120
s_waitcnt vmcnt(17)
v_mfma_f32_16x16x32_bf16 v[160:163], v[96:99], a[248:251], v[160:163]
ds_read_b64_tr_b16 v[88:89], v40 offset:33024
s_add_u32 s86, s22, 0
s_waitcnt vmcnt(16)
v_mfma_f32_16x16x32_bf16 v[176:179], v[96:99], a[252:255], v[176:179]
ds_read_b64_tr_b16 v[90:91], v40 offset:34048
v_mfma_f32_16x16x32_bf16 v[164:167], v[100:103], a[248:251], v[164:167]
buffer_load_dwordx4 a[152:155], v77, s[52:55], s86 offen offset:1024 sc1
v_mfma_f32_16x16x32_bf16 v[180:183], v[100:103], a[252:255], v[180:183]
ds_read_b64_tr_b16 v[92:93], v13 offset:33024
v_mfma_f32_16x16x32_bf16 v[168:171], v[104:107], a[248:251], v[168:171]
ds_read_b64_tr_b16 v[94:95], v13 offset:34048
v_mfma_f32_16x16x32_bf16 v[184:187], v[104:107], a[252:255], v[184:187]
v_mfma_f32_16x16x32_bf16 v[172:175], v[108:111], a[248:251], v[172:175]
buffer_load_dwordx4 a[156:159], v77, s[52:55], s86 offen offset:1280 sc1
v_mfma_f32_16x16x32_bf16 v[188:191], v[108:111], a[252:255], v[188:191]
v_mov_b32 v121, v120
s_nop 1
v_permlane16_swap_b32 v120, v121
v_mov_b32 v122, v120
v_mov_b32_e64 v123, v121
s_waitcnt lgkmcnt(4)
s_waitcnt vmcnt(17)
v_mfma_f32_16x16x32_bf16 v[128:131], v[80:83], a[96:99], v[128:131]
s_add_u32 s86, s22, 4096
s_waitcnt vmcnt(16)
v_mfma_f32_16x16x32_bf16 v[144:147], v[80:83], a[100:103], v[144:147]
v_mfma_f32_16x16x32_bf16 v[132:135], v[84:87], a[96:99], v[132:135]
buffer_load_dwordx4 a[168:171], v77, s[52:55], s86 offen offset:1024 sc1
v_mfma_f32_16x16x32_bf16 v[148:151], v[84:87], a[100:103], v[148:151]
s_waitcnt lgkmcnt(0)
v_mfma_f32_16x16x32_bf16 v[136:139], v[88:91], a[96:99], v[136:139]
v_mfma_f32_16x16x32_bf16 v[152:155], v[88:91], a[100:103], v[152:155]
v_mfma_f32_16x16x32_bf16 v[140:143], v[92:95], a[96:99], v[140:143]
buffer_load_dwordx4 a[172:175], v77, s[52:55], s86 offen offset:1280 sc1
v_mfma_f32_16x16x32_bf16 v[156:159], v[92:95], a[100:103], v[156:159]
v_permlane32_swap_b32 v120, v122
v_permlane32_swap_b32 v121, v123
v_sub_f32_e64 v124, 1.0, v120
v_sub_f32 v125, 1.0, v121
s_waitcnt vmcnt(17)
v_mfma_f32_16x16x32_bf16 v[160:163], v[80:83], a[104:107], v[160:163]
v_sub_f32_e64 v126, 1.0, v122
v_sub_f32 v127, 1.0, v123
s_waitcnt vmcnt(16)
v_mfma_f32_16x16x32_bf16 v[176:179], v[80:83], a[108:111], v[176:179]
v_mfma_f32_16x16x32_bf16 v[164:167], v[84:87], a[104:107], v[164:167]
v_mfma_f32_16x16x32_bf16 v[180:183], v[84:87], a[108:111], v[180:183]
v_mfma_f32_16x16x32_bf16 v[168:171], v[88:91], a[104:107], v[168:171]
v_mfma_f32_16x16x32_bf16 v[184:187], v[88:91], a[108:111], v[184:187]
v_mfma_f32_16x16x32_bf16 v[172:175], v[92:95], a[104:107], v[172:175]
v_mfma_f32_16x16x32_bf16 v[188:191], v[92:95], a[108:111], v[188:191]
s_waitcnt vmcnt(15)
v_mfma_f32_16x16x32_bf16 v[192:195], a[0:3], a[112:115], 0
v_mul_f32 v128, v128, v124
v_mul_f32_e64 v129, v129, v124
v_mfma_f32_16x16x32_bf16 v[196:199], a[4:7], a[112:115], 0
v_mul_f32 v130, v130, v124
v_mul_f32 v131, v131, v124
v_mfma_f32_16x16x32_bf16 v[200:203], a[8:11], a[112:115], 0
v_mul_f32 v132, v132, v124
v_mul_f32 v133, v133, v124
v_mfma_f32_16x16x32_bf16 v[204:207], a[12:15], a[112:115], 0
v_mul_f32_e64 v134, v134, v124
v_mul_f32 v135, v135, v124
s_waitcnt vmcnt(14)
v_mfma_f32_16x16x32_bf16 v[208:211], a[0:3], a[116:119], 0
v_mul_f32 v136, v136, v124
v_mul_f32 v137, v137, v124
v_mfma_f32_16x16x32_bf16 v[212:215], a[4:7], a[116:119], 0
v_mul_f32 v138, v138, v124
v_mul_f32 v139, v139, v124
v_mfma_f32_16x16x32_bf16 v[216:219], a[8:11], a[116:119], 0
v_mul_f32_e64 v140, v140, v124
v_mfma_f32_16x16x32_bf16 v[220:223], a[12:15], a[116:119], 0
s_waitcnt vmcnt(13)
v_mfma_f32_16x16x32_bf16 v[192:195], a[16:19], a[128:131], v[192:195]
v_mul_f32 v141, v141, v124
v_mul_f32_e64 v142, v142, v124
v_mfma_f32_16x16x32_bf16 v[196:199], a[20:23], a[128:131], v[196:199]
v_mul_f32 v143, v143, v124
v_mul_f32 v144, v144, v125
v_mfma_f32_16x16x32_bf16 v[200:203], a[24:27], a[128:131], v[200:203]
v_mul_f32 v145, v145, v125
v_mul_f32 v146, v146, v125
v_mfma_f32_16x16x32_bf16 v[204:207], a[28:31], a[128:131], v[204:207]
v_mul_f32_e64 v147, v147, v125
v_mul_f32 v148, v148, v125
s_waitcnt vmcnt(12)
v_mfma_f32_16x16x32_bf16 v[208:211], a[16:19], a[132:135], v[208:211]
v_mul_f32 v149, v149, v125
v_mul_f32 v150, v150, v125
v_mfma_f32_16x16x32_bf16 v[212:215], a[20:23], a[132:135], v[212:215]
v_mul_f32 v151, v151, v125
v_mul_f32 v152, v152, v125
v_mfma_f32_16x16x32_bf16 v[216:219], a[24:27], a[132:135], v[216:219]
v_mul_f32_e64 v153, v153, v125
v_mfma_f32_16x16x32_bf16 v[220:223], a[28:31], a[132:135], v[220:223]
s_waitcnt vmcnt(11)
v_mfma_f32_16x16x32_bf16 v[192:195], a[32:35], a[144:147], v[192:195]
v_mul_f32 v154, v154, v125
v_mul_f32_e64 v155, v155, v125
v_mfma_f32_16x16x32_bf16 v[196:199], a[36:39], a[144:147], v[196:199]
v_mul_f32 v156, v156, v125
v_mul_f32 v157, v157, v125
v_mfma_f32_16x16x32_bf16 v[200:203], a[40:43], a[144:147], v[200:203]
v_mul_f32 v158, v158, v125
v_mul_f32 v159, v159, v125
v_mfma_f32_16x16x32_bf16 v[204:207], a[44:47], a[144:147], v[204:207]
v_mul_f32_e64 v160, v160, v126
v_mul_f32 v161, v161, v126
s_waitcnt vmcnt(10)
v_mfma_f32_16x16x32_bf16 v[208:211], a[32:35], a[148:151], v[208:211]
v_mul_f32 v162, v162, v126
v_mul_f32 v163, v163, v126
v_mfma_f32_16x16x32_bf16 v[212:215], a[36:39], a[148:151], v[212:215]
v_mul_f32 v164, v164, v126
v_mul_f32 v165, v165, v126
v_mfma_f32_16x16x32_bf16 v[216:219], a[40:43], a[148:151], v[216:219]
v_mul_f32_e64 v166, v166, v126
v_mfma_f32_16x16x32_bf16 v[220:223], a[44:47], a[148:151], v[220:223]
s_waitcnt vmcnt(9)
v_mfma_f32_16x16x32_bf16 v[192:195], a[48:51], a[160:163], v[192:195]
v_mul_f32 v167, v167, v126
v_mul_f32_e64 v168, v168, v126
v_mfma_f32_16x16x32_bf16 v[196:199], a[52:55], a[160:163], v[196:199]
v_mul_f32 v169, v169, v126
v_mul_f32 v170, v170, v126
v_mfma_f32_16x16x32_bf16 v[200:203], a[56:59], a[160:163], v[200:203]
v_mul_f32 v171, v171, v126
v_mul_f32 v172, v172, v126
v_mfma_f32_16x16x32_bf16 v[204:207], a[60:63], a[160:163], v[204:207]
v_mul_f32_e64 v173, v173, v126
v_mul_f32 v174, v174, v126
s_waitcnt vmcnt(8)
v_mfma_f32_16x16x32_bf16 v[208:211], a[48:51], a[164:167], v[208:211]
v_mul_f32 v175, v175, v126
v_mul_f32 v176, v176, v127
v_mfma_f32_16x16x32_bf16 v[212:215], a[52:55], a[164:167], v[212:215]
v_mul_f32 v177, v177, v127
v_mul_f32 v178, v178, v127
v_mfma_f32_16x16x32_bf16 v[216:219], a[56:59], a[164:167], v[216:219]
v_mul_f32_e64 v179, v179, v127
v_mfma_f32_16x16x32_bf16 v[220:223], a[60:63], a[164:167], v[220:223]
s_waitcnt vmcnt(7)
v_mfma_f32_16x16x32_bf16 v[224:227], a[0:3], a[120:123], 0
v_mul_f32 v180, v180, v127
v_mul_f32_e64 v181, v181, v127
v_mfma_f32_16x16x32_bf16 v[228:231], a[4:7], a[120:123], 0
v_mul_f32 v182, v182, v127
v_mul_f32 v183, v183, v127
v_mfma_f32_16x16x32_bf16 v[232:235], a[8:11], a[120:123], 0
v_mul_f32 v184, v184, v127
v_mul_f32 v185, v185, v127
v_mfma_f32_16x16x32_bf16 v[236:239], a[12:15], a[120:123], 0
v_mul_f32_e64 v186, v186, v127
v_mul_f32 v187, v187, v127
s_waitcnt vmcnt(6)
v_mfma_f32_16x16x32_bf16 v[240:243], a[0:3], a[124:127], 0
v_mul_f32 v188, v188, v127
v_mul_f32 v189, v189, v127
v_mfma_f32_16x16x32_bf16 v[244:247], a[4:7], a[124:127], 0
v_mul_f32 v190, v190, v127
v_mul_f32 v191, v191, v127
v_mfma_f32_16x16x32_bf16 v[248:251], a[8:11], a[124:127], 0
v_mfma_f32_16x16x32_bf16 v[252:255], a[12:15], a[124:127], 0
s_waitcnt vmcnt(5)
v_mfma_f32_16x16x32_bf16 v[224:227], a[16:19], a[136:139], v[224:227]
v_fmac_f32 v128, v192, v120
v_fmac_f32_e64 v129, v193, v120
v_mfma_f32_16x16x32_bf16 v[228:231], a[20:23], a[136:139], v[228:231]
v_fmac_f32 v130, v194, v120
v_fmac_f32 v131, v195, v120
v_mfma_f32_16x16x32_bf16 v[232:235], a[24:27], a[136:139], v[232:235]
ds_write_b128 v112, v[128:131] offset:0
v_fmac_f32_e64 v132, v196, v120
v_mfma_f32_16x16x32_bf16 v[236:239], a[28:31], a[136:139], v[236:239]
v_fmac_f32_e64 v133, v197, v120
v_fmac_f32 v134, v198, v120
s_waitcnt vmcnt(4)
v_mfma_f32_16x16x32_bf16 v[240:243], a[16:19], a[140:143], v[240:243]
v_fmac_f32_e64 v135, v199, v120
v_mfma_f32_16x16x32_bf16 v[244:247], a[20:23], a[140:143], v[244:247]
ds_write_b128 v113, v[132:135] offset:0
v_fmac_f32_e64 v136, v200, v120
v_mfma_f32_16x16x32_bf16 v[248:251], a[24:27], a[140:143], v[248:251]
v_fmac_f32 v137, v201, v120
v_fmac_f32 v138, v202, v120
v_mfma_f32_16x16x32_bf16 v[252:255], a[28:31], a[140:143], v[252:255]
v_fmac_f32_e64 v139, v203, v120
ds_write_b128 v112, v[136:139] offset:128
s_waitcnt vmcnt(3)
v_mfma_f32_16x16x32_bf16 v[224:227], a[32:35], a[152:155], v[224:227]
v_fmac_f32 v140, v204, v120
v_fmac_f32_e64 v141, v205, v120
v_mfma_f32_16x16x32_bf16 v[228:231], a[36:39], a[152:155], v[228:231]
v_fmac_f32 v142, v206, v120
v_fmac_f32 v143, v207, v120
v_mfma_f32_16x16x32_bf16 v[232:235], a[40:43], a[152:155], v[232:235]
ds_write_b128 v113, v[140:143] offset:128
v_fmac_f32_e64 v144, v208, v121
v_mfma_f32_16x16x32_bf16 v[236:239], a[44:47], a[152:155], v[236:239]
v_fmac_f32_e64 v145, v209, v121
v_fmac_f32 v146, v210, v121
s_waitcnt vmcnt(2)
v_mfma_f32_16x16x32_bf16 v[240:243], a[32:35], a[156:159], v[240:243]
v_fmac_f32_e64 v147, v211, v121
v_mfma_f32_16x16x32_bf16 v[244:247], a[36:39], a[156:159], v[244:247]
ds_write_b128 v112, v[144:147] offset:16384
v_fmac_f32_e64 v148, v212, v121
v_mfma_f32_16x16x32_bf16 v[248:251], a[40:43], a[156:159], v[248:251]
v_fmac_f32 v149, v213, v121
v_fmac_f32 v150, v214, v121
v_mfma_f32_16x16x32_bf16 v[252:255], a[44:47], a[156:159], v[252:255]
v_fmac_f32_e64 v151, v215, v121
ds_write_b128 v113, v[148:151] offset:16384
s_waitcnt vmcnt(1)
v_mfma_f32_16x16x32_bf16 v[224:227], a[48:51], a[168:171], v[224:227]
v_fmac_f32 v152, v216, v121
v_fmac_f32_e64 v153, v217, v121
v_mfma_f32_16x16x32_bf16 v[228:231], a[52:55], a[168:171], v[228:231]
v_fmac_f32 v154, v218, v121
v_fmac_f32 v155, v219, v121
v_mfma_f32_16x16x32_bf16 v[232:235], a[56:59], a[168:171], v[232:235]
ds_write_b128 v112, v[152:155] offset:16512
v_fmac_f32_e64 v156, v220, v121
v_mfma_f32_16x16x32_bf16 v[236:239], a[60:63], a[168:171], v[236:239]
v_fmac_f32_e64 v157, v221, v121
v_fmac_f32 v158, v222, v121
s_waitcnt vmcnt(0)
v_mfma_f32_16x16x32_bf16 v[240:243], a[48:51], a[172:175], v[240:243]
v_fmac_f32_e64 v159, v223, v121
v_mfma_f32_16x16x32_bf16 v[244:247], a[52:55], a[172:175], v[244:247]
ds_write_b128 v113, v[156:159] offset:16512
v_mfma_f32_16x16x32_bf16 v[248:251], a[56:59], a[172:175], v[248:251]
v_mfma_f32_16x16x32_bf16 v[252:255], a[60:63], a[172:175], v[252:255]
v_pk_fma_f32 v[160:161], v[224:225], v[122:123], v[160:161] op_sel_hi:[1,0,1]
v_pk_fma_f32 v[162:163], v[226:227], v[122:123], v[162:163] op_sel_hi:[1,0,1]
ds_write_b128 v112, v[160:163] offset:32768
v_pk_fma_f32 v[164:165], v[228:229], v[122:123], v[164:165] op_sel_hi:[1,0,1]
v_pk_fma_f32 v[166:167], v[230:231], v[122:123], v[166:167] op_sel_hi:[1,0,1]
ds_write_b128 v113, v[164:167] offset:32768
v_pk_fma_f32 v[168:169], v[232:233], v[122:123], v[168:169] op_sel_hi:[1,0,1]
v_pk_fma_f32 v[170:171], v[234:235], v[122:123], v[170:171] op_sel_hi:[1,0,1]
ds_write_b128 v112, v[168:171] offset:32896
v_pk_fma_f32 v[172:173], v[236:237], v[122:123], v[172:173] op_sel_hi:[1,0,1]
v_pk_fma_f32 v[174:175], v[238:239], v[122:123], v[174:175] op_sel_hi:[1,0,1]
L_pad_Q_5:
s_cbranch_execz L_padslow_Q
s_nop 0
ds_write_b128 v113, v[172:175] offset:32896
v_pk_fma_f32 v[176:177], v[240:241], v[122:123], v[176:177] op_sel:[0,1,0] op_sel_hi:[1,1,1]
v_pk_fma_f32 v[178:179], v[242:243], v[122:123], v[178:179] op_sel:[0,1,0] op_sel_hi:[1,1,1]
ds_write_b128 v112, v[176:179] offset:49152
v_pk_fma_f32 v[180:181], v[244:245], v[122:123], v[180:181] op_sel:[0,1,0] op_sel_hi:[1,1,1]
v_pk_fma_f32 v[182:183], v[246:247], v[122:123], v[182:183] op_sel:[0,1,0] op_sel_hi:[1,1,1]
ds_write_b128 v113, v[180:183] offset:49152
v_pk_fma_f32 v[184:185], v[248:249], v[122:123], v[184:185] op_sel:[0,1,0] op_sel_hi:[1,1,1]
v_pk_fma_f32 v[186:187], v[250:251], v[122:123], v[186:187] op_sel:[0,1,0] op_sel_hi:[1,1,1]
ds_write_b128 v112, v[184:187] offset:49280
v_pk_fma_f32 v[188:189], v[252:253], v[122:123], v[188:189] op_sel:[0,1,0] op_sel_hi:[1,1,1]
v_pk_fma_f32 v[190:191], v[254:255], v[122:123], v[190:191] op_sel:[0,1,0] op_sel_hi:[1,1,1]
ds_write_b128 v113, v[188:191] offset:49280
s_waitcnt lgkmcnt(0)
s_barrier
ds_read_b128 v[192:195], v116 offset:0
ds_read_b128 v[196:199], v117 offset:0
ds_read_b128 v[200:203], v116 offset:4096
ds_read_b128 v[204:207], v117 offset:4096
ds_read_b128 v[208:211], v116 offset:8192
ds_read_b128 v[212:215], v117 offset:8192
ds_read_b128 v[216:219], v116 offset:12288
ds_read_b128 v[220:223], v117 offset:12288
ds_read_b128 v[128:131], v116 offset:32768
ds_read_b128 v[132:135], v117 offset:32768
ds_read_b128 v[136:139], v116 offset:36864
ds_read_b128 v[140:143], v117 offset:36864
ds_read_b128 v[144:147], v116 offset:40960
ds_read_b128 v[148:151], v117 offset:40960
ds_read_b128 v[152:155], v116 offset:45056
ds_read_b128 v[156:159], v117 offset:45056
s_waitcnt lgkmcnt(13)
v_pk_add_f32 v[192:193], v[192:193], v[200:201]
v_pk_add_f32 v[194:195], v[194:195], v[202:203]
s_waitcnt lgkmcnt(12)
v_pk_add_f32 v[196:197], v[196:197], v[204:205]
v_pk_add_f32 v[198:199], v[198:199], v[206:207]
s_waitcnt lgkmcnt(9)
v_pk_add_f32 v[208:209], v[208:209], v[216:217]
v_pk_add_f32 v[210:211], v[210:211], v[218:219]
s_waitcnt lgkmcnt(8)
v_pk_add_f32 v[212:213], v[212:213], v[220:221]
v_pk_add_f32 v[214:215], v[214:215], v[222:223]
v_pk_add_f32 v[192:193], v[192:193], v[208:209]
v_pk_add_f32 v[194:195], v[194:195], v[210:211]
v_pk_add_f32 v[196:197], v[196:197], v[212:213]
v_pk_add_f32 v[198:199], v[198:199], v[214:215]
v_cvt_pk_bf16_f32 v200, v192, v193
v_cvt_pk_bf16_f32 v201, v194, v195
v_cvt_pk_bf16_f32 v202, v196, v197
v_cvt_pk_bf16_f32 v203, v198, v199
buffer_store_dwordx4 v[200:203], v118, s[56:59], s90 offen
s_waitcnt lgkmcnt(5)
v_pk_add_f32 v[128:129], v[128:129], v[136:137]
v_pk_add_f32 v[130:131], v[130:131], v[138:139]
s_waitcnt lgkmcnt(4)
v_pk_add_f32 v[132:133], v[132:133], v[140:141]
v_pk_add_f32 v[134:135], v[134:135], v[142:143]
s_waitcnt lgkmcnt(1)
v_pk_add_f32 v[144:145], v[144:145], v[152:153]
v_pk_add_f32 v[146:147], v[146:147], v[154:155]
s_waitcnt lgkmcnt(0)
v_pk_add_f32 v[148:149], v[148:149], v[156:157]
v_pk_add_f32 v[150:151], v[150:151], v[158:159]
v_pk_add_f32 v[128:129], v[128:129], v[144:145]
v_pk_add_f32 v[130:131], v[130:131], v[146:147]
v_pk_add_f32 v[132:133], v[132:133], v[148:149]
v_pk_add_f32 v[134:135], v[134:135], v[150:151]
v_cvt_pk_bf16_f32 v136, v128, v129
v_cvt_pk_bf16_f32 v137, v130, v131
v_cvt_pk_bf16_f32 v138, v132, v133
v_cvt_pk_bf16_f32 v139, v134, v135
buffer_store_dwordx4 v[136:139], v118, s[56:59], s91 offen
s_endpgm
L_padslow_Q:
s_branch L_warm_Q
L_slow_Q0:
s_mov_b32 s96, 0
L_spin_Q0:
s_add_u32 s96, s96, 1
v_mov_b32 v47, 0
global_load_dword v47, v47, s[24:25] sc1
s_waitcnt vmcnt(0)
v_readfirstlane_b32 s68, v47
s_nop 3
s_bfe_u32 s97, s68, 524288
s_cmp_lt_u32 s97, 16
s_cbranch_scc0 L_back_Q0
s_cmp_ge_u32 s96, 0x8000
s_cbranch_scc1 L_back_Q0
s_sleep 16
s_branch L_spin_Q0
L_slow_Q1:
s_mov_b32 s96, 0
L_spin_Q1:
s_add_u32 s96, s96, 1
s_load_dword s68, s[26:27], s14 glc
s_waitcnt lgkmcnt(0)
s_bfe_u32 s97, s68, 524288
s_cmp_lt_u32 s97, 4
s_cbranch_scc0 L_back_Q1
s_cmp_ge_u32 s96, 0x8000
s_cbranch_scc1 L_back_Q1
s_sleep 3
s_branch L_spin_Q1
L_slow_Q2:
s_mov_b32 s96, 0
L_spin_Q2:
s_add_u32 s96, s96, 1
s_load_dword s68, s[26:27], s15 glc
s_waitcnt lgkmcnt(0)
s_bfe_u32 s97, s68, 524296
s_cmp_lt_u32 s97, 5
s_cbranch_scc0 L_back_Q2
s_cmp_ge_u32 s96, 0x8000
s_cbranch_scc1 L_back_Q2
s_sleep 3
s_branch L_spin_Q2
L_slow_Q3:
s_mov_b32 s96, 0
L_spin_Q3:
s_add_u32 s96, s96, 1
s_load_dword s68, s[26:27], s14 glc
s_waitcnt lgkmcnt(0)
s_bfe_u32 s97, s68, 524304
s_cmp_lt_u32 s97, 6
s_cbranch_scc0 L_back_Q3
s_cmp_ge_u32 s96, 0x8000
s_cbranch_scc1 L_back_Q3
s_sleep 1
s_branch L_spin_Q3
L_slow_Q4:
s_mov_b32 s96, 0
L_spin_Q4:
s_add_u32 s96, s96, 1
s_load_dword s68, s[26:27], s14 glc
s_waitcnt lgkmcnt(0)
s_bfe_u32 s97, s68, 524296
s_cmp_lt_u32 s97, 4
s_cbranch_scc0 L_back_Q4
s_cmp_ge_u32 s96, 0x8000
s_cbranch_scc1 L_back_Q4
s_sleep 1
s_branch L_spin_Q4
L_end:
s_endpgm
.fill 2048, 4, 0xbf810000
.section .rodata,"a"
.p2align 6
.amdhsa_kernel gated_mix__linear_kernel_hedgehog__glu_gated_geglu__prompt_kernel
  .amdhsa_next_free_vgpr 512
  .amdhsa_next_free_sgpr 102
  .amdhsa_accum_offset 256
  .amdhsa_group_segment_fixed_size 0
  .amdhsa_kernarg_size 96
  .amdhsa_user_sgpr_count 2
  .amdhsa_user_sgpr_kernarg_segment_ptr 1
  .amdhsa_system_sgpr_workgroup_id_x 1
.end_amdhsa_kernel
```
